```python
import torch

def _softmax(x, axis=-1):
    return torch.softmax(x, dim=axis)
def _gelu(x):
    return torch.nn.functional.gelu(x, approximate="tanh")
def _silu(x):
    return torch.nn.functional.silu(x)
def _sigmoid(x):
    return torch.sigmoid(x)
def _layernorm(x, axis=-1, eps=1e-5):
    m = x.mean(dim=axis, keepdim=True)
    v = x.var(dim=axis, keepdim=True, unbiased=False)
    return (x - m) / torch.sqrt(v + eps)
def _scatter_add(tgt, idx, src, axis=0):
    return tgt.clone().index_add_(axis, idx, src)
def _segment_sum(src, seg, n):
    out = torch.zeros((n,) + src.shape[1:], dtype=src.dtype)
    return out.index_add_(0, seg, src)
def _pad(x, pw):
    flat = tuple(v for pair in reversed(pw) for v in pair)
    return torch.nn.functional.pad(x, flat)

kernel_name = 'gated_mix__softmax_full_mha__glu_gated_glu__prompt'

def setup_inputs():

    _w = (lambda a: (lambda t: t.to(torch.bfloat16) if t.is_floating_point() else t)(torch.as_tensor(a)))
    def _A_setup():
        B, S, D = 1, 2048, 448
        return {
            "x": _w((lambda *s: torch.randn(*s, dtype=torch.bfloat16) * 0.05)(B, S, D)),
            "wqkv": _w((lambda *s: torch.randn(*s, dtype=torch.bfloat16) * 0.8)(D, 3 * D)),
            "wo": _w((lambda *s: torch.randn(*s, dtype=torch.bfloat16) * 0.1)(D, D)),
        }
    _A_in = _A_setup()

    def _B_setup():
        B, S, D, F = 1, 2048, 448, 1792
        return {
            "x": _w((lambda *s: torch.randn(*s, dtype=torch.bfloat16) * 0.05)(B, S, D)),
            "w_gate": _w((lambda *s: torch.randn(*s, dtype=torch.bfloat16) * 0.4)(D, F)),
            "w_up": _w((lambda *s: torch.randn(*s, dtype=torch.bfloat16) * 0.05)(D, F)),
            "w_down": _w((lambda *s: torch.randn(*s, dtype=torch.bfloat16) * 0.05)(F, D)),
        }
    _B_in = _B_setup()

    return {
        "A_x": _A_in["x"],
        "A_wqkv": _A_in["wqkv"],
        "A_wo": _A_in["wo"],
        "B_x": _B_in["x"],
        "B_w_gate": _B_in["w_gate"],
        "B_w_up": _B_in["w_up"],
        "B_w_down": _B_in["w_down"],
        "gate_w": _w((lambda *s: torch.randn(*s, dtype=torch.bfloat16) * 0.05)(448) * 16.0),
    }

def reference(A_x, A_wqkv, A_wo, B_x, B_w_gate, B_w_up, B_w_down, gate_w):
    def _A_ref(x, wqkv, wo):
        B, S, D = x.shape
        H = 16; Dh = D // H
        qkv = (lambda x, *d: x.permute(*d))((x @ wqkv).reshape(B, S, 3, H, Dh), 2, 0, 3, 1, 4)
        q, k, v = qkv[0], qkv[1], qkv[2]
        scale = Dh ** -0.5
        scores = torch.einsum("bhqd,bhkd->bhqk", q, k) * scale
        p = _softmax(scores, axis=-1)
        o = torch.einsum("bhqk,bhkd->bhqd", p, v)
        return (lambda x, *d: x.permute(*d))(o, 0, 2, 1, 3).reshape(B, S, D) @ wo

    def _B_ref(x, w_gate, w_up, w_down):
        g = torch.einsum("bsd,df->bsf", x, w_gate)
        u = torch.einsum("bsd,df->bsf", x, w_up)
        h = _sigmoid(g) * u
        return torch.einsum("bsf,fd->bsd", h, w_down)

    x = A_x
    g = _sigmoid((x * gate_w).sum(-1, keepdims=True))
    a = _A_ref(x, A_wqkv, A_wo)
    b = _B_ref(x, B_w_gate, B_w_up, B_w_down)
    return g * a + (1 - g) * b
```

```asm
; @launch kernel=k1_kernel grid=(256,1,1) block=(512,1,1) lds=163840
; @launch kernel=k2_kernel grid=(256,1,1) block=(768,1,1) lds=155904
.amdgcn_target "amdgcn-amd-amdhsa--gfx950"
.text
.p2align 8
.globl k1_kernel
.type k1_kernel,@function
k1_kernel:
    s_cmp_ge_u32 s2, 256
    s_cbranch_scc1 K1_END
    s_load_dwordx16 s[16:31], s[0:1], 0
    s_load_dwordx2 s[32:33], s[0:1], 80
    v_lshrrev_b32 v2, 6, v0
    v_and_b32 v1, 63, v0
    s_and_b32 s6, s2, 7
    s_lshr_b32 s7, s2, 3
    v_readfirstlane_b32 s3, v2
    s_cmp_ge_u32 s3, 4
    s_cbranch_scc1 K1_LDS
    s_lshl2_add_u32 s8, s7, s3
    s_cmp_ge_u32 s8, 0x7f
    s_cbranch_scc1 K1_CONS
    s_mul_i32 s8, s8, 256
    s_getpc_b64 s[10:11]
K1_PC:
    s_add_u32 s8, s8, ST_A_0 - K1_PC
    s_add_u32 s10, s10, s8
    s_addc_u32 s11, s11, 0
    s_mov_b64 exec, 0
    s_setpc_b64 s[10:11]
K1_LDS:
    s_and_b32 s4, s6, 1
    s_lshl_b32 s4, s4, 3
    s_lshr_b32 s6, s6, 1
    s_mul_i32 s8, s6, 28
    s_add_u32 s8, s8, s7
    s_sub_u32 s8, s8, 4
    s_lshr_b32 s5, s8, 3
    s_and_b32 s8, s8, 7
    s_and_b32 s9, s7, 1
    s_add_u32 s9, s9, 14
    s_lshr_b32 s10, s7, 1
    s_lshl_b32 s6, s6, 1
    s_add_u32 s10, s10, s6
    s_cmp_lt_u32 s7, 4
    s_cselect_b32 s5, s9, s5
    s_cselect_b32 s8, s10, s8
    s_add_u32 s4, s4, s8
    s_sub_u32 s40, s3, 4
    s_and_b32 s41, s40, 1
    s_lshr_b32 s42, s40, 1
    v_lshrrev_b32 v3, 3, v1
    v_lshrrev_b32 v4, 4, v1
    v_and_b32 v5, 7, v1
    s_lshl_b32 s8, s41, 2
    v_add_u32 v6, s8, v4
    v_and_b32 v6, 7, v6
    v_xor_b32 v6, v6, v5
    v_mul_u32_u24 v2, 896, v3
    v_lshl_add_u32 v2, v6, 4, v2
    s_lshl_b32 s8, s4, 7
    s_lshl_b32 s9, s40, 3
    s_add_u32 s8, s8, s9
    s_mul_i32 s43, s8, 896
    v_and_b32 v4, 1, v4
ST_A_0:
    s_cbranch_execz ST_C_0
    s_lshl_b32 s8, s41, 1
    v_or_b32 v6, s8, v4
    v_lshlrev_b32 v6, 1, v6
    v_xor_b32 v6, v6, v5
    v_mul_u32_u24 v8, 3584, v3
    v_lshl_add_u32 v8, v6, 4, v8
    v_lshlrev_b32 v6, 2, v4
    v_xor_b32 v6, v6, v5
    v_mul_u32_u24 v9, 2688, v3
    v_lshl_add_u32 v9, v6, 4, v9
    s_lshl_b32 s44, s41, 11
    s_lshl_b32 s8, s42, 10
    s_add_u32 s44, s44, s8
    s_add_u32 s44, s44, 114688
    s_lshl_b32 s45, s40, 10
    s_mul_i32 s8, s5, 2
    s_add_u32 s8, s8, s4
    s_mul_i32 s9, s8, 37
    s_lshr_b32 s9, s9, 8
    s_mul_i32 s9, s9, 7
    s_sub_u32 s72, s8, s9
    s_mul_i32 s72, s72, 259
    s_lshr_b32 s72, s72, 8
    s_lshl_b32 s8, s41, 1
    s_add_u32 s8, s8, s42
    s_mul_i32 s56, s8, 21504
    s_mul_i32 s47, s5, 128
    s_add_u32 s47, s47, s56
    s_add_u32 s56, s56, 2560
    s_mov_b32 s38, 1835008
    s_mov_b32 s39, 0x00020000
    s_mov_b32 s50, 1605632
    s_mov_b32 s51, 0x00020000
    s_mov_b32 s54, 1204224
    s_mov_b32 s55, 0x00020000
    s_mov_b32 s34, 29360128
    s_mov_b32 s35, 0x00020000
    s_cmp_eq_u32 s41, 0
    s_waitcnt lgkmcnt(0)
    s_mov_b32 s36, s16
    s_mov_b32 s37, s17
    s_cselect_b32 s48, s24, s26
    s_cselect_b32 s49, s25, s27
    s_mov_b32 s52, s18
    s_mov_b32 s53, s19
    s_cmp_eq_u32 s5, 14
ST_A_1:
    s_cbranch_execz ST_C_1
    s_cbranch_scc1 K1_LD1
    s_cmp_eq_u32 s5, 15
    s_cbranch_scc1 K1_LD2
K1_LD0:
    s_mul_i32 s46, s42, 28672
    s_lshl_b32 s8, s5, 8
    s_add_u32 s46, s46, s8
    s_add_u32 m0, s45, 0
    s_lshl_b32 s11, s72, 7
    s_add_u32 s11, s11, s43
    buffer_load_dwordx4 v2, s[36:39], s11 offen lds
    s_add_u32 m0, s45, 4096
    s_lshl_b32 s11, s72, 7
    s_add_u32 s11, s11, s43
    s_add_u32 s11, s11, 28672
    buffer_load_dwordx4 v2, s[36:39], s11 offen lds
    s_add_u32 m0, s45, 8192
    s_lshl_b32 s11, s72, 7
    s_add_u32 s11, s11, s43
    s_add_u32 s11, s11, 57344
    buffer_load_dwordx4 v2, s[36:39], s11 offen lds
    s_add_u32 m0, s45, 12288
    s_lshl_b32 s11, s72, 7
    s_add_u32 s11, s11, s43
    s_add_u32 s11, s11, 86016
    buffer_load_dwordx4 v2, s[36:39], s11 offen lds
    s_mul_i32 s13, s72, 229376
    s_add_u32 s13, s13, s46
    s_add_u32 m0, s44, 0
    s_add_u32 s11, s13, 0
    buffer_load_dwordx4 v8, s[48:51], s11 offen lds
    s_add_u32 m0, s44, 4096
    s_add_u32 s11, s13, 57344
    buffer_load_dwordx4 v8, s[48:51], s11 offen lds
    s_mul_i32 s13, s72, 229376
    s_add_u32 s13, s13, s46
    s_add_u32 m0, s44, 8192
    s_add_u32 s11, s13, 114688
    buffer_load_dwordx4 v8, s[48:51], s11 offen lds
    s_add_u32 m0, s44, 12288
    s_add_u32 s11, s13, 172032
    s_nop 0
ST_A_2:
    s_cbranch_execz ST_C_2
    buffer_load_dwordx4 v8, s[48:51], s11 offen lds
    s_add_u32 s73, s72, 1
    s_cmp_eq_u32 s73, 7
    s_cselect_b32 s73, 0, s73
    s_add_u32 m0, s45, 16384
    s_lshl_b32 s11, s73, 7
    s_add_u32 s11, s11, s43
    buffer_load_dwordx4 v2, s[36:39], s11 offen lds
    s_add_u32 m0, s45, 20480
    s_lshl_b32 s11, s73, 7
    s_add_u32 s11, s11, s43
    s_add_u32 s11, s11, 28672
    buffer_load_dwordx4 v2, s[36:39], s11 offen lds
    s_add_u32 m0, s45, 24576
    s_lshl_b32 s11, s73, 7
    s_add_u32 s11, s11, s43
    s_add_u32 s11, s11, 57344
    buffer_load_dwordx4 v2, s[36:39], s11 offen lds
    s_add_u32 m0, s45, 28672
    s_lshl_b32 s11, s73, 7
    s_add_u32 s11, s11, s43
    s_add_u32 s11, s11, 86016
    buffer_load_dwordx4 v2, s[36:39], s11 offen lds
    s_mul_i32 s13, s73, 229376
    s_add_u32 s13, s13, s46
    s_add_u32 m0, s44, 16384
    s_add_u32 s11, s13, 0
    buffer_load_dwordx4 v8, s[48:51], s11 offen lds
    s_add_u32 m0, s44, 20480
    s_add_u32 s11, s13, 57344
    buffer_load_dwordx4 v8, s[48:51], s11 offen lds
    s_mul_i32 s13, s73, 229376
    s_add_u32 s13, s13, s46
    s_add_u32 m0, s44, 24576
    s_add_u32 s11, s13, 114688
    buffer_load_dwordx4 v8, s[48:51], s11 offen lds
    s_add_u32 m0, s44, 28672
    s_add_u32 s11, s13, 172032
    s_nop 0
ST_A_3:
    s_cbranch_execz ST_C_3
    buffer_load_dwordx4 v8, s[48:51], s11 offen lds
    v_lshl_add_u32 v20, v1, 4, s44
    s_waitcnt vmcnt(10)
    s_barrier
    s_add_u32 s74, s73, 1
    s_cmp_eq_u32 s74, 7
    s_cselect_b32 s74, 0, s74
    s_mul_i32 s13, s74, 229376
    s_add_u32 s13, s13, s46
    s_add_u32 m0, s44, 32768
    s_add_u32 s11, s13, 0
    buffer_load_dwordx4 v8, s[48:51], s11 offen lds
    s_add_u32 m0, s44, 36864
    s_add_u32 s11, s13, 57344
    buffer_load_dwordx4 v8, s[48:51], s11 offen lds
    s_add_u32 m0, s45, 32768
    s_lshl_b32 s11, s74, 7
    s_add_u32 s11, s11, s43
    buffer_load_dwordx4 v2, s[36:39], s11 offen lds
    s_add_u32 m0, s45, 36864
    s_lshl_b32 s11, s74, 7
    s_add_u32 s11, s11, s43
    s_add_u32 s11, s11, 28672
    buffer_load_dwordx4 v2, s[36:39], s11 offen lds
    s_add_u32 m0, s45, 40960
    s_lshl_b32 s11, s74, 7
    s_add_u32 s11, s11, s43
    s_add_u32 s11, s11, 57344
    buffer_load_dwordx4 v2, s[36:39], s11 offen lds
    s_waitcnt vmcnt(13)
    s_barrier
    s_mul_i32 s13, s74, 229376
    s_add_u32 s13, s13, s46
    s_add_u32 m0, s44, 40960
    s_add_u32 s11, s13, 114688
    buffer_load_dwordx4 v8, s[48:51], s11 offen lds
    s_add_u32 m0, s44, 45056
    s_add_u32 s11, s13, 172032
    buffer_load_dwordx4 v8, s[48:51], s11 offen lds
    s_nop 0
ST_A_4:
    s_cbranch_execz ST_C_4
    s_add_u32 m0, s45, 45056
    s_lshl_b32 s11, s74, 7
    s_add_u32 s11, s11, s43
    s_add_u32 s11, s11, 86016
    buffer_load_dwordx4 v2, s[36:39], s11 offen lds
    s_add_u32 s75, s74, 1
    s_cmp_eq_u32 s75, 7
    s_cselect_b32 s75, 0, s75
    s_add_u32 m0, s45, 49152
    s_lshl_b32 s11, s75, 7
    s_add_u32 s11, s11, s43
    buffer_load_dwordx4 v2, s[36:39], s11 offen lds
    s_add_u32 m0, s45, 53248
    s_lshl_b32 s11, s75, 7
    s_add_u32 s11, s11, s43
    s_add_u32 s11, s11, 28672
    buffer_load_dwordx4 v2, s[36:39], s11 offen lds
    s_waitcnt vmcnt(12)
    s_barrier
    s_mul_i32 s13, s75, 229376
    s_add_u32 s13, s13, s46
    s_add_u32 m0, s44, 0
    s_add_u32 s11, s13, 0
    buffer_load_dwordx4 v8, s[48:51], s11 offen lds
    s_add_u32 m0, s44, 4096
    s_add_u32 s11, s13, 57344
    buffer_load_dwordx4 v8, s[48:51], s11 offen lds
    s_add_u32 m0, s45, 57344
    s_lshl_b32 s11, s75, 7
    s_add_u32 s11, s11, s43
    s_add_u32 s11, s11, 57344
    buffer_load_dwordx4 v2, s[36:39], s11 offen lds
    s_add_u32 m0, s45, 61440
    s_lshl_b32 s11, s75, 7
    s_add_u32 s11, s11, s43
    s_add_u32 s11, s11, 86016
    buffer_load_dwordx4 v2, s[36:39], s11 offen lds
    s_add_u32 s76, s75, 1
    s_cmp_eq_u32 s76, 7
    s_cselect_b32 s76, 0, s76
    s_add_u32 m0, s45, 65536
    s_lshl_b32 s11, s76, 7
    s_add_u32 s11, s11, s43
ST_A_5:
    s_cbranch_execz ST_C_5
    buffer_load_dwordx4 v2, s[36:39], s11 offen lds
    s_waitcnt vmcnt(15)
    s_barrier
    s_mul_i32 s13, s75, 229376
    s_add_u32 s13, s13, s46
    s_add_u32 m0, s44, 8192
    s_add_u32 s11, s13, 114688
    buffer_load_dwordx4 v8, s[48:51], s11 offen lds
    s_add_u32 m0, s44, 12288
    s_add_u32 s11, s13, 172032
    buffer_load_dwordx4 v8, s[48:51], s11 offen lds
    s_add_u32 m0, s45, 69632
    s_lshl_b32 s11, s76, 7
    s_add_u32 s11, s11, s43
    s_add_u32 s11, s11, 28672
    buffer_load_dwordx4 v2, s[36:39], s11 offen lds
    s_add_u32 m0, s45, 73728
    s_lshl_b32 s11, s76, 7
    s_add_u32 s11, s11, s43
    s_add_u32 s11, s11, 57344
    buffer_load_dwordx4 v2, s[36:39], s11 offen lds
    s_add_u32 m0, s45, 77824
    s_lshl_b32 s11, s76, 7
    s_add_u32 s11, s11, s43
    s_add_u32 s11, s11, 86016
    buffer_load_dwordx4 v2, s[36:39], s11 offen lds
    s_waitcnt vmcnt(12)
    s_barrier
    s_mul_i32 s13, s76, 229376
    s_add_u32 s13, s13, s46
    s_add_u32 m0, s44, 16384
    s_add_u32 s11, s13, 0
    buffer_load_dwordx4 v8, s[48:51], s11 offen lds
    s_add_u32 m0, s44, 20480
    s_add_u32 s11, s13, 57344
    buffer_load_dwordx4 v8, s[48:51], s11 offen lds
    s_add_u32 s77, s76, 1
    s_cmp_eq_u32 s77, 7
    s_cselect_b32 s77, 0, s77
    s_nop 0
ST_A_6:
    s_cbranch_execz ST_C_6
    s_add_u32 m0, s45, 81920
    s_lshl_b32 s11, s77, 7
    s_add_u32 s11, s11, s43
    buffer_load_dwordx4 v2, s[36:39], s11 offen lds
    s_add_u32 m0, s45, 86016
    s_lshl_b32 s11, s77, 7
    s_add_u32 s11, s11, s43
    s_add_u32 s11, s11, 28672
    buffer_load_dwordx4 v2, s[36:39], s11 offen lds
    s_add_u32 m0, s45, 90112
    s_lshl_b32 s11, s77, 7
    s_add_u32 s11, s11, s43
    s_add_u32 s11, s11, 57344
    buffer_load_dwordx4 v2, s[36:39], s11 offen lds
    s_barrier
    s_mul_i32 s13, s76, 229376
    s_add_u32 s13, s13, s46
    s_add_u32 m0, s44, 24576
    s_add_u32 s11, s13, 114688
    buffer_load_dwordx4 v8, s[48:51], s11 offen lds
    s_add_u32 m0, s44, 28672
    s_add_u32 s11, s13, 172032
    buffer_load_dwordx4 v8, s[48:51], s11 offen lds
    s_add_u32 m0, s45, 94208
    s_lshl_b32 s11, s77, 7
    s_add_u32 s11, s11, s43
    s_add_u32 s11, s11, 86016
    buffer_load_dwordx4 v2, s[36:39], s11 offen lds
    s_add_u32 s78, s77, 1
    s_cmp_eq_u32 s78, 7
    s_cselect_b32 s78, 0, s78
    s_add_u32 m0, s45, 98304
    s_lshl_b32 s11, s78, 7
    s_add_u32 s11, s11, s43
    buffer_load_dwordx4 v2, s[36:39], s11 offen lds
    s_add_u32 m0, s45, 102400
    s_lshl_b32 s11, s78, 7
    s_add_u32 s11, s11, s43
    s_add_u32 s11, s11, 28672
    buffer_load_dwordx4 v2, s[36:39], s11 offen lds
ST_A_7:
    s_cbranch_execz ST_C_7
    s_waitcnt vmcnt(16)
    s_barrier
    s_mul_i32 s13, s77, 229376
    s_add_u32 s13, s13, s46
    s_add_u32 m0, s44, 32768
    s_add_u32 s11, s13, 0
    buffer_load_dwordx4 v8, s[48:51], s11 offen lds
    s_add_u32 m0, s44, 36864
    s_add_u32 s11, s13, 57344
    buffer_load_dwordx4 v8, s[48:51], s11 offen lds
    s_add_u32 m0, s45, 106496
    s_lshl_b32 s11, s78, 7
    s_add_u32 s11, s11, s43
    s_add_u32 s11, s11, 57344
    buffer_load_dwordx4 v2, s[36:39], s11 offen lds
    s_add_u32 m0, s45, 110592
    s_lshl_b32 s11, s78, 7
    s_add_u32 s11, s11, s43
    s_add_u32 s11, s11, 86016
    buffer_load_dwordx4 v2, s[36:39], s11 offen lds
    s_waitcnt vmcnt(17)
    s_barrier
    s_mul_i32 s13, s77, 229376
    s_add_u32 s13, s13, s46
    s_add_u32 m0, s44, 40960
    s_add_u32 s11, s13, 114688
    buffer_load_dwordx4 v8, s[48:51], s11 offen lds
    s_add_u32 m0, s44, 45056
    s_add_u32 s11, s13, 172032
    buffer_load_dwordx4 v8, s[48:51], s11 offen lds
    s_waitcnt vmcnt(14)
    s_barrier
    s_mul_i32 s13, s78, 229376
    s_add_u32 s13, s13, s46
    s_add_u32 m0, s44, 0
    s_add_u32 s11, s13, 0
    buffer_load_dwordx4 v8, s[48:51], s11 offen lds
    s_add_u32 m0, s44, 4096
    s_add_u32 s11, s13, 57344
    s_nop 0
ST_A_8:
    s_cbranch_execz ST_C_8
    buffer_load_dwordx4 v8, s[48:51], s11 offen lds
    s_mul_i32 s13, s72, 172032
    s_add_u32 s13, s13, s47
    s_add_u32 s11, s13, 0
    buffer_load_dwordx4 v[24:27], v9, s[52:55], s11 offen
    s_add_u32 s11, s13, 86016
    buffer_load_dwordx4 v[28:31], v9, s[52:55], s11 offen
    s_waitcnt vmcnt(13)
    s_barrier
    s_mul_i32 s13, s78, 229376
    s_add_u32 s13, s13, s46
    s_add_u32 m0, s44, 8192
    s_add_u32 s11, s13, 114688
    buffer_load_dwordx4 v8, s[48:51], s11 offen lds
    s_add_u32 m0, s44, 12288
    s_add_u32 s11, s13, 172032
    buffer_load_dwordx4 v8, s[48:51], s11 offen lds
    s_waitcnt vmcnt(10)
    s_barrier
    s_mul_i32 s13, s72, 229376
    s_add_u32 s13, s13, s46
    s_add_u32 s11, s13, 128
    buffer_load_dwordx4 v[32:35], v8, s[48:51], s11 offen
    s_add_u32 s11, s13, 57472
    buffer_load_dwordx4 v[36:39], v8, s[48:51], s11 offen
    s_waitcnt vmcnt(8)
    s_barrier
    s_mul_i32 s13, s73, 172032
    s_add_u32 s13, s13, s47
    s_add_u32 m0, s44, 24576
    s_add_u32 s11, s13, 0
    buffer_load_dwordx4 v9, s[52:55], s11 offen lds
    s_add_u32 m0, s44, 28672
    s_add_u32 s11, s13, 86016
    buffer_load_dwordx4 v9, s[52:55], s11 offen lds
    s_mul_i32 s13, s72, 229376
    s_add_u32 s13, s13, s46
    s_add_u32 s11, s13, 114816
ST_A_9:
    s_cbranch_execz ST_C_9
    buffer_load_dwordx4 v[40:43], v8, s[48:51], s11 offen
    s_add_u32 s11, s13, 172160
    buffer_load_dwordx4 v[44:47], v8, s[48:51], s11 offen
    s_waitcnt vmcnt(10)
    s_barrier
    s_waitcnt vmcnt(8)
    ds_write_b128 v20, v[24:27] offset:16384
    ds_write_b128 v20, v[28:31] offset:20480
    s_mul_i32 s13, s74, 172032
    s_add_u32 s13, s13, s47
    s_add_u32 m0, s44, 32768
    s_add_u32 s11, s13, 0
    buffer_load_dwordx4 v9, s[52:55], s11 offen lds
    s_add_u32 m0, s44, 36864
    s_add_u32 s11, s13, 86016
    buffer_load_dwordx4 v9, s[52:55], s11 offen lds
    s_mul_i32 s13, s75, 172032
    s_add_u32 s13, s13, s47
    s_add_u32 s11, s13, 0
    buffer_load_dwordx4 v[48:51], v9, s[52:55], s11 offen
    s_add_u32 s11, s13, 86016
    buffer_load_dwordx4 v[52:55], v9, s[52:55], s11 offen
    s_waitcnt vmcnt(10)
    s_barrier
    s_mul_i32 s13, s76, 172032
    s_add_u32 s13, s13, s47
    s_add_u32 s11, s13, 0
    buffer_load_dwordx4 v[56:59], v9, s[52:55], s11 offen
    s_add_u32 s11, s13, 86016
    buffer_load_dwordx4 v[60:63], v9, s[52:55], s11 offen
    s_mul_i32 s13, s77, 172032
    s_add_u32 s13, s13, s47
    s_add_u32 s11, s13, 0
    buffer_load_dwordx4 v[64:67], v9, s[52:55], s11 offen
    s_add_u32 s11, s13, 86016
    buffer_load_dwordx4 v[68:71], v9, s[52:55], s11 offen
    s_waitcnt lgkmcnt(0)
    s_barrier
    s_mul_i32 s13, s78, 172032
ST_A_10:
    s_cbranch_execz ST_C_10
    s_add_u32 s13, s13, s47
    s_add_u32 s11, s13, 0
    buffer_load_dwordx4 v[72:75], v9, s[52:55], s11 offen
    s_add_u32 s11, s13, 86016
    buffer_load_dwordx4 v[76:79], v9, s[52:55], s11 offen
    s_mul_i32 s13, s73, 229376
    s_add_u32 s13, s13, s46
    s_add_u32 s11, s13, 128
    buffer_load_dwordx4 v[80:83], v8, s[48:51], s11 offen
    s_add_u32 s11, s13, 57472
    buffer_load_dwordx4 v[84:87], v8, s[48:51], s11 offen
    s_waitcnt vmcnt(14)
    s_barrier
    s_waitcnt vmcnt(8)
    ds_write_b128 v20, v[48:51] offset:40960
    ds_write_b128 v20, v[52:55] offset:45056
    s_mul_i32 s13, s73, 229376
    s_add_u32 s13, s13, s46
    s_add_u32 s11, s13, 114816
    buffer_load_dwordx4 v[88:91], v8, s[48:51], s11 offen
    s_add_u32 s11, s13, 172160
    buffer_load_dwordx4 v[92:95], v8, s[48:51], s11 offen
    s_mul_i32 s13, s74, 229376
    s_add_u32 s13, s13, s46
    s_add_u32 s11, s13, 128
    buffer_load_dwordx4 v[104:107], v8, s[48:51], s11 offen
    s_add_u32 s11, s13, 57472
    buffer_load_dwordx4 v[108:111], v8, s[48:51], s11 offen
    s_barrier
    s_waitcnt vmcnt(10)
    ds_write_b128 v20, v[56:59] offset:0
    ds_write_b128 v20, v[60:63] offset:4096
    s_mul_i32 s13, s74, 229376
    s_add_u32 s13, s13, s46
    s_add_u32 s11, s13, 114816
    buffer_load_dwordx4 v[112:115], v8, s[48:51], s11 offen
    s_add_u32 s11, s13, 172160
ST_A_11:
    s_cbranch_execz ST_C_11
    buffer_load_dwordx4 v[116:119], v8, s[48:51], s11 offen
    s_mul_i32 s13, s75, 229376
    s_add_u32 s13, s13, s46
    s_add_u32 s11, s13, 128
    buffer_load_dwordx4 v[120:123], v8, s[48:51], s11 offen
    s_add_u32 s11, s13, 57472
    buffer_load_dwordx4 v[124:127], v8, s[48:51], s11 offen
    s_waitcnt lgkmcnt(0)
    s_barrier
    s_waitcnt vmcnt(12)
    ds_write_b128 v20, v[64:67] offset:8192
    ds_write_b128 v20, v[68:71] offset:12288
    s_mul_i32 s13, s75, 229376
    s_add_u32 s13, s13, s46
    s_add_u32 s11, s13, 114816
    buffer_load_dwordx4 v[128:131], v8, s[48:51], s11 offen
    s_add_u32 s11, s13, 172160
    buffer_load_dwordx4 v[132:135], v8, s[48:51], s11 offen
    s_mul_i32 s13, s76, 229376
    s_add_u32 s13, s13, s46
    s_add_u32 s11, s13, 128
    buffer_load_dwordx4 v[136:139], v8, s[48:51], s11 offen
    s_add_u32 s11, s13, 57472
    buffer_load_dwordx4 v[140:143], v8, s[48:51], s11 offen
    s_barrier
    s_waitcnt vmcnt(14)
    ds_write_b128 v20, v[72:75] offset:16384
    ds_write_b128 v20, v[76:79] offset:20480
    s_mul_i32 s13, s76, 229376
    s_add_u32 s13, s13, s46
    s_add_u32 s11, s13, 114816
    buffer_load_dwordx4 v[144:147], v8, s[48:51], s11 offen
    s_add_u32 s11, s13, 172160
    buffer_load_dwordx4 v[148:151], v8, s[48:51], s11 offen
    s_mul_i32 s13, s77, 229376
    s_add_u32 s13, s13, s46
    s_nop 0
ST_A_12:
    s_cbranch_execz ST_C_12
    s_add_u32 s11, s13, 128
    buffer_load_dwordx4 v[152:155], v8, s[48:51], s11 offen
    s_add_u32 s11, s13, 57472
    buffer_load_dwordx4 v[156:159], v8, s[48:51], s11 offen
    s_waitcnt lgkmcnt(0)
    s_barrier
    ds_write_b128 v20, v[32:35] offset:24576
    ds_write_b128 v20, v[36:39] offset:28672
    s_mul_i32 s13, s77, 229376
    s_add_u32 s13, s13, s46
    s_add_u32 s11, s13, 114816
    buffer_load_dwordx4 v[160:163], v8, s[48:51], s11 offen
    s_add_u32 s11, s13, 172160
    buffer_load_dwordx4 v[164:167], v8, s[48:51], s11 offen
    s_mul_i32 s13, s78, 229376
    s_add_u32 s13, s13, s46
    s_add_u32 s11, s13, 128
    buffer_load_dwordx4 v[168:171], v8, s[48:51], s11 offen
    s_add_u32 s11, s13, 57472
    buffer_load_dwordx4 v[172:175], v8, s[48:51], s11 offen
    s_barrier
    ds_write_b128 v20, v[40:43] offset:32768
    ds_write_b128 v20, v[44:47] offset:36864
    s_mul_i32 s13, s78, 229376
    s_add_u32 s13, s13, s46
    s_add_u32 s11, s13, 114816
    buffer_load_dwordx4 v[176:179], v8, s[48:51], s11 offen
    s_add_u32 s11, s13, 172160
    buffer_load_dwordx4 v[180:183], v8, s[48:51], s11 offen
    s_lshl2_add_u32 s8, s2, s40
    s_min_u32 s8, s8, 1007
    s_mul_i32 s9, s8, 9363
    s_lshr_b32 s9, s9, 16
    s_mul_i32 s10, s9, 7
    s_sub_u32 s8, s8, s10
    s_mul_i32 s80, s8, 294912
    s_lshl_b32 s10, s9, 10
ST_A_13:
    s_cbranch_execz ST_C_13
    s_add_u32 s80, s80, s10
    s_add_u32 s80, s80, 25165824
    s_add_u32 s81, s80, 147456
    s_lshl_b32 s8, s8, 7
    s_mul_i32 s10, s9, 14336
    s_sub_u32 s11, s9, 112
    s_lshr_b32 s12, s11, 1
    s_mul_i32 s12, s12, 3584
    s_mul_i32 s11, s11, 14336
    s_sub_u32 s11, s11, s12
    s_mov_b32 s86, 1605632
    s_mov_b32 s87, 0x00020000
    s_cmp_lt_u32 s9, 112
    s_cselect_b32 s10, s10, s11
    s_cselect_b32 s86, s86, 401408
    s_cselect_b32 s84, s28, s20
    s_cselect_b32 s85, s29, s21
    s_add_u32 s8, s8, s10
    s_add_u32 s9, s8, 7168
    v_mul_u32_u24 v21, 896, v3
    v_lshl_add_u32 v21, v5, 4, v21
    buffer_load_dwordx4 v[248:251], v21, s[84:87], s8 offen
    buffer_load_dwordx4 v[252:255], v21, s[84:87], s9 offen
    s_lshl_b32 s8, s40, 11
    s_add_u32 s8, s8, 155648
    v_lshl_add_u32 v22, v1, 4, s8
    v_lshrrev_b32 v14, 5, v1
    v_bfe_u32 v15, v1, 2, 2
    v_lshl_add_u32 v14, v14, 2, v15
    v_bfe_u32 v15, v1, 4, 1
    v_lshlrev_b32 v15, 5, v15
    v_lshl_add_u32 v14, v14, 7, v15
    v_and_b32 v15, 3, v1
    v_lshl_add_u32 v14, v15, 3, v14
    v_add_u32 v23, s8, v14
    v_lshlrev_b32 v14, 4, v1
    s_waitcnt lgkmcnt(0)
    s_barrier
    s_waitcnt vmcnt(24)
    ds_write_b128 v20, v[80:83] offset:40960
ST_A_14:
    s_cbranch_execz ST_C_14
    ds_write_b128 v20, v[84:87] offset:45056
    s_barrier
    s_waitcnt vmcnt(22)
    ds_write_b128 v20, v[88:91] offset:0
    ds_write_b128 v20, v[92:95] offset:4096
    s_waitcnt lgkmcnt(0)
    s_barrier
    s_waitcnt vmcnt(20)
    ds_write_b128 v20, v[104:107] offset:8192
    ds_write_b128 v20, v[108:111] offset:12288
    s_barrier
    s_waitcnt vmcnt(18)
    ds_write_b128 v20, v[112:115] offset:16384
    ds_write_b128 v20, v[116:119] offset:20480
    s_waitcnt lgkmcnt(0)
    s_barrier
    s_waitcnt vmcnt(16)
    ds_write_b128 v20, v[120:123] offset:24576
    ds_write_b128 v20, v[124:127] offset:28672
    s_barrier
    s_waitcnt vmcnt(14)
    ds_write_b128 v20, v[128:131] offset:32768
    ds_write_b128 v20, v[132:135] offset:36864
    s_waitcnt lgkmcnt(0)
    s_barrier
    s_waitcnt vmcnt(12)
    ds_write_b128 v20, v[136:139] offset:40960
    ds_write_b128 v20, v[140:143] offset:45056
    s_barrier
    s_waitcnt vmcnt(10)
    ds_write_b128 v20, v[144:147] offset:0
    ds_write_b128 v20, v[148:151] offset:4096
    s_waitcnt lgkmcnt(0)
    s_barrier
    s_waitcnt vmcnt(8)
    ds_write_b128 v20, v[152:155] offset:8192
    ds_write_b128 v20, v[156:159] offset:12288
    s_barrier
    s_waitcnt vmcnt(6)
    ds_write_b128 v20, v[160:163] offset:16384
    ds_write_b128 v20, v[164:167] offset:20480
    v_mov_b32 v16, -1
    v_mov_b32 v17, -1
    v_mov_b32 v18, -1
ST_A_15:
    s_cbranch_execz ST_C_15
    v_mov_b32 v19, -1
    v_lshlrev_b32 v12, 4, v1
    s_lshr_b32 s9, s2, 2
    s_mul_i32 s9, s9, 147456
    s_and_b32 s11, s2, 3
    s_lshl_b32 s11, s11, 2
    s_add_u32 s11, s11, s40
    s_lshl_b32 s11, s11, 11
    s_add_u32 s11, s11, s9
    s_add_u32 s11, s11, 8503296
    buffer_store_dwordx4 v[16:19], v12, s[32:35], s11 offen sc1
    buffer_store_dwordx4 v[16:19], v12, s[32:35], s11 offen offset:1024 sc1
    s_waitcnt lgkmcnt(0)
    s_barrier
    s_waitcnt vmcnt(6)
    ds_write_b128 v20, v[168:171] offset:24576
    ds_write_b128 v20, v[172:175] offset:28672
    s_waitcnt vmcnt(2)
    ds_write_b128 v22, v[248:251] offset:0
    ds_write_b128 v22, v[252:255] offset:1024
    s_barrier
    ds_write_b128 v20, v[176:179] offset:32768
    ds_write_b128 v20, v[180:183] offset:36864
    s_waitcnt lgkmcnt(0)
    ds_read_b64_tr_b16 v[248:249], v23 offset:0
    ds_read_b64_tr_b16 v[250:251], v23 offset:1024
    ds_read_b64_tr_b16 v[252:253], v23 offset:64
    ds_read_b64_tr_b16 v[254:255], v23 offset:1088
    s_waitcnt lgkmcnt(0)
    s_barrier
    s_waitcnt lgkmcnt(0)
    buffer_store_dwordx4 v[248:251], v14, s[32:35], s80 offen sc1
    buffer_store_dwordx4 v[252:255], v14, s[32:35], s81 offen sc1
    s_barrier
    s_endpgm
K1_CONS:
    s_mov_b64 exec, -1
    s_and_b32 s4, s6, 1
    s_lshl_b32 s4, s4, 3
    s_lshr_b32 s6, s6, 1
    s_mul_i32 s8, s6, 28
    s_add_u32 s8, s8, s7
    s_sub_u32 s8, s8, 4
    s_lshr_b32 s5, s8, 3
    s_and_b32 s8, s8, 7
    s_and_b32 s9, s7, 1
    s_add_u32 s9, s9, 14
    s_lshr_b32 s10, s7, 1
ST_A_16:
    s_cbranch_execz ST_C_16
    s_lshl_b32 s6, s6, 1
    s_add_u32 s10, s10, s6
    s_cmp_lt_u32 s7, 4
    s_cselect_b32 s5, s9, s5
    s_cselect_b32 s8, s10, s8
    s_add_u32 s4, s4, s8
    s_lshr_b32 s40, s3, 1
    s_and_b32 s41, s3, 1
    s_mov_b32 s10, 0
    s_waitcnt lgkmcnt(0)
    v_and_b32 v3, 31, v1
    v_lshrrev_b32 v4, 5, v1
    s_lshl_b32 s8, s40, 6
    v_add_u32 v5, s8, v3
    v_lshrrev_b32 v6, 1, v5
    v_and_b32 v6, 7, v6
    v_lshlrev_b32 v5, 7, v5
    v_add_u32 v7, 0, v4
    v_xor_b32 v7, v7, v6
    v_lshl_add_u32 v192, v7, 4, v5
    v_add_u32 v196, 0x10000, v192
    v_add_u32 v7, 2, v4
    v_xor_b32 v7, v7, v6
    v_lshl_add_u32 v193, v7, 4, v5
    v_add_u32 v197, 0x10000, v193
    v_add_u32 v7, 4, v4
    v_xor_b32 v7, v7, v6
    v_lshl_add_u32 v194, v7, 4, v5
    v_add_u32 v198, 0x10000, v194
    v_add_u32 v7, 6, v4
    v_xor_b32 v7, v7, v6
    v_lshl_add_u32 v195, v7, 4, v5
    v_add_u32 v199, 0x10000, v195
    v_lshrrev_b32 v5, 2, v1
    v_and_b32 v5, 3, v5
    v_lshrrev_b32 v6, 4, v1
    v_and_b32 v6, 1, v6
    v_and_b32 v7, 3, v1
    v_lshlrev_b32 v7, 3, v7
    v_lshl_add_u32 v8, v4, 3, v5
    v_lshlrev_b32 v8, 7, v8
    v_add_u32 v8, 114688, v8
    v_lshrrev_b32 v9, 1, v5
    v_lshl_add_u32 v10, v6, 5, v7
    v_lshlrev_b32 v11, 6, v9
    s_lshl_b32 s8, s41, 6
    v_add_u32 v12, s8, v10
    v_xor_b32 v12, v12, v11
    v_add_u32 v203, v12, v8
    v_lshrrev_b32 v12, 1, v1
    v_xor_b32 v12, v12, v1
    v_and_b32 v12, 1, v12
ST_A_17:
    s_cbranch_execz ST_C_17
    v_mul_u32_u24 v12, 24, v12
    v_xor_b32 v202, v203, v12
    v_lshl_add_u32 v12, v4, 2, v5
    v_lshl_add_u32 v12, v12, 7, v10
    s_add_u32 s8, s10, 98304
    v_add_u32 v229, s8, v12
    v_add_u32 v8, v8, v7
    v_lshlrev_b32 v228, 4, v1
    s_lshl_b32 s42, s4, 2
    s_lshl_b32 s8, s40, 1
    s_add_u32 s42, s42, s8
    s_mov_b32 s55, 0xbfb8aa3b
    s_mov_b32 s48, 1.0
    s_mov_b32 s34, 29360128
    s_mov_b32 s35, 0x00020000
    s_mov_b32 s46, 0
    s_mov_b32 s47, -1
    s_lshl_b32 s8, s5, 1
    s_add_u32 s8, s8, s41
    s_mul_i32 s50, s42, 57344
    s_lshl_b32 s9, s8, 11
    s_add_u32 s50, s50, s9
    s_add_u32 s51, s50, 57344
    s_cmp_lt_u32 s8, 14
    s_cselect_b32 s54, 0x3e8b97f6, 1.0
    s_cmp_ge_u32 s5, 14
    s_cbranch_scc1 K1_CV
    v_lshl_or_b32 v10, v6, 1, v9
    s_lshl_b32 s8, s41, 1
    v_xor_b32 v10, s8, v10
    v_lshl_add_u32 v11, v6, 11, v8
    v_lshl_add_u32 v200, v10, 5, v11
    v_xor_b32 v201, 32, v200
    s_mul_i32 s56, s42, 147456
    s_lshl_b32 s8, s5, 3
    s_lshl_b32 s9, s41, 1
    s_add_u32 s8, s8, s9
    s_lshl_b32 s8, s8, 10
    s_add_u32 s56, s56, s8
    s_add_u32 s56, s56, 8388608
    s_add_u32 s57, s56, 147456
    s_add_u32 s58, s56, 4096
    s_add_u32 s59, s57, 4096
    s_barrier
    ds_read_b128 v[144:147], v192 offset:0
ST_A_18:
    s_cbranch_execz ST_C_18
    ds_read_b64_tr_b16 v[148:149], v200 offset:0
    ds_read_b64_tr_b16 v[150:151], v200 offset:512
    ds_read_b128 v[152:155], v192 offset:4096
    ds_read_b64_tr_b16 v[156:157], v201 offset:0
    ds_read_b64_tr_b16 v[158:159], v201 offset:512
    ds_read_b128 v[160:163], v193 offset:0
    ds_read_b64_tr_b16 v[164:165], v200 offset:4096
    ds_read_b64_tr_b16 v[166:167], v200 offset:4608
    ds_read_b128 v[168:171], v193 offset:4096
    ds_read_b64_tr_b16 v[172:173], v201 offset:4096
    ds_read_b64_tr_b16 v[174:175], v201 offset:4608
    s_barrier
    ds_read_b128 v[176:179], v194 offset:0
    ds_read_b64_tr_b16 v[180:181], v200 offset:8192
    ds_read_b64_tr_b16 v[182:183], v200 offset:8704
    s_waitcnt lgkmcnt(12)
    v_mfma_f32_32x32x16_bf16 v[16:31], v[148:151], v[144:147], 0
    ds_read_b128 v[184:187], v194 offset:4096
    ds_read_b64_tr_b16 v[188:189], v201 offset:8192
    ds_read_b64_tr_b16 v[190:191], v201 offset:8704
    s_waitcnt lgkmcnt(14)
    v_mfma_f32_32x32x16_bf16 v[32:47], v[148:151], v[152:155], 0
    ds_read_b128 v[240:243], v195 offset:0
    s_waitcnt lgkmcnt(13)
    v_mfma_f32_32x32x16_bf16 v[48:63], v[156:159], v[144:147], 0
    ds_read_b64_tr_b16 v[244:245], v200 offset:12288
    ds_read_b64_tr_b16 v[246:247], v200 offset:12800
    v_mfma_f32_32x32x16_bf16 v[64:79], v[156:159], v[152:155], 0
    s_waitcnt lgkmcnt(12)
    v_mfma_f32_32x32x16_bf16 v[16:31], v[164:167], v[160:163], v[16:31]
    ds_read_b128 v[248:251], v195 offset:4096
    ds_read_b64_tr_b16 v[252:253], v201 offset:12288
    ds_read_b64_tr_b16 v[254:255], v201 offset:12800
    s_waitcnt lgkmcnt(14)
    s_nop 0
ST_A_19:
    s_cbranch_execz ST_C_19
    v_mfma_f32_32x32x16_bf16 v[32:47], v[164:167], v[168:171], v[32:47]
    s_waitcnt lgkmcnt(12)
    s_barrier
    ds_read_b128 v[148:151], v192 offset:16384
    ds_read_b64_tr_b16 v[144:145], v200 offset:16384
    ds_read_b64_tr_b16 v[146:147], v200 offset:16896
    v_mfma_f32_32x32x16_bf16 v[48:63], v[172:175], v[160:163], v[48:63]
    v_mfma_f32_32x32x16_bf16 v[64:79], v[172:175], v[168:171], v[64:79]
    s_waitcnt lgkmcnt(12)
    v_mfma_f32_32x32x16_bf16 v[16:31], v[180:183], v[176:179], v[16:31]
    ds_read_b128 v[152:155], v192 offset:20480
    ds_read_b64_tr_b16 v[156:157], v201 offset:16384
    ds_read_b64_tr_b16 v[158:159], v201 offset:16896
    s_waitcnt lgkmcnt(14)
    v_mfma_f32_32x32x16_bf16 v[32:47], v[180:183], v[184:187], v[32:47]
    ds_read_b128 v[164:167], v193 offset:16384
    s_waitcnt lgkmcnt(13)
    v_mfma_f32_32x32x16_bf16 v[48:63], v[188:191], v[176:179], v[48:63]
    ds_read_b64_tr_b16 v[160:161], v200 offset:20480
    ds_read_b64_tr_b16 v[162:163], v200 offset:20992
    v_mfma_f32_32x32x16_bf16 v[64:79], v[188:191], v[184:187], v[64:79]
    s_waitcnt lgkmcnt(12)
    v_mfma_f32_32x32x16_bf16 v[16:31], v[244:247], v[240:243], v[16:31]
    ds_read_b128 v[168:171], v193 offset:20480
    ds_read_b64_tr_b16 v[172:173], v201 offset:20480
    ds_read_b64_tr_b16 v[174:175], v201 offset:20992
    s_waitcnt lgkmcnt(14)
    v_mfma_f32_32x32x16_bf16 v[32:47], v[244:247], v[248:251], v[32:47]
    s_waitcnt lgkmcnt(12)
    s_barrier
    ds_read_b128 v[180:183], v194 offset:16384
    ds_read_b64_tr_b16 v[176:177], v200 offset:24576
    ds_read_b64_tr_b16 v[178:179], v200 offset:25088
    v_mfma_f32_32x32x16_bf16 v[48:63], v[252:255], v[240:243], v[48:63]
    v_mfma_f32_32x32x16_bf16 v[64:79], v[252:255], v[248:251], v[64:79]
    s_waitcnt lgkmcnt(12)
    s_nop 0
ST_A_20:
    s_cbranch_execz ST_C_20
    v_mfma_f32_32x32x16_bf16 v[16:31], v[144:147], v[148:151], v[16:31]
    ds_read_b128 v[184:187], v194 offset:20480
    ds_read_b64_tr_b16 v[188:189], v201 offset:24576
    ds_read_b64_tr_b16 v[190:191], v201 offset:25088
    s_waitcnt lgkmcnt(14)
    v_mfma_f32_32x32x16_bf16 v[32:47], v[144:147], v[152:155], v[32:47]
    ds_read_b128 v[244:247], v195 offset:16384
    s_waitcnt lgkmcnt(13)
    v_mfma_f32_32x32x16_bf16 v[48:63], v[156:159], v[148:151], v[48:63]
    ds_read_b64_tr_b16 v[240:241], v200 offset:28672
    ds_read_b64_tr_b16 v[242:243], v200 offset:29184
    v_mfma_f32_32x32x16_bf16 v[64:79], v[156:159], v[152:155], v[64:79]
    s_waitcnt lgkmcnt(12)
    v_mfma_f32_32x32x16_bf16 v[16:31], v[160:163], v[164:167], v[16:31]
    ds_read_b128 v[248:251], v195 offset:20480
    ds_read_b64_tr_b16 v[252:253], v201 offset:28672
    ds_read_b64_tr_b16 v[254:255], v201 offset:29184
    s_waitcnt lgkmcnt(14)
    v_mfma_f32_32x32x16_bf16 v[32:47], v[160:163], v[168:171], v[32:47]
    s_waitcnt lgkmcnt(12)
    s_barrier
    ds_read_b128 v[144:147], v192 offset:32768
    ds_read_b64_tr_b16 v[148:149], v200 offset:32768
    ds_read_b64_tr_b16 v[150:151], v200 offset:33280
    v_mfma_f32_32x32x16_bf16 v[48:63], v[172:175], v[164:167], v[48:63]
    v_mfma_f32_32x32x16_bf16 v[64:79], v[172:175], v[168:171], v[64:79]
    s_waitcnt lgkmcnt(12)
    v_mfma_f32_32x32x16_bf16 v[16:31], v[176:179], v[180:183], v[16:31]
    ds_read_b128 v[152:155], v192 offset:36864
    ds_read_b64_tr_b16 v[156:157], v201 offset:32768
    ds_read_b64_tr_b16 v[158:159], v201 offset:33280
    s_waitcnt lgkmcnt(14)
    v_mfma_f32_32x32x16_bf16 v[32:47], v[176:179], v[184:187], v[32:47]
    ds_read_b128 v[160:163], v193 offset:32768
    s_waitcnt lgkmcnt(13)
    v_mfma_f32_32x32x16_bf16 v[48:63], v[188:191], v[180:183], v[48:63]
ST_A_21:
    s_cbranch_execz ST_C_21
    ds_read_b64_tr_b16 v[164:165], v200 offset:36864
    ds_read_b64_tr_b16 v[166:167], v200 offset:37376
    v_mfma_f32_32x32x16_bf16 v[64:79], v[188:191], v[184:187], v[64:79]
    s_waitcnt lgkmcnt(12)
    v_mfma_f32_32x32x16_bf16 v[16:31], v[240:243], v[244:247], v[16:31]
    ds_read_b128 v[168:171], v193 offset:36864
    ds_read_b64_tr_b16 v[172:173], v201 offset:36864
    ds_read_b64_tr_b16 v[174:175], v201 offset:37376
    s_waitcnt lgkmcnt(14)
    v_mfma_f32_32x32x16_bf16 v[32:47], v[240:243], v[248:251], v[32:47]
    s_waitcnt lgkmcnt(12)
    s_barrier
    ds_read_b128 v[176:179], v194 offset:32768
    ds_read_b64_tr_b16 v[180:181], v200 offset:40960
    ds_read_b64_tr_b16 v[182:183], v200 offset:41472
    v_mfma_f32_32x32x16_bf16 v[48:63], v[252:255], v[244:247], v[48:63]
    v_mfma_f32_32x32x16_bf16 v[64:79], v[252:255], v[248:251], v[64:79]
    s_waitcnt lgkmcnt(12)
    v_mfma_f32_32x32x16_bf16 v[16:31], v[148:151], v[144:147], v[16:31]
    ds_read_b128 v[184:187], v194 offset:36864
    ds_read_b64_tr_b16 v[188:189], v201 offset:40960
    ds_read_b64_tr_b16 v[190:191], v201 offset:41472
    s_waitcnt lgkmcnt(14)
    v_mfma_f32_32x32x16_bf16 v[32:47], v[148:151], v[152:155], v[32:47]
    ds_read_b128 v[240:243], v195 offset:32768
    s_waitcnt lgkmcnt(13)
    v_mfma_f32_32x32x16_bf16 v[48:63], v[156:159], v[144:147], v[48:63]
    ds_read_b64_tr_b16 v[244:245], v200 offset:45056
    ds_read_b64_tr_b16 v[246:247], v200 offset:45568
    v_mfma_f32_32x32x16_bf16 v[64:79], v[156:159], v[152:155], v[64:79]
    s_waitcnt lgkmcnt(12)
    v_mfma_f32_32x32x16_bf16 v[16:31], v[164:167], v[160:163], v[16:31]
    ds_read_b128 v[248:251], v195 offset:36864
    ds_read_b64_tr_b16 v[252:253], v201 offset:45056
    ds_read_b64_tr_b16 v[254:255], v201 offset:45568
    s_waitcnt lgkmcnt(14)
ST_A_22:
    s_cbranch_execz ST_C_22
    v_mfma_f32_32x32x16_bf16 v[32:47], v[164:167], v[168:171], v[32:47]
    s_waitcnt lgkmcnt(12)
    s_barrier
    ds_read_b128 v[148:151], v192 offset:49152
    ds_read_b64_tr_b16 v[144:145], v200 offset:0
    ds_read_b64_tr_b16 v[146:147], v200 offset:512
    v_mfma_f32_32x32x16_bf16 v[48:63], v[172:175], v[160:163], v[48:63]
    v_mfma_f32_32x32x16_bf16 v[64:79], v[172:175], v[168:171], v[64:79]
    s_waitcnt lgkmcnt(12)
    v_mfma_f32_32x32x16_bf16 v[16:31], v[180:183], v[176:179], v[16:31]
    ds_read_b128 v[152:155], v192 offset:53248
    ds_read_b64_tr_b16 v[156:157], v201 offset:0
    ds_read_b64_tr_b16 v[158:159], v201 offset:512
    s_waitcnt lgkmcnt(14)
    v_mfma_f32_32x32x16_bf16 v[32:47], v[180:183], v[184:187], v[32:47]
    ds_read_b128 v[164:167], v193 offset:49152
    s_waitcnt lgkmcnt(13)
    v_mfma_f32_32x32x16_bf16 v[48:63], v[188:191], v[176:179], v[48:63]
    ds_read_b64_tr_b16 v[160:161], v200 offset:4096
    ds_read_b64_tr_b16 v[162:163], v200 offset:4608
    v_mfma_f32_32x32x16_bf16 v[64:79], v[188:191], v[184:187], v[64:79]
    s_waitcnt lgkmcnt(12)
    v_mfma_f32_32x32x16_bf16 v[16:31], v[244:247], v[240:243], v[16:31]
    ds_read_b128 v[168:171], v193 offset:53248
    ds_read_b64_tr_b16 v[172:173], v201 offset:4096
    ds_read_b64_tr_b16 v[174:175], v201 offset:4608
    s_waitcnt lgkmcnt(14)
    v_mfma_f32_32x32x16_bf16 v[32:47], v[244:247], v[248:251], v[32:47]
    s_waitcnt lgkmcnt(12)
    s_barrier
    ds_read_b128 v[180:183], v194 offset:49152
    ds_read_b64_tr_b16 v[176:177], v200 offset:8192
    ds_read_b64_tr_b16 v[178:179], v200 offset:8704
    v_mfma_f32_32x32x16_bf16 v[48:63], v[252:255], v[240:243], v[48:63]
    v_mfma_f32_32x32x16_bf16 v[64:79], v[252:255], v[248:251], v[64:79]
    s_waitcnt lgkmcnt(12)
    s_nop 0
ST_A_23:
    s_cbranch_execz ST_C_23
    v_mfma_f32_32x32x16_bf16 v[16:31], v[144:147], v[148:151], v[16:31]
    ds_read_b128 v[184:187], v194 offset:53248
    ds_read_b64_tr_b16 v[188:189], v201 offset:8192
    ds_read_b64_tr_b16 v[190:191], v201 offset:8704
    s_waitcnt lgkmcnt(14)
    v_mfma_f32_32x32x16_bf16 v[32:47], v[144:147], v[152:155], v[32:47]
    ds_read_b128 v[244:247], v195 offset:49152
    s_waitcnt lgkmcnt(13)
    v_mfma_f32_32x32x16_bf16 v[48:63], v[156:159], v[148:151], v[48:63]
    ds_read_b64_tr_b16 v[240:241], v200 offset:12288
    ds_read_b64_tr_b16 v[242:243], v200 offset:12800
    v_mfma_f32_32x32x16_bf16 v[64:79], v[156:159], v[152:155], v[64:79]
    s_waitcnt lgkmcnt(12)
    v_mfma_f32_32x32x16_bf16 v[16:31], v[160:163], v[164:167], v[16:31]
    ds_read_b128 v[248:251], v195 offset:53248
    ds_read_b64_tr_b16 v[252:253], v201 offset:12288
    ds_read_b64_tr_b16 v[254:255], v201 offset:12800
    s_waitcnt lgkmcnt(14)
    v_mfma_f32_32x32x16_bf16 v[32:47], v[160:163], v[168:171], v[32:47]
    s_waitcnt lgkmcnt(12)
    s_barrier
    ds_read_b128 v[144:147], v196 offset:0
    ds_read_b64_tr_b16 v[148:149], v200 offset:16384
    ds_read_b64_tr_b16 v[150:151], v200 offset:16896
    v_mfma_f32_32x32x16_bf16 v[48:63], v[172:175], v[164:167], v[48:63]
    v_mfma_f32_32x32x16_bf16 v[64:79], v[172:175], v[168:171], v[64:79]
    s_waitcnt lgkmcnt(12)
    v_mfma_f32_32x32x16_bf16 v[16:31], v[176:179], v[180:183], v[16:31]
    ds_read_b128 v[152:155], v196 offset:4096
    ds_read_b64_tr_b16 v[156:157], v201 offset:16384
    ds_read_b64_tr_b16 v[158:159], v201 offset:16896
    s_waitcnt lgkmcnt(14)
    v_mfma_f32_32x32x16_bf16 v[32:47], v[176:179], v[184:187], v[32:47]
    ds_read_b128 v[160:163], v197 offset:0
    s_waitcnt lgkmcnt(13)
    v_mfma_f32_32x32x16_bf16 v[48:63], v[188:191], v[180:183], v[48:63]
ST_A_24:
    s_cbranch_execz ST_C_24
    ds_read_b64_tr_b16 v[164:165], v200 offset:20480
    ds_read_b64_tr_b16 v[166:167], v200 offset:20992
    v_mfma_f32_32x32x16_bf16 v[64:79], v[188:191], v[184:187], v[64:79]
    s_waitcnt lgkmcnt(12)
    v_mfma_f32_32x32x16_bf16 v[16:31], v[240:243], v[244:247], v[16:31]
    ds_read_b128 v[168:171], v197 offset:4096
    ds_read_b64_tr_b16 v[172:173], v201 offset:20480
    ds_read_b64_tr_b16 v[174:175], v201 offset:20992
    s_waitcnt lgkmcnt(14)
    v_mfma_f32_32x32x16_bf16 v[32:47], v[240:243], v[248:251], v[32:47]
    s_waitcnt lgkmcnt(12)
    s_barrier
    ds_read_b128 v[176:179], v198 offset:0
    ds_read_b64_tr_b16 v[180:181], v200 offset:24576
    ds_read_b64_tr_b16 v[182:183], v200 offset:25088
    v_mfma_f32_32x32x16_bf16 v[48:63], v[252:255], v[244:247], v[48:63]
    v_mfma_f32_32x32x16_bf16 v[64:79], v[252:255], v[248:251], v[64:79]
    s_waitcnt lgkmcnt(12)
    v_mfma_f32_32x32x16_bf16 v[16:31], v[148:151], v[144:147], v[16:31]
    ds_read_b128 v[184:187], v198 offset:4096
    ds_read_b64_tr_b16 v[188:189], v201 offset:24576
    ds_read_b64_tr_b16 v[190:191], v201 offset:25088
    s_waitcnt lgkmcnt(14)
    v_mfma_f32_32x32x16_bf16 v[32:47], v[148:151], v[152:155], v[32:47]
    ds_read_b128 v[240:243], v199 offset:0
    s_waitcnt lgkmcnt(13)
    v_mfma_f32_32x32x16_bf16 v[48:63], v[156:159], v[144:147], v[48:63]
    ds_read_b64_tr_b16 v[244:245], v200 offset:28672
    ds_read_b64_tr_b16 v[246:247], v200 offset:29184
    v_mfma_f32_32x32x16_bf16 v[64:79], v[156:159], v[152:155], v[64:79]
    s_waitcnt lgkmcnt(12)
    v_mfma_f32_32x32x16_bf16 v[16:31], v[164:167], v[160:163], v[16:31]
    ds_read_b128 v[248:251], v199 offset:4096
    ds_read_b64_tr_b16 v[252:253], v201 offset:28672
    ds_read_b64_tr_b16 v[254:255], v201 offset:29184
    s_waitcnt lgkmcnt(14)
ST_A_25:
    s_cbranch_execz ST_C_25
    v_mfma_f32_32x32x16_bf16 v[32:47], v[164:167], v[168:171], v[32:47]
    s_waitcnt lgkmcnt(12)
    s_barrier
    ds_read_b128 v[148:151], v196 offset:16384
    ds_read_b64_tr_b16 v[144:145], v200 offset:32768
    ds_read_b64_tr_b16 v[146:147], v200 offset:33280
    v_mfma_f32_32x32x16_bf16 v[48:63], v[172:175], v[160:163], v[48:63]
    v_mfma_f32_32x32x16_bf16 v[64:79], v[172:175], v[168:171], v[64:79]
    s_waitcnt lgkmcnt(12)
    v_mfma_f32_32x32x16_bf16 v[16:31], v[180:183], v[176:179], v[16:31]
    ds_read_b128 v[152:155], v196 offset:20480
    ds_read_b64_tr_b16 v[156:157], v201 offset:32768
    ds_read_b64_tr_b16 v[158:159], v201 offset:33280
    s_waitcnt lgkmcnt(14)
    v_mfma_f32_32x32x16_bf16 v[32:47], v[180:183], v[184:187], v[32:47]
    ds_read_b128 v[164:167], v197 offset:16384
    s_waitcnt lgkmcnt(13)
    v_mfma_f32_32x32x16_bf16 v[48:63], v[188:191], v[176:179], v[48:63]
    ds_read_b64_tr_b16 v[160:161], v200 offset:36864
    ds_read_b64_tr_b16 v[162:163], v200 offset:37376
    v_mfma_f32_32x32x16_bf16 v[64:79], v[188:191], v[184:187], v[64:79]
    s_waitcnt lgkmcnt(12)
    v_mfma_f32_32x32x16_bf16 v[16:31], v[244:247], v[240:243], v[16:31]
    ds_read_b128 v[168:171], v197 offset:20480
    ds_read_b64_tr_b16 v[172:173], v201 offset:36864
    ds_read_b64_tr_b16 v[174:175], v201 offset:37376
    s_waitcnt lgkmcnt(14)
    v_mfma_f32_32x32x16_bf16 v[32:47], v[244:247], v[248:251], v[32:47]
    s_waitcnt lgkmcnt(12)
    s_barrier
    ds_read_b128 v[180:183], v198 offset:16384
    ds_read_b64_tr_b16 v[176:177], v200 offset:40960
    ds_read_b64_tr_b16 v[178:179], v200 offset:41472
    v_mfma_f32_32x32x16_bf16 v[48:63], v[252:255], v[240:243], v[48:63]
    v_mfma_f32_32x32x16_bf16 v[64:79], v[252:255], v[248:251], v[64:79]
    s_waitcnt lgkmcnt(12)
    s_nop 0
ST_A_26:
    s_cbranch_execz ST_C_26
    v_mfma_f32_32x32x16_bf16 v[16:31], v[144:147], v[148:151], v[16:31]
    ds_read_b128 v[184:187], v198 offset:20480
    ds_read_b64_tr_b16 v[188:189], v201 offset:40960
    ds_read_b64_tr_b16 v[190:191], v201 offset:41472
    s_waitcnt lgkmcnt(14)
    v_mfma_f32_32x32x16_bf16 v[32:47], v[144:147], v[152:155], v[32:47]
    ds_read_b128 v[244:247], v199 offset:16384
    s_waitcnt lgkmcnt(13)
    v_mfma_f32_32x32x16_bf16 v[48:63], v[156:159], v[148:151], v[48:63]
    ds_read_b64_tr_b16 v[240:241], v200 offset:45056
    ds_read_b64_tr_b16 v[242:243], v200 offset:45568
    v_mfma_f32_32x32x16_bf16 v[64:79], v[156:159], v[152:155], v[64:79]
    s_waitcnt lgkmcnt(12)
    v_mfma_f32_32x32x16_bf16 v[16:31], v[160:163], v[164:167], v[16:31]
    ds_read_b128 v[248:251], v199 offset:20480
    ds_read_b64_tr_b16 v[252:253], v201 offset:45056
    ds_read_b64_tr_b16 v[254:255], v201 offset:45568
    s_waitcnt lgkmcnt(14)
    v_mfma_f32_32x32x16_bf16 v[32:47], v[160:163], v[168:171], v[32:47]
    s_waitcnt lgkmcnt(12)
    s_barrier
    ds_read_b128 v[144:147], v196 offset:32768
    ds_read_b64_tr_b16 v[148:149], v200 offset:0
    ds_read_b64_tr_b16 v[150:151], v200 offset:512
    v_mfma_f32_32x32x16_bf16 v[48:63], v[172:175], v[164:167], v[48:63]
    v_mfma_f32_32x32x16_bf16 v[64:79], v[172:175], v[168:171], v[64:79]
    s_waitcnt lgkmcnt(12)
    v_mfma_f32_32x32x16_bf16 v[16:31], v[176:179], v[180:183], v[16:31]
    ds_read_b128 v[152:155], v196 offset:36864
    ds_read_b64_tr_b16 v[156:157], v201 offset:0
    ds_read_b64_tr_b16 v[158:159], v201 offset:512
    s_waitcnt lgkmcnt(14)
    v_mfma_f32_32x32x16_bf16 v[32:47], v[176:179], v[184:187], v[32:47]
    ds_read_b128 v[160:163], v197 offset:32768
    s_waitcnt lgkmcnt(13)
    v_mfma_f32_32x32x16_bf16 v[48:63], v[188:191], v[180:183], v[48:63]
ST_A_27:
    s_cbranch_execz ST_C_27
    ds_read_b64_tr_b16 v[164:165], v200 offset:4096
    ds_read_b64_tr_b16 v[166:167], v200 offset:4608
    v_mfma_f32_32x32x16_bf16 v[64:79], v[188:191], v[184:187], v[64:79]
    s_waitcnt lgkmcnt(12)
    v_mfma_f32_32x32x16_bf16 v[16:31], v[240:243], v[244:247], v[16:31]
    ds_read_b128 v[168:171], v197 offset:36864
    ds_read_b64_tr_b16 v[172:173], v201 offset:4096
    ds_read_b64_tr_b16 v[174:175], v201 offset:4608
    s_waitcnt lgkmcnt(14)
    v_mfma_f32_32x32x16_bf16 v[32:47], v[240:243], v[248:251], v[32:47]
    s_waitcnt lgkmcnt(12)
    s_barrier
    ds_read_b128 v[176:179], v198 offset:32768
    ds_read_b64_tr_b16 v[180:181], v200 offset:8192
    ds_read_b64_tr_b16 v[182:183], v200 offset:8704
    v_mfma_f32_32x32x16_bf16 v[48:63], v[252:255], v[244:247], v[48:63]
    v_mfma_f32_32x32x16_bf16 v[64:79], v[252:255], v[248:251], v[64:79]
    s_waitcnt lgkmcnt(12)
    v_mfma_f32_32x32x16_bf16 v[16:31], v[148:151], v[144:147], v[16:31]
    ds_read_b128 v[184:187], v198 offset:36864
    ds_read_b64_tr_b16 v[188:189], v201 offset:8192
    ds_read_b64_tr_b16 v[190:191], v201 offset:8704
    s_waitcnt lgkmcnt(14)
    v_mfma_f32_32x32x16_bf16 v[32:47], v[148:151], v[152:155], v[32:47]
    ds_read_b128 v[240:243], v199 offset:32768
    s_waitcnt lgkmcnt(13)
    v_mfma_f32_32x32x16_bf16 v[48:63], v[156:159], v[144:147], v[48:63]
    ds_read_b64_tr_b16 v[244:245], v200 offset:12288
    ds_read_b64_tr_b16 v[246:247], v200 offset:12800
    v_mfma_f32_32x32x16_bf16 v[64:79], v[156:159], v[152:155], v[64:79]
    s_waitcnt lgkmcnt(12)
    v_mfma_f32_32x32x16_bf16 v[16:31], v[164:167], v[160:163], v[16:31]
    ds_read_b128 v[248:251], v199 offset:36864
    ds_read_b64_tr_b16 v[252:253], v201 offset:12288
    ds_read_b64_tr_b16 v[254:255], v201 offset:12800
    s_waitcnt lgkmcnt(14)
ST_A_28:
    s_cbranch_execz ST_C_28
    v_mfma_f32_32x32x16_bf16 v[32:47], v[164:167], v[168:171], v[32:47]
    s_waitcnt lgkmcnt(12)
    s_barrier
    ds_read_b128 v[148:151], v192 offset:0
    ds_read_b64_tr_b16 v[144:145], v202 offset:16384
    ds_read_b64_tr_b16 v[146:147], v202 offset:16896
    v_mfma_f32_32x32x16_bf16 v[48:63], v[172:175], v[160:163], v[48:63]
    v_mfma_f32_32x32x16_bf16 v[64:79], v[172:175], v[168:171], v[64:79]
    s_waitcnt lgkmcnt(12)
    v_mfma_f32_32x32x16_bf16 v[16:31], v[180:183], v[176:179], v[16:31]
    ds_read_b128 v[152:155], v192 offset:4096
    ds_read_b128 v[156:159], v193 offset:0
    s_waitcnt lgkmcnt(13)
    v_mfma_f32_32x32x16_bf16 v[32:47], v[180:183], v[184:187], v[32:47]
    ds_read_b64_tr_b16 v[164:165], v202 offset:18432
    ds_read_b64_tr_b16 v[166:167], v202 offset:18944
    s_waitcnt lgkmcnt(13)
    v_mfma_f32_32x32x16_bf16 v[48:63], v[188:191], v[176:179], v[48:63]
    ds_read_b128 v[160:163], v193 offset:4096
    ds_read_b128 v[168:171], v194 offset:0
    v_mfma_f32_32x32x16_bf16 v[64:79], v[188:191], v[184:187], v[64:79]
    s_waitcnt lgkmcnt(12)
    v_mfma_f32_32x32x16_bf16 v[16:31], v[244:247], v[240:243], v[16:31]
    ds_read_b64_tr_b16 v[172:173], v202 offset:20480
    ds_read_b64_tr_b16 v[174:175], v202 offset:20992
    s_waitcnt lgkmcnt(13)
    v_mfma_f32_32x32x16_bf16 v[32:47], v[244:247], v[248:251], v[32:47]
    ds_read_b128 v[180:183], v194 offset:4096
    ds_read_b128 v[176:179], v195 offset:0
    s_waitcnt lgkmcnt(13)
    v_mfma_f32_32x32x16_bf16 v[48:63], v[252:255], v[240:243], v[48:63]
    ds_read_b64_tr_b16 v[184:185], v202 offset:22528
    ds_read_b64_tr_b16 v[186:187], v202 offset:23040
    s_nop 1
    v_pk_mul_f32 v[204:205], v[16:17], s[54:55] op_sel:[0,1] op_sel_hi:[1,1]
    v_pk_mul_f32 v[206:207], v[18:19], s[54:55] op_sel:[0,1] op_sel_hi:[1,1]
ST_A_29:
    s_cbranch_execz ST_C_29
    v_pk_mul_f32 v[208:209], v[20:21], s[54:55] op_sel:[0,1] op_sel_hi:[1,1]
    v_pk_mul_f32 v[210:211], v[22:23], s[54:55] op_sel:[0,1] op_sel_hi:[1,1]
    v_exp_f32 v204, v204
    v_mfma_f32_32x32x16_bf16 v[64:79], v[252:255], v[248:251], v[64:79]
    v_exp_f32 v205, v205
    v_exp_f32 v206, v206
    s_waitcnt lgkmcnt(12)
    v_mfma_f32_32x32x16_bf16 v[80:95], v[144:147], v[148:151], 0
    ds_read_b128 v[188:191], v195 offset:4096
    s_barrier
    ds_read_b128 v[244:247], v192 offset:16384
    v_exp_f32 v207, v207
    v_exp_f32 v208, v208
    s_waitcnt lgkmcnt(13)
    v_mfma_f32_32x32x16_bf16 v[96:111], v[144:147], v[152:155], 0
    ds_read_b64_tr_b16 v[240:241], v202 offset:24576
    ds_read_b64_tr_b16 v[242:243], v202 offset:25088
    v_exp_f32 v209, v209
    s_waitcnt lgkmcnt(12)
    v_mfma_f32_32x32x16_bf16 v[80:95], v[164:167], v[156:159], v[80:95]
    ds_read_b128 v[248:251], v192 offset:20480
    ds_read_b128 v[252:255], v193 offset:16384
    v_exp_f32 v210, v210
    v_exp_f32 v211, v211
    v_pk_add_f32 v[204:205], v[204:205], s[48:49] op_sel_hi:[1,0]
    s_waitcnt lgkmcnt(13)
    v_mfma_f32_32x32x16_bf16 v[96:111], v[164:167], v[160:163], v[96:111]
    ds_read_b64_tr_b16 v[148:149], v202 offset:26624
    ds_read_b64_tr_b16 v[150:151], v202 offset:27136
    v_pk_add_f32 v[206:207], v[206:207], s[48:49] op_sel_hi:[1,0]
    v_pk_add_f32 v[208:209], v[208:209], s[48:49] op_sel_hi:[1,0]
    v_pk_add_f32 v[210:211], v[210:211], s[48:49] op_sel_hi:[1,0]
    s_waitcnt lgkmcnt(12)
    v_mfma_f32_32x32x16_bf16 v[80:95], v[172:175], v[168:171], v[80:95]
    ds_read_b128 v[144:147], v193 offset:20480
    ds_read_b128 v[152:155], v194 offset:16384
    v_rcp_f32 v204, v204
    v_rcp_f32 v205, v205
    s_waitcnt lgkmcnt(13)
    v_mfma_f32_32x32x16_bf16 v[96:111], v[172:175], v[180:183], v[96:111]
ST_A_30:
    s_cbranch_execz ST_C_30
    ds_read_b64_tr_b16 v[156:157], v202 offset:28672
    ds_read_b64_tr_b16 v[158:159], v202 offset:29184
    v_rcp_f32 v206, v206
    s_waitcnt lgkmcnt(12)
    v_mfma_f32_32x32x16_bf16 v[80:95], v[184:187], v[176:179], v[80:95]
    ds_read_b128 v[164:167], v194 offset:20480
    ds_read_b128 v[160:163], v195 offset:16384
    v_rcp_f32 v207, v207
    v_rcp_f32 v208, v208
    s_waitcnt lgkmcnt(13)
    v_mfma_f32_32x32x16_bf16 v[96:111], v[184:187], v[188:191], v[96:111]
    ds_read_b64_tr_b16 v[168:169], v202 offset:30720
    ds_read_b64_tr_b16 v[170:171], v202 offset:31232
    v_rcp_f32 v209, v209
    v_rcp_f32 v210, v210
    s_waitcnt lgkmcnt(12)
    v_mfma_f32_32x32x16_bf16 v[80:95], v[240:243], v[244:247], v[80:95]
    ds_read_b128 v[172:175], v195 offset:20480
    s_barrier
    ds_read_b128 v[180:183], v192 offset:32768
    v_rcp_f32 v211, v211
    v_pk_mul_f32 v[204:205], v[204:205], v[24:25]
    v_pk_mul_f32 v[206:207], v[206:207], v[26:27]
    s_waitcnt lgkmcnt(13)
    v_mfma_f32_32x32x16_bf16 v[96:111], v[240:243], v[248:251], v[96:111]
    ds_read_b64_tr_b16 v[176:177], v202 offset:32768
    ds_read_b64_tr_b16 v[178:179], v202 offset:33280
    v_pk_mul_f32 v[208:209], v[208:209], v[28:29]
    v_pk_mul_f32 v[210:211], v[210:211], v[30:31]
    v_cvt_pk_bf16_f32 v212, v204, v205
    s_waitcnt lgkmcnt(12)
    v_mfma_f32_32x32x16_bf16 v[80:95], v[148:151], v[252:255], v[80:95]
    ds_read_b128 v[184:187], v192 offset:36864
    ds_read_b128 v[188:191], v193 offset:32768
    v_cvt_pk_bf16_f32 v213, v206, v207
    v_cvt_pk_bf16_f32 v214, v208, v209
    v_cvt_pk_bf16_f32 v215, v210, v211
    s_waitcnt lgkmcnt(13)
ST_A_31:
    s_cbranch_execz ST_C_31
    v_mfma_f32_32x32x16_bf16 v[96:111], v[148:151], v[144:147], v[96:111]
    ds_read_b64_tr_b16 v[244:245], v202 offset:34816
    ds_read_b64_tr_b16 v[246:247], v202 offset:35328
    buffer_store_dwordx4 v[212:215], v228, s[32:35], s56 offen offset:0 sc1
    v_pk_mul_f32 v[216:217], v[32:33], s[54:55] op_sel:[0,1] op_sel_hi:[1,1]
    s_waitcnt lgkmcnt(12)
    v_mfma_f32_32x32x16_bf16 v[80:95], v[156:159], v[152:155], v[80:95]
    ds_read_b128 v[240:243], v193 offset:36864
    ds_read_b128 v[248:251], v194 offset:32768
    v_pk_mul_f32 v[218:219], v[34:35], s[54:55] op_sel:[0,1] op_sel_hi:[1,1]
    v_pk_mul_f32 v[220:221], v[36:37], s[54:55] op_sel:[0,1] op_sel_hi:[1,1]
    v_pk_mul_f32 v[222:223], v[38:39], s[54:55] op_sel:[0,1] op_sel_hi:[1,1]
    s_waitcnt lgkmcnt(13)
    v_mfma_f32_32x32x16_bf16 v[96:111], v[156:159], v[164:167], v[96:111]
    ds_read_b64_tr_b16 v[252:253], v202 offset:36864
    ds_read_b64_tr_b16 v[254:255], v202 offset:37376
    v_exp_f32 v216, v216
    v_exp_f32 v217, v217
    s_waitcnt lgkmcnt(12)
    v_mfma_f32_32x32x16_bf16 v[80:95], v[168:171], v[160:163], v[80:95]
    ds_read_b128 v[148:151], v194 offset:36864
    ds_read_b128 v[144:147], v195 offset:32768
    v_exp_f32 v218, v218
    v_exp_f32 v219, v219
    s_waitcnt lgkmcnt(13)
    v_mfma_f32_32x32x16_bf16 v[96:111], v[168:171], v[172:175], v[96:111]
    ds_read_b64_tr_b16 v[152:153], v202 offset:38912
    ds_read_b64_tr_b16 v[154:155], v202 offset:39424
    v_exp_f32 v220, v220
    s_waitcnt lgkmcnt(12)
    v_mfma_f32_32x32x16_bf16 v[80:95], v[176:179], v[180:183], v[80:95]
    ds_read_b128 v[156:159], v195 offset:36864
    s_barrier
    ds_read_b128 v[164:167], v192 offset:49152
    v_exp_f32 v221, v221
    v_exp_f32 v222, v222
    s_waitcnt lgkmcnt(13)
    v_mfma_f32_32x32x16_bf16 v[96:111], v[176:179], v[184:187], v[96:111]
    s_nop 0
ST_A_32:
    s_cbranch_execz ST_C_32
    ds_read_b64_tr_b16 v[160:161], v202 offset:40960
    ds_read_b64_tr_b16 v[162:163], v202 offset:41472
    v_exp_f32 v223, v223
    v_pk_add_f32 v[216:217], v[216:217], s[48:49] op_sel_hi:[1,0]
    v_pk_add_f32 v[218:219], v[218:219], s[48:49] op_sel_hi:[1,0]
    s_waitcnt lgkmcnt(12)
    v_mfma_f32_32x32x16_bf16 v[80:95], v[244:247], v[188:191], v[80:95]
    ds_read_b128 v[168:171], v192 offset:53248
    ds_read_b128 v[172:175], v193 offset:49152
    v_pk_add_f32 v[220:221], v[220:221], s[48:49] op_sel_hi:[1,0]
    v_pk_add_f32 v[222:223], v[222:223], s[48:49] op_sel_hi:[1,0]
    v_rcp_f32 v216, v216
    s_waitcnt lgkmcnt(13)
    v_mfma_f32_32x32x16_bf16 v[96:111], v[244:247], v[240:243], v[96:111]
    ds_read_b64_tr_b16 v[180:181], v202 offset:43008
    ds_read_b64_tr_b16 v[182:183], v202 offset:43520
    v_rcp_f32 v217, v217
    s_waitcnt lgkmcnt(12)
    v_mfma_f32_32x32x16_bf16 v[80:95], v[252:255], v[248:251], v[80:95]
    ds_read_b128 v[176:179], v193 offset:53248
    ds_read_b128 v[184:187], v194 offset:49152
    v_rcp_f32 v218, v218
    v_rcp_f32 v219, v219
    s_waitcnt lgkmcnt(13)
    v_mfma_f32_32x32x16_bf16 v[96:111], v[252:255], v[148:151], v[96:111]
    ds_read_b64_tr_b16 v[188:189], v202 offset:45056
    ds_read_b64_tr_b16 v[190:191], v202 offset:45568
    v_rcp_f32 v220, v220
    v_rcp_f32 v221, v221
    s_waitcnt lgkmcnt(12)
    v_mfma_f32_32x32x16_bf16 v[80:95], v[152:155], v[144:147], v[80:95]
    ds_read_b128 v[244:247], v194 offset:53248
    ds_read_b128 v[240:243], v195 offset:49152
    v_rcp_f32 v222, v222
    v_rcp_f32 v223, v223
    s_waitcnt lgkmcnt(13)
    v_mfma_f32_32x32x16_bf16 v[96:111], v[152:155], v[156:159], v[96:111]
    ds_read_b64_tr_b16 v[248:249], v202 offset:47104
    ds_read_b64_tr_b16 v[250:251], v202 offset:47616
ST_A_33:
    s_cbranch_execz ST_C_33
    v_pk_mul_f32 v[216:217], v[216:217], v[40:41]
    v_pk_mul_f32 v[218:219], v[218:219], v[42:43]
    v_pk_mul_f32 v[220:221], v[220:221], v[44:45]
    s_waitcnt lgkmcnt(12)
    v_mfma_f32_32x32x16_bf16 v[80:95], v[160:163], v[164:167], v[80:95]
    ds_read_b128 v[252:255], v195 offset:53248
    s_barrier
    ds_read_b128 v[148:151], v196 offset:0
    v_pk_mul_f32 v[222:223], v[222:223], v[46:47]
    v_cvt_pk_bf16_f32 v224, v216, v217
    v_cvt_pk_bf16_f32 v225, v218, v219
    s_waitcnt lgkmcnt(13)
    v_mfma_f32_32x32x16_bf16 v[96:111], v[160:163], v[168:171], v[96:111]
    ds_read_b64_tr_b16 v[144:145], v202 offset:0
    ds_read_b64_tr_b16 v[146:147], v202 offset:512
    v_cvt_pk_bf16_f32 v226, v220, v221
    v_cvt_pk_bf16_f32 v227, v222, v223
    s_waitcnt lgkmcnt(12)
    v_mfma_f32_32x32x16_bf16 v[80:95], v[180:183], v[172:175], v[80:95]
    ds_read_b128 v[152:155], v196 offset:4096
    ds_read_b128 v[156:159], v197 offset:0
    buffer_store_dwordx4 v[224:227], v228, s[32:35], s57 offen offset:0 sc1
    v_pk_mul_f32 v[204:205], v[48:49], s[54:55] op_sel:[0,1] op_sel_hi:[1,1]
    v_pk_mul_f32 v[206:207], v[50:51], s[54:55] op_sel:[0,1] op_sel_hi:[1,1]
    v_pk_mul_f32 v[208:209], v[52:53], s[54:55] op_sel:[0,1] op_sel_hi:[1,1]
    s_waitcnt lgkmcnt(13)
    v_mfma_f32_32x32x16_bf16 v[96:111], v[180:183], v[176:179], v[96:111]
    ds_read_b64_tr_b16 v[164:165], v202 offset:2048
    ds_read_b64_tr_b16 v[166:167], v202 offset:2560
    v_pk_mul_f32 v[210:211], v[54:55], s[54:55] op_sel:[0,1] op_sel_hi:[1,1]
    v_exp_f32 v204, v204
    s_waitcnt lgkmcnt(12)
    v_mfma_f32_32x32x16_bf16 v[80:95], v[188:191], v[184:187], v[80:95]
    ds_read_b128 v[160:163], v197 offset:4096
    ds_read_b128 v[168:171], v198 offset:0
ST_A_34:
    s_cbranch_execz ST_C_34
    v_exp_f32 v205, v205
    v_exp_f32 v206, v206
    s_waitcnt lgkmcnt(13)
    v_mfma_f32_32x32x16_bf16 v[96:111], v[188:191], v[244:247], v[96:111]
    ds_read_b64_tr_b16 v[172:173], v202 offset:4096
    ds_read_b64_tr_b16 v[174:175], v202 offset:4608
    v_exp_f32 v207, v207
    s_waitcnt lgkmcnt(12)
    v_mfma_f32_32x32x16_bf16 v[80:95], v[248:251], v[240:243], v[80:95]
    ds_read_b128 v[180:183], v198 offset:4096
    ds_read_b128 v[176:179], v199 offset:0
    v_exp_f32 v208, v208
    v_exp_f32 v209, v209
    s_waitcnt lgkmcnt(13)
    v_mfma_f32_32x32x16_bf16 v[96:111], v[248:251], v[252:255], v[96:111]
    ds_read_b64_tr_b16 v[184:185], v202 offset:6144
    ds_read_b64_tr_b16 v[186:187], v202 offset:6656
    v_exp_f32 v210, v210
    v_exp_f32 v211, v211
    s_waitcnt lgkmcnt(12)
    v_mfma_f32_32x32x16_bf16 v[80:95], v[144:147], v[148:151], v[80:95]
    ds_read_b128 v[188:191], v199 offset:4096
    s_barrier
    ds_read_b128 v[244:247], v196 offset:16384
    v_pk_add_f32 v[204:205], v[204:205], s[48:49] op_sel_hi:[1,0]
    v_pk_add_f32 v[206:207], v[206:207], s[48:49] op_sel_hi:[1,0]
    v_pk_add_f32 v[208:209], v[208:209], s[48:49] op_sel_hi:[1,0]
    v_pk_add_f32 v[210:211], v[210:211], s[48:49] op_sel_hi:[1,0]
    s_waitcnt lgkmcnt(13)
    v_mfma_f32_32x32x16_bf16 v[96:111], v[144:147], v[152:155], v[96:111]
    ds_read_b64_tr_b16 v[240:241], v202 offset:8192
    ds_read_b64_tr_b16 v[242:243], v202 offset:8704
    v_rcp_f32 v204, v204
    s_waitcnt lgkmcnt(12)
    v_mfma_f32_32x32x16_bf16 v[80:95], v[164:167], v[156:159], v[80:95]
    ds_read_b128 v[248:251], v196 offset:20480
    ds_read_b128 v[252:255], v197 offset:16384
    v_rcp_f32 v205, v205
    v_rcp_f32 v206, v206
    s_waitcnt lgkmcnt(13)
    s_nop 0
ST_A_35:
    s_cbranch_execz ST_C_35
    v_mfma_f32_32x32x16_bf16 v[96:111], v[164:167], v[160:163], v[96:111]
    ds_read_b64_tr_b16 v[148:149], v202 offset:10240
    ds_read_b64_tr_b16 v[150:151], v202 offset:10752
    v_rcp_f32 v207, v207
    v_rcp_f32 v208, v208
    s_waitcnt lgkmcnt(12)
    v_mfma_f32_32x32x16_bf16 v[80:95], v[172:175], v[168:171], v[80:95]
    ds_read_b128 v[144:147], v197 offset:20480
    ds_read_b128 v[152:155], v198 offset:16384
    v_rcp_f32 v209, v209
    v_rcp_f32 v210, v210
    s_waitcnt lgkmcnt(13)
    v_mfma_f32_32x32x16_bf16 v[96:111], v[172:175], v[180:183], v[96:111]
    ds_read_b64_tr_b16 v[156:157], v202 offset:12288
    ds_read_b64_tr_b16 v[158:159], v202 offset:12800
    v_rcp_f32 v211, v211
    v_pk_mul_f32 v[204:205], v[204:205], v[56:57]
    s_waitcnt lgkmcnt(12)
    v_mfma_f32_32x32x16_bf16 v[80:95], v[184:187], v[176:179], v[80:95]
    ds_read_b128 v[164:167], v198 offset:20480
    ds_read_b128 v[160:163], v199 offset:16384
    v_pk_mul_f32 v[206:207], v[206:207], v[58:59]
    v_pk_mul_f32 v[208:209], v[208:209], v[60:61]
    v_pk_mul_f32 v[210:211], v[210:211], v[62:63]
    s_waitcnt lgkmcnt(13)
    v_mfma_f32_32x32x16_bf16 v[96:111], v[184:187], v[188:191], v[96:111]
    ds_read_b64_tr_b16 v[168:169], v202 offset:14336
    ds_read_b64_tr_b16 v[170:171], v202 offset:14848
    v_cvt_pk_bf16_f32 v212, v204, v205
    v_cvt_pk_bf16_f32 v213, v206, v207
    v_cvt_pk_bf16_f32 v214, v208, v209
    s_waitcnt lgkmcnt(12)
    v_mfma_f32_32x32x16_bf16 v[80:95], v[240:243], v[244:247], v[80:95]
    ds_read_b128 v[172:175], v199 offset:20480
    s_barrier
    ds_read_b128 v[180:183], v196 offset:32768
    v_cvt_pk_bf16_f32 v215, v210, v211
ST_A_36:
    s_cbranch_execz ST_C_36
    buffer_store_dwordx4 v[212:215], v228, s[32:35], s56 offen offset:1024 sc1
    v_pk_mul_f32 v[216:217], v[64:65], s[54:55] op_sel:[0,1] op_sel_hi:[1,1]
    s_waitcnt lgkmcnt(13)
    v_mfma_f32_32x32x16_bf16 v[96:111], v[240:243], v[248:251], v[96:111]
    ds_read_b64_tr_b16 v[176:177], v202 offset:16384
    ds_read_b64_tr_b16 v[178:179], v202 offset:16896
    v_pk_mul_f32 v[218:219], v[66:67], s[54:55] op_sel:[0,1] op_sel_hi:[1,1]
    v_pk_mul_f32 v[220:221], v[68:69], s[54:55] op_sel:[0,1] op_sel_hi:[1,1]
    v_pk_mul_f32 v[222:223], v[70:71], s[54:55] op_sel:[0,1] op_sel_hi:[1,1]
    s_waitcnt lgkmcnt(12)
    v_mfma_f32_32x32x16_bf16 v[80:95], v[148:151], v[252:255], v[80:95]
    ds_read_b128 v[184:187], v196 offset:36864
    ds_read_b128 v[188:191], v197 offset:32768
    v_exp_f32 v216, v216
    v_exp_f32 v217, v217
    s_waitcnt lgkmcnt(13)
    v_mfma_f32_32x32x16_bf16 v[96:111], v[148:151], v[144:147], v[96:111]
    ds_read_b64_tr_b16 v[244:245], v202 offset:18432
    ds_read_b64_tr_b16 v[246:247], v202 offset:18944
    v_exp_f32 v218, v218
    s_waitcnt lgkmcnt(12)
    v_mfma_f32_32x32x16_bf16 v[80:95], v[156:159], v[152:155], v[80:95]
    ds_read_b128 v[240:243], v197 offset:36864
    ds_read_b128 v[248:251], v198 offset:32768
    v_exp_f32 v219, v219
    v_exp_f32 v220, v220
    s_waitcnt lgkmcnt(13)
    v_mfma_f32_32x32x16_bf16 v[96:111], v[156:159], v[164:167], v[96:111]
    ds_read_b64_tr_b16 v[252:253], v202 offset:20480
    ds_read_b64_tr_b16 v[254:255], v202 offset:20992
    v_exp_f32 v221, v221
    v_exp_f32 v222, v222
    s_waitcnt lgkmcnt(12)
    v_mfma_f32_32x32x16_bf16 v[80:95], v[168:171], v[160:163], v[80:95]
    ds_read_b128 v[148:151], v198 offset:36864
    ds_read_b128 v[144:147], v199 offset:32768
    v_exp_f32 v223, v223
    v_pk_add_f32 v[216:217], v[216:217], s[48:49] op_sel_hi:[1,0]
    s_nop 0
ST_A_37:
    s_cbranch_execz ST_C_37
    v_pk_add_f32 v[218:219], v[218:219], s[48:49] op_sel_hi:[1,0]
    s_waitcnt lgkmcnt(13)
    v_mfma_f32_32x32x16_bf16 v[96:111], v[168:171], v[172:175], v[96:111]
    ds_read_b64_tr_b16 v[152:153], v202 offset:22528
    ds_read_b64_tr_b16 v[154:155], v202 offset:23040
    v_pk_add_f32 v[220:221], v[220:221], s[48:49] op_sel_hi:[1,0]
    v_pk_add_f32 v[222:223], v[222:223], s[48:49] op_sel_hi:[1,0]
    s_waitcnt lgkmcnt(12)
    v_mfma_f32_32x32x16_bf16 v[80:95], v[176:179], v[180:183], v[80:95]
    ds_read_b128 v[156:159], v199 offset:36864
    s_barrier
    ds_read_b128 v[164:167], v192 offset:0
    v_rcp_f32 v216, v216
    v_rcp_f32 v217, v217
    s_waitcnt lgkmcnt(13)
    v_mfma_f32_32x32x16_bf16 v[96:111], v[176:179], v[184:187], v[96:111]
    ds_read_b64_tr_b16 v[160:161], v200 offset:24576
    ds_read_b64_tr_b16 v[162:163], v200 offset:25088
    v_rcp_f32 v218, v218
    v_rcp_f32 v219, v219
    s_waitcnt lgkmcnt(12)
    v_mfma_f32_32x32x16_bf16 v[80:95], v[244:247], v[188:191], v[80:95]
    ds_read_b128 v[168:171], v192 offset:4096
    ds_read_b64_tr_b16 v[172:173], v201 offset:24576
    ds_read_b64_tr_b16 v[174:175], v201 offset:25088
    v_rcp_f32 v220, v220
    v_rcp_f32 v221, v221
    s_waitcnt lgkmcnt(14)
    v_mfma_f32_32x32x16_bf16 v[96:111], v[244:247], v[240:243], v[96:111]
    ds_read_b128 v[180:183], v193 offset:0
    v_rcp_f32 v222, v222
    s_waitcnt lgkmcnt(12)
    v_mfma_f32_32x32x16_bf16 v[80:95], v[252:255], v[248:251], v[80:95]
    ds_read_b64_tr_b16 v[176:177], v200 offset:28672
    ds_read_b64_tr_b16 v[178:179], v200 offset:29184
    v_rcp_f32 v223, v223
    v_pk_mul_f32 v[216:217], v[216:217], v[72:73]
    v_pk_mul_f32 v[218:219], v[218:219], v[74:75]
    v_pk_mul_f32 v[220:221], v[220:221], v[76:77]
ST_A_38:
    s_cbranch_execz ST_C_38
    s_waitcnt lgkmcnt(13)
    v_mfma_f32_32x32x16_bf16 v[96:111], v[252:255], v[148:151], v[96:111]
    ds_read_b128 v[184:187], v193 offset:4096
    v_pk_mul_f32 v[222:223], v[222:223], v[78:79]
    v_cvt_pk_bf16_f32 v224, v216, v217
    v_cvt_pk_bf16_f32 v225, v218, v219
    s_waitcnt lgkmcnt(11)
    v_mfma_f32_32x32x16_bf16 v[80:95], v[152:155], v[144:147], v[80:95]
    ds_read_b64_tr_b16 v[188:189], v201 offset:28672
    ds_read_b64_tr_b16 v[190:191], v201 offset:29184
    v_cvt_pk_bf16_f32 v226, v220, v221
    v_cvt_pk_bf16_f32 v227, v222, v223
    s_waitcnt lgkmcnt(12)
    v_mfma_f32_32x32x16_bf16 v[96:111], v[152:155], v[156:159], v[96:111]
    s_barrier
    ds_read_b128 v[244:247], v194 offset:0
    ds_read_b64_tr_b16 v[240:241], v200 offset:32768
    ds_read_b64_tr_b16 v[242:243], v200 offset:33280
    buffer_store_dwordx4 v[224:227], v228, s[32:35], s57 offen offset:1024 sc1
    s_waitcnt lgkmcnt(12)
    v_mfma_f32_32x32x16_bf16 v[16:31], v[160:163], v[164:167], 0
    ds_read_b128 v[248:251], v194 offset:4096
    ds_read_b64_tr_b16 v[252:253], v201 offset:32768
    ds_read_b64_tr_b16 v[254:255], v201 offset:33280
    v_pk_mul_f32 v[80:81], v[80:81], s[54:55] op_sel_hi:[1,0]
    v_pk_mul_f32 v[82:83], v[82:83], s[54:55] op_sel_hi:[1,0]
    v_pk_mul_f32 v[84:85], v[84:85], s[54:55] op_sel_hi:[1,0]
    v_pk_mul_f32 v[86:87], v[86:87], s[54:55] op_sel_hi:[1,0]
    v_pk_mul_f32 v[88:89], v[88:89], s[54:55] op_sel_hi:[1,0]
    v_pk_mul_f32 v[90:91], v[90:91], s[54:55] op_sel_hi:[1,0]
    s_waitcnt lgkmcnt(14)
    v_mfma_f32_32x32x16_bf16 v[32:47], v[160:163], v[168:171], 0
    ds_read_b128 v[148:151], v195 offset:0
    v_pk_mul_f32 v[92:93], v[92:93], s[54:55] op_sel_hi:[1,0]
    s_nop 0
ST_A_39:
    s_cbranch_execz ST_C_39
    v_pk_mul_f32 v[94:95], v[94:95], s[54:55] op_sel_hi:[1,0]
    v_cvt_pk_bf16_f32 v204, v80, v81
    s_waitcnt lgkmcnt(13)
    v_mfma_f32_32x32x16_bf16 v[48:63], v[172:175], v[164:167], 0
    ds_read_b64_tr_b16 v[144:145], v200 offset:36864
    ds_read_b64_tr_b16 v[146:147], v200 offset:37376
    v_cvt_pk_bf16_f32 v205, v82, v83
    v_cvt_pk_bf16_f32 v206, v84, v85
    v_cvt_pk_bf16_f32 v207, v86, v87
    v_mfma_f32_32x32x16_bf16 v[64:79], v[172:175], v[168:171], 0
    v_cvt_pk_bf16_f32 v208, v88, v89
    v_cvt_pk_bf16_f32 v209, v90, v91
    s_waitcnt lgkmcnt(12)
    v_mfma_f32_32x32x16_bf16 v[16:31], v[176:179], v[180:183], v[16:31]
    ds_read_b128 v[152:155], v195 offset:4096
    ds_read_b64_tr_b16 v[156:157], v201 offset:36864
    ds_read_b64_tr_b16 v[158:159], v201 offset:37376
    v_cvt_pk_bf16_f32 v210, v92, v93
    v_cvt_pk_bf16_f32 v211, v94, v95
    buffer_store_dwordx4 v[204:207], v228, s[32:35], s50 offen offset:0 sc1
    s_waitcnt lgkmcnt(14)
    v_mfma_f32_32x32x16_bf16 v[32:47], v[176:179], v[184:187], v[32:47]
    s_waitcnt lgkmcnt(12)
    s_barrier
    ds_read_b128 v[160:163], v192 offset:16384
    ds_read_b64_tr_b16 v[164:165], v200 offset:40960
    ds_read_b64_tr_b16 v[166:167], v200 offset:41472
    buffer_store_dwordx4 v[208:211], v228, s[32:35], s50 offen offset:1024 sc1
    v_pk_mul_f32 v[96:97], v[96:97], s[54:55] op_sel_hi:[1,0]
    v_mfma_f32_32x32x16_bf16 v[48:63], v[188:191], v[180:183], v[48:63]
    v_pk_mul_f32 v[98:99], v[98:99], s[54:55] op_sel_hi:[1,0]
    v_pk_mul_f32 v[100:101], v[100:101], s[54:55] op_sel_hi:[1,0]
    v_pk_mul_f32 v[102:103], v[102:103], s[54:55] op_sel_hi:[1,0]
    v_pk_mul_f32 v[104:105], v[104:105], s[54:55] op_sel_hi:[1,0]
ST_A_40:
    s_cbranch_execz ST_C_40
    v_mfma_f32_32x32x16_bf16 v[64:79], v[188:191], v[184:187], v[64:79]
    v_pk_mul_f32 v[106:107], v[106:107], s[54:55] op_sel_hi:[1,0]
    v_pk_mul_f32 v[108:109], v[108:109], s[54:55] op_sel_hi:[1,0]
    v_pk_mul_f32 v[110:111], v[110:111], s[54:55] op_sel_hi:[1,0]
    s_waitcnt lgkmcnt(12)
    v_mfma_f32_32x32x16_bf16 v[16:31], v[240:243], v[244:247], v[16:31]
    ds_read_b128 v[168:171], v192 offset:20480
    ds_read_b64_tr_b16 v[172:173], v201 offset:40960
    ds_read_b64_tr_b16 v[174:175], v201 offset:41472
    v_cvt_pk_bf16_f32 v216, v96, v97
    v_cvt_pk_bf16_f32 v217, v98, v99
    v_cvt_pk_bf16_f32 v218, v100, v101
    s_waitcnt lgkmcnt(14)
    v_mfma_f32_32x32x16_bf16 v[32:47], v[240:243], v[248:251], v[32:47]
    ds_read_b128 v[176:179], v193 offset:16384
    v_cvt_pk_bf16_f32 v219, v102, v103
    v_cvt_pk_bf16_f32 v220, v104, v105
    v_cvt_pk_bf16_f32 v221, v106, v107
    s_waitcnt lgkmcnt(13)
    v_mfma_f32_32x32x16_bf16 v[48:63], v[252:255], v[244:247], v[48:63]
    ds_read_b64_tr_b16 v[180:181], v200 offset:45056
    ds_read_b64_tr_b16 v[182:183], v200 offset:45568
    v_cvt_pk_bf16_f32 v222, v108, v109
    v_cvt_pk_bf16_f32 v223, v110, v111
    v_mfma_f32_32x32x16_bf16 v[64:79], v[252:255], v[248:251], v[64:79]
    buffer_store_dwordx4 v[216:219], v228, s[32:35], s51 offen offset:0 sc1
    buffer_store_dwordx4 v[220:223], v228, s[32:35], s51 offen offset:1024 sc1
    s_waitcnt lgkmcnt(12)
    v_mfma_f32_32x32x16_bf16 v[16:31], v[144:147], v[148:151], v[16:31]
    ds_read_b128 v[184:187], v193 offset:20480
    ds_read_b64_tr_b16 v[188:189], v201 offset:45056
    ds_read_b64_tr_b16 v[190:191], v201 offset:45568
    s_waitcnt lgkmcnt(14)
    v_mfma_f32_32x32x16_bf16 v[32:47], v[144:147], v[152:155], v[32:47]
ST_A_41:
    s_cbranch_execz ST_C_41
    s_waitcnt lgkmcnt(12)
    s_barrier
    ds_read_b128 v[240:243], v194 offset:16384
    ds_read_b64_tr_b16 v[244:245], v200 offset:0
    ds_read_b64_tr_b16 v[246:247], v200 offset:512
    v_mfma_f32_32x32x16_bf16 v[48:63], v[156:159], v[148:151], v[48:63]
    v_mfma_f32_32x32x16_bf16 v[64:79], v[156:159], v[152:155], v[64:79]
    s_waitcnt lgkmcnt(12)
    v_mfma_f32_32x32x16_bf16 v[16:31], v[164:167], v[160:163], v[16:31]
    ds_read_b128 v[248:251], v194 offset:20480
    ds_read_b64_tr_b16 v[252:253], v201 offset:0
    ds_read_b64_tr_b16 v[254:255], v201 offset:512
    s_waitcnt lgkmcnt(14)
    v_mfma_f32_32x32x16_bf16 v[32:47], v[164:167], v[168:171], v[32:47]
    ds_read_b128 v[144:147], v195 offset:16384
    s_waitcnt lgkmcnt(13)
    v_mfma_f32_32x32x16_bf16 v[48:63], v[172:175], v[160:163], v[48:63]
    ds_read_b64_tr_b16 v[148:149], v200 offset:4096
    ds_read_b64_tr_b16 v[150:151], v200 offset:4608
    v_mfma_f32_32x32x16_bf16 v[64:79], v[172:175], v[168:171], v[64:79]
    s_waitcnt lgkmcnt(12)
    v_mfma_f32_32x32x16_bf16 v[16:31], v[180:183], v[176:179], v[16:31]
    ds_read_b128 v[152:155], v195 offset:20480
    ds_read_b64_tr_b16 v[156:157], v201 offset:4096
    ds_read_b64_tr_b16 v[158:159], v201 offset:4608
    s_waitcnt lgkmcnt(14)
    v_mfma_f32_32x32x16_bf16 v[32:47], v[180:183], v[184:187], v[32:47]
    s_waitcnt lgkmcnt(12)
    s_barrier
    ds_read_b128 v[164:167], v192 offset:32768
    ds_read_b64_tr_b16 v[160:161], v200 offset:8192
    ds_read_b64_tr_b16 v[162:163], v200 offset:8704
    v_mfma_f32_32x32x16_bf16 v[48:63], v[188:191], v[176:179], v[48:63]
    v_mfma_f32_32x32x16_bf16 v[64:79], v[188:191], v[184:187], v[64:79]
    s_waitcnt lgkmcnt(12)
    v_mfma_f32_32x32x16_bf16 v[16:31], v[244:247], v[240:243], v[16:31]
    s_nop 0
ST_A_42:
    s_cbranch_execz ST_C_42
    ds_read_b128 v[168:171], v192 offset:36864
    ds_read_b64_tr_b16 v[172:173], v201 offset:8192
    ds_read_b64_tr_b16 v[174:175], v201 offset:8704
    s_waitcnt lgkmcnt(14)
    v_mfma_f32_32x32x16_bf16 v[32:47], v[244:247], v[248:251], v[32:47]
    ds_read_b128 v[180:183], v193 offset:32768
    s_waitcnt lgkmcnt(13)
    v_mfma_f32_32x32x16_bf16 v[48:63], v[252:255], v[240:243], v[48:63]
    ds_read_b64_tr_b16 v[176:177], v200 offset:12288
    ds_read_b64_tr_b16 v[178:179], v200 offset:12800
    v_mfma_f32_32x32x16_bf16 v[64:79], v[252:255], v[248:251], v[64:79]
    s_waitcnt lgkmcnt(12)
    v_mfma_f32_32x32x16_bf16 v[16:31], v[148:151], v[144:147], v[16:31]
    ds_read_b128 v[184:187], v193 offset:36864
    ds_read_b64_tr_b16 v[188:189], v201 offset:12288
    ds_read_b64_tr_b16 v[190:191], v201 offset:12800
    s_waitcnt lgkmcnt(14)
    v_mfma_f32_32x32x16_bf16 v[32:47], v[148:151], v[152:155], v[32:47]
    s_waitcnt lgkmcnt(12)
    s_barrier
    ds_read_b128 v[244:247], v194 offset:32768
    ds_read_b64_tr_b16 v[240:241], v200 offset:16384
    ds_read_b64_tr_b16 v[242:243], v200 offset:16896
    v_mfma_f32_32x32x16_bf16 v[48:63], v[156:159], v[144:147], v[48:63]
    v_mfma_f32_32x32x16_bf16 v[64:79], v[156:159], v[152:155], v[64:79]
    s_waitcnt lgkmcnt(12)
    v_mfma_f32_32x32x16_bf16 v[16:31], v[160:163], v[164:167], v[16:31]
    ds_read_b128 v[248:251], v194 offset:36864
    ds_read_b64_tr_b16 v[252:253], v201 offset:16384
    ds_read_b64_tr_b16 v[254:255], v201 offset:16896
    s_waitcnt lgkmcnt(14)
    v_mfma_f32_32x32x16_bf16 v[32:47], v[160:163], v[168:171], v[32:47]
    ds_read_b128 v[148:151], v195 offset:32768
    s_waitcnt lgkmcnt(13)
    v_mfma_f32_32x32x16_bf16 v[48:63], v[172:175], v[164:167], v[48:63]
    ds_read_b64_tr_b16 v[144:145], v200 offset:20480
ST_A_43:
    s_cbranch_execz ST_C_43
    ds_read_b64_tr_b16 v[146:147], v200 offset:20992
    v_mfma_f32_32x32x16_bf16 v[64:79], v[172:175], v[168:171], v[64:79]
    s_waitcnt lgkmcnt(12)
    v_mfma_f32_32x32x16_bf16 v[16:31], v[176:179], v[180:183], v[16:31]
    ds_read_b128 v[152:155], v195 offset:36864
    ds_read_b64_tr_b16 v[156:157], v201 offset:20480
    ds_read_b64_tr_b16 v[158:159], v201 offset:20992
    s_waitcnt lgkmcnt(14)
    v_mfma_f32_32x32x16_bf16 v[32:47], v[176:179], v[184:187], v[32:47]
    s_waitcnt lgkmcnt(12)
    s_barrier
    ds_read_b128 v[160:163], v192 offset:49152
    ds_read_b64_tr_b16 v[164:165], v200 offset:24576
    ds_read_b64_tr_b16 v[166:167], v200 offset:25088
    v_mfma_f32_32x32x16_bf16 v[48:63], v[188:191], v[180:183], v[48:63]
    v_mfma_f32_32x32x16_bf16 v[64:79], v[188:191], v[184:187], v[64:79]
    s_waitcnt lgkmcnt(12)
    v_mfma_f32_32x32x16_bf16 v[16:31], v[240:243], v[244:247], v[16:31]
    ds_read_b128 v[168:171], v192 offset:53248
    ds_read_b64_tr_b16 v[172:173], v201 offset:24576
    ds_read_b64_tr_b16 v[174:175], v201 offset:25088
    s_waitcnt lgkmcnt(14)
    v_mfma_f32_32x32x16_bf16 v[32:47], v[240:243], v[248:251], v[32:47]
    ds_read_b128 v[176:179], v193 offset:49152
    s_waitcnt lgkmcnt(13)
    v_mfma_f32_32x32x16_bf16 v[48:63], v[252:255], v[244:247], v[48:63]
    ds_read_b64_tr_b16 v[180:181], v200 offset:28672
    ds_read_b64_tr_b16 v[182:183], v200 offset:29184
    v_mfma_f32_32x32x16_bf16 v[64:79], v[252:255], v[248:251], v[64:79]
    s_waitcnt lgkmcnt(12)
    v_mfma_f32_32x32x16_bf16 v[16:31], v[144:147], v[148:151], v[16:31]
    ds_read_b128 v[184:187], v193 offset:53248
    ds_read_b64_tr_b16 v[188:189], v201 offset:28672
    ds_read_b64_tr_b16 v[190:191], v201 offset:29184
    s_waitcnt lgkmcnt(14)
    v_mfma_f32_32x32x16_bf16 v[32:47], v[144:147], v[152:155], v[32:47]
ST_A_44:
    s_cbranch_execz ST_C_44
    s_waitcnt lgkmcnt(12)
    s_barrier
    ds_read_b128 v[240:243], v194 offset:49152
    ds_read_b64_tr_b16 v[244:245], v200 offset:32768
    ds_read_b64_tr_b16 v[246:247], v200 offset:33280
    v_mfma_f32_32x32x16_bf16 v[48:63], v[156:159], v[148:151], v[48:63]
    v_mfma_f32_32x32x16_bf16 v[64:79], v[156:159], v[152:155], v[64:79]
    s_waitcnt lgkmcnt(12)
    v_mfma_f32_32x32x16_bf16 v[16:31], v[164:167], v[160:163], v[16:31]
    ds_read_b128 v[248:251], v194 offset:53248
    ds_read_b64_tr_b16 v[252:253], v201 offset:32768
    ds_read_b64_tr_b16 v[254:255], v201 offset:33280
    s_waitcnt lgkmcnt(14)
    v_mfma_f32_32x32x16_bf16 v[32:47], v[164:167], v[168:171], v[32:47]
    ds_read_b128 v[144:147], v195 offset:49152
    s_waitcnt lgkmcnt(13)
    v_mfma_f32_32x32x16_bf16 v[48:63], v[172:175], v[160:163], v[48:63]
    ds_read_b64_tr_b16 v[148:149], v200 offset:36864
    ds_read_b64_tr_b16 v[150:151], v200 offset:37376
    v_mfma_f32_32x32x16_bf16 v[64:79], v[172:175], v[168:171], v[64:79]
    s_waitcnt lgkmcnt(12)
    v_mfma_f32_32x32x16_bf16 v[16:31], v[180:183], v[176:179], v[16:31]
    ds_read_b128 v[152:155], v195 offset:53248
    ds_read_b64_tr_b16 v[156:157], v201 offset:36864
    ds_read_b64_tr_b16 v[158:159], v201 offset:37376
    s_waitcnt lgkmcnt(14)
    v_mfma_f32_32x32x16_bf16 v[32:47], v[180:183], v[184:187], v[32:47]
    s_waitcnt lgkmcnt(12)
    s_barrier
    ds_read_b128 v[164:167], v196 offset:0
    ds_read_b64_tr_b16 v[160:161], v200 offset:40960
    ds_read_b64_tr_b16 v[162:163], v200 offset:41472
    v_mfma_f32_32x32x16_bf16 v[48:63], v[188:191], v[176:179], v[48:63]
    v_mfma_f32_32x32x16_bf16 v[64:79], v[188:191], v[184:187], v[64:79]
    s_waitcnt lgkmcnt(12)
    v_mfma_f32_32x32x16_bf16 v[16:31], v[244:247], v[240:243], v[16:31]
    s_nop 0
ST_A_45:
    s_cbranch_execz ST_C_45
    ds_read_b128 v[168:171], v196 offset:4096
    ds_read_b64_tr_b16 v[172:173], v201 offset:40960
    ds_read_b64_tr_b16 v[174:175], v201 offset:41472
    s_waitcnt lgkmcnt(14)
    v_mfma_f32_32x32x16_bf16 v[32:47], v[244:247], v[248:251], v[32:47]
    ds_read_b128 v[180:183], v197 offset:0
    s_waitcnt lgkmcnt(13)
    v_mfma_f32_32x32x16_bf16 v[48:63], v[252:255], v[240:243], v[48:63]
    ds_read_b64_tr_b16 v[176:177], v200 offset:45056
    ds_read_b64_tr_b16 v[178:179], v200 offset:45568
    v_mfma_f32_32x32x16_bf16 v[64:79], v[252:255], v[248:251], v[64:79]
    s_waitcnt lgkmcnt(12)
    v_mfma_f32_32x32x16_bf16 v[16:31], v[148:151], v[144:147], v[16:31]
    ds_read_b128 v[184:187], v197 offset:4096
    ds_read_b64_tr_b16 v[188:189], v201 offset:45056
    ds_read_b64_tr_b16 v[190:191], v201 offset:45568
    s_waitcnt lgkmcnt(14)
    v_mfma_f32_32x32x16_bf16 v[32:47], v[148:151], v[152:155], v[32:47]
    s_waitcnt lgkmcnt(12)
    s_barrier
    ds_read_b128 v[244:247], v198 offset:0
    ds_read_b64_tr_b16 v[240:241], v200 offset:0
    ds_read_b64_tr_b16 v[242:243], v200 offset:512
    v_mfma_f32_32x32x16_bf16 v[48:63], v[156:159], v[144:147], v[48:63]
    v_mfma_f32_32x32x16_bf16 v[64:79], v[156:159], v[152:155], v[64:79]
    s_waitcnt lgkmcnt(12)
    v_mfma_f32_32x32x16_bf16 v[16:31], v[160:163], v[164:167], v[16:31]
    ds_read_b128 v[248:251], v198 offset:4096
    ds_read_b64_tr_b16 v[252:253], v201 offset:0
    ds_read_b64_tr_b16 v[254:255], v201 offset:512
    s_waitcnt lgkmcnt(14)
    v_mfma_f32_32x32x16_bf16 v[32:47], v[160:163], v[168:171], v[32:47]
    ds_read_b128 v[148:151], v199 offset:0
    s_waitcnt lgkmcnt(13)
    v_mfma_f32_32x32x16_bf16 v[48:63], v[172:175], v[164:167], v[48:63]
    ds_read_b64_tr_b16 v[144:145], v200 offset:4096
ST_A_46:
    s_cbranch_execz ST_C_46
    ds_read_b64_tr_b16 v[146:147], v200 offset:4608
    v_mfma_f32_32x32x16_bf16 v[64:79], v[172:175], v[168:171], v[64:79]
    s_waitcnt lgkmcnt(12)
    v_mfma_f32_32x32x16_bf16 v[16:31], v[176:179], v[180:183], v[16:31]
    ds_read_b128 v[152:155], v199 offset:4096
    ds_read_b64_tr_b16 v[156:157], v201 offset:4096
    ds_read_b64_tr_b16 v[158:159], v201 offset:4608
    s_waitcnt lgkmcnt(14)
    v_mfma_f32_32x32x16_bf16 v[32:47], v[176:179], v[184:187], v[32:47]
    s_waitcnt lgkmcnt(12)
    s_barrier
    ds_read_b128 v[160:163], v196 offset:16384
    ds_read_b64_tr_b16 v[164:165], v200 offset:8192
    ds_read_b64_tr_b16 v[166:167], v200 offset:8704
    v_mfma_f32_32x32x16_bf16 v[48:63], v[188:191], v[180:183], v[48:63]
    v_mfma_f32_32x32x16_bf16 v[64:79], v[188:191], v[184:187], v[64:79]
    s_waitcnt lgkmcnt(12)
    v_mfma_f32_32x32x16_bf16 v[16:31], v[240:243], v[244:247], v[16:31]
    ds_read_b128 v[168:171], v196 offset:20480
    ds_read_b128 v[172:175], v197 offset:16384
    s_waitcnt lgkmcnt(13)
    v_mfma_f32_32x32x16_bf16 v[32:47], v[240:243], v[248:251], v[32:47]
    ds_read_b64_tr_b16 v[176:177], v200 offset:12288
    ds_read_b64_tr_b16 v[178:179], v200 offset:12800
    s_waitcnt lgkmcnt(13)
    v_mfma_f32_32x32x16_bf16 v[48:63], v[252:255], v[244:247], v[48:63]
    ds_read_b128 v[180:183], v197 offset:20480
    s_waitcnt lgkmcnt(8)
    s_barrier
    ds_read_b128 v[184:187], v198 offset:16384
    v_mfma_f32_32x32x16_bf16 v[64:79], v[252:255], v[248:251], v[64:79]
    ds_read_b64_tr_b16 v[188:189], v200 offset:16384
    ds_read_b64_tr_b16 v[190:191], v200 offset:16896
    v_mfma_f32_32x32x16_bf16 v[16:31], v[144:147], v[148:151], v[16:31]
    ds_read_b128 v[240:243], v198 offset:20480
    ds_read_b128 v[244:247], v199 offset:16384
ST_A_47:
    s_cbranch_execz ST_C_47
    v_mfma_f32_32x32x16_bf16 v[32:47], v[144:147], v[152:155], v[32:47]
    ds_read_b64_tr_b16 v[248:249], v200 offset:20480
    ds_read_b64_tr_b16 v[250:251], v200 offset:20992
    v_mfma_f32_32x32x16_bf16 v[48:63], v[156:159], v[148:151], v[48:63]
    v_mfma_f32_32x32x16_bf16 v[64:79], v[156:159], v[152:155], v[64:79]
    s_waitcnt lgkmcnt(12)
    v_mfma_f32_32x32x16_bf16 v[16:31], v[164:167], v[160:163], v[16:31]
    ds_read_b128 v[252:255], v199 offset:20480
    s_waitcnt lgkmcnt(8)
    s_barrier
    ds_read_b128 v[144:147], v196 offset:32768
    v_mfma_f32_32x32x16_bf16 v[32:47], v[164:167], v[168:171], v[32:47]
    ds_read_b64_tr_b16 v[148:149], v200 offset:24576
    ds_read_b64_tr_b16 v[150:151], v200 offset:25088
    v_mfma_f32_32x32x16_bf16 v[16:31], v[176:179], v[172:175], v[16:31]
    ds_read_b128 v[152:155], v196 offset:36864
    ds_read_b128 v[156:159], v197 offset:32768
    v_mfma_f32_32x32x16_bf16 v[32:47], v[176:179], v[180:183], v[32:47]
    ds_read_b64_tr_b16 v[160:161], v200 offset:28672
    ds_read_b64_tr_b16 v[162:163], v200 offset:29184
    s_waitcnt lgkmcnt(12)
    v_mfma_f32_32x32x16_bf16 v[16:31], v[188:191], v[184:187], v[16:31]
    ds_read_b128 v[164:167], v197 offset:36864
    s_waitcnt lgkmcnt(8)
    s_barrier
    ds_read_b128 v[168:171], v198 offset:32768
    v_mfma_f32_32x32x16_bf16 v[32:47], v[188:191], v[240:243], v[32:47]
    ds_read_b64_tr_b16 v[172:173], v200 offset:32768
    ds_read_b64_tr_b16 v[174:175], v200 offset:33280
    v_mfma_f32_32x32x16_bf16 v[16:31], v[248:251], v[244:247], v[16:31]
    ds_read_b128 v[176:179], v198 offset:36864
    ds_read_b128 v[180:183], v199 offset:32768
    v_mfma_f32_32x32x16_bf16 v[32:47], v[248:251], v[252:255], v[32:47]
    ds_read_b64_tr_b16 v[184:185], v200 offset:36864
    s_nop 0
ST_A_48:
    s_cbranch_execz ST_C_48
    ds_read_b64_tr_b16 v[186:187], v200 offset:37376
    s_waitcnt lgkmcnt(12)
    v_mfma_f32_32x32x16_bf16 v[16:31], v[148:151], v[144:147], v[16:31]
    ds_read_b128 v[188:191], v199 offset:36864
    ds_read_b128 v[240:243], v196 offset:16384
    s_waitcnt lgkmcnt(13)
    v_mfma_f32_32x32x16_bf16 v[32:47], v[148:151], v[152:155], v[32:47]
    ds_read_b64_tr_b16 v[244:245], v201 offset:8192
    ds_read_b64_tr_b16 v[246:247], v201 offset:8704
    s_waitcnt lgkmcnt(12)
    v_mfma_f32_32x32x16_bf16 v[16:31], v[160:163], v[156:159], v[16:31]
    ds_read_b128 v[248:251], v196 offset:20480
    ds_read_b128 v[252:255], v197 offset:16384
    s_waitcnt lgkmcnt(13)
    v_mfma_f32_32x32x16_bf16 v[32:47], v[160:163], v[164:167], v[32:47]
    ds_read_b64_tr_b16 v[144:145], v201 offset:12288
    ds_read_b64_tr_b16 v[146:147], v201 offset:12800
    s_waitcnt lgkmcnt(12)
    v_mfma_f32_32x32x16_bf16 v[16:31], v[172:175], v[168:171], v[16:31]
    ds_read_b128 v[148:151], v197 offset:20480
    ds_read_b128 v[152:155], v198 offset:16384
    s_waitcnt lgkmcnt(13)
    v_mfma_f32_32x32x16_bf16 v[32:47], v[172:175], v[176:179], v[32:47]
    ds_read_b64_tr_b16 v[156:157], v201 offset:16384
    ds_read_b64_tr_b16 v[158:159], v201 offset:16896
    s_waitcnt lgkmcnt(12)
    v_mfma_f32_32x32x16_bf16 v[16:31], v[184:187], v[180:183], v[16:31]
    ds_read_b128 v[160:163], v198 offset:20480
    ds_read_b128 v[164:167], v199 offset:16384
    s_waitcnt lgkmcnt(13)
    v_mfma_f32_32x32x16_bf16 v[32:47], v[184:187], v[188:191], v[32:47]
    ds_read_b64_tr_b16 v[168:169], v201 offset:20480
    ds_read_b64_tr_b16 v[170:171], v201 offset:20992
    s_waitcnt lgkmcnt(12)
    v_mfma_f32_32x32x16_bf16 v[48:63], v[244:247], v[240:243], v[48:63]
    ds_read_b128 v[172:175], v199 offset:20480
ST_A_49:
    s_cbranch_execz ST_C_49
    ds_read_b128 v[176:179], v196 offset:32768
    s_nop 1
    v_pk_mul_f32 v[204:205], v[16:17], s[54:55] op_sel:[0,1] op_sel_hi:[1,1]
    v_pk_mul_f32 v[206:207], v[18:19], s[54:55] op_sel:[0,1] op_sel_hi:[1,1]
    v_pk_mul_f32 v[208:209], v[20:21], s[54:55] op_sel:[0,1] op_sel_hi:[1,1]
    v_pk_mul_f32 v[210:211], v[22:23], s[54:55] op_sel:[0,1] op_sel_hi:[1,1]
    v_exp_f32 v204, v204
    v_exp_f32 v205, v205
    v_exp_f32 v206, v206
    v_exp_f32 v207, v207
    s_waitcnt lgkmcnt(13)
    v_mfma_f32_32x32x16_bf16 v[64:79], v[244:247], v[248:251], v[64:79]
    ds_read_b64_tr_b16 v[180:181], v201 offset:24576
    ds_read_b64_tr_b16 v[182:183], v201 offset:25088
    v_exp_f32 v208, v208
    v_exp_f32 v209, v209
    v_exp_f32 v210, v210
    s_waitcnt lgkmcnt(12)
    v_mfma_f32_32x32x16_bf16 v[48:63], v[144:147], v[252:255], v[48:63]
    ds_read_b128 v[184:187], v196 offset:36864
    ds_read_b128 v[188:191], v197 offset:32768
    v_exp_f32 v211, v211
    v_pk_add_f32 v[204:205], v[204:205], s[48:49] op_sel_hi:[1,0]
    v_pk_add_f32 v[206:207], v[206:207], s[48:49] op_sel_hi:[1,0]
    v_pk_add_f32 v[208:209], v[208:209], s[48:49] op_sel_hi:[1,0]
    v_pk_add_f32 v[210:211], v[210:211], s[48:49] op_sel_hi:[1,0]
    s_waitcnt lgkmcnt(13)
    v_mfma_f32_32x32x16_bf16 v[64:79], v[144:147], v[148:151], v[64:79]
    ds_read_b64_tr_b16 v[240:241], v201 offset:28672
    ds_read_b64_tr_b16 v[242:243], v201 offset:29184
    v_rcp_f32 v204, v204
    v_rcp_f32 v205, v205
    v_rcp_f32 v206, v206
    s_waitcnt lgkmcnt(12)
    v_mfma_f32_32x32x16_bf16 v[48:63], v[156:159], v[152:155], v[48:63]
    ds_read_b128 v[244:247], v197 offset:36864
    ds_read_b128 v[248:251], v198 offset:32768
    v_rcp_f32 v207, v207
    v_rcp_f32 v208, v208
    v_rcp_f32 v209, v209
    s_waitcnt lgkmcnt(13)
    s_nop 0
ST_A_50:
    s_cbranch_execz ST_C_50
    v_mfma_f32_32x32x16_bf16 v[64:79], v[156:159], v[160:163], v[64:79]
    ds_read_b64_tr_b16 v[252:253], v201 offset:32768
    ds_read_b64_tr_b16 v[254:255], v201 offset:33280
    v_rcp_f32 v210, v210
    v_rcp_f32 v211, v211
    v_pk_mul_f32 v[204:205], v[204:205], v[24:25]
    v_pk_mul_f32 v[206:207], v[206:207], v[26:27]
    s_waitcnt lgkmcnt(12)
    v_mfma_f32_32x32x16_bf16 v[48:63], v[168:171], v[164:167], v[48:63]
    ds_read_b128 v[144:147], v198 offset:36864
    ds_read_b128 v[148:151], v199 offset:32768
    v_pk_mul_f32 v[208:209], v[208:209], v[28:29]
    v_pk_mul_f32 v[210:211], v[210:211], v[30:31]
    v_cvt_pk_bf16_f32 v212, v204, v205
    v_cvt_pk_bf16_f32 v213, v206, v207
    v_cvt_pk_bf16_f32 v214, v208, v209
    s_waitcnt lgkmcnt(13)
    v_mfma_f32_32x32x16_bf16 v[64:79], v[168:171], v[172:175], v[64:79]
    ds_read_b64_tr_b16 v[152:153], v201 offset:36864
    ds_read_b64_tr_b16 v[154:155], v201 offset:37376
    v_cvt_pk_bf16_f32 v215, v210, v211
    buffer_store_dwordx4 v[212:215], v228, s[32:35], s58 offen offset:0 sc1
    v_pk_mul_f32 v[216:217], v[32:33], s[54:55] op_sel:[0,1] op_sel_hi:[1,1]
    v_pk_mul_f32 v[218:219], v[34:35], s[54:55] op_sel:[0,1] op_sel_hi:[1,1]
    v_pk_mul_f32 v[220:221], v[36:37], s[54:55] op_sel:[0,1] op_sel_hi:[1,1]
    s_waitcnt lgkmcnt(12)
    v_mfma_f32_32x32x16_bf16 v[48:63], v[180:183], v[176:179], v[48:63]
    ds_read_b128 v[156:159], v199 offset:36864
    v_pk_mul_f32 v[222:223], v[38:39], s[54:55] op_sel:[0,1] op_sel_hi:[1,1]
    v_exp_f32 v216, v216
    v_exp_f32 v217, v217
    s_waitcnt lgkmcnt(12)
    v_mfma_f32_32x32x16_bf16 v[64:79], v[180:183], v[184:187], v[64:79]
    v_exp_f32 v218, v218
    v_exp_f32 v219, v219
    v_exp_f32 v220, v220
    s_waitcnt lgkmcnt(9)
    s_nop 0
ST_A_51:
    s_cbranch_execz ST_C_51
    v_mfma_f32_32x32x16_bf16 v[48:63], v[240:243], v[188:191], v[48:63]
    v_exp_f32 v221, v221
    v_exp_f32 v222, v222
    v_exp_f32 v223, v223
    v_pk_add_f32 v[216:217], v[216:217], s[48:49] op_sel_hi:[1,0]
    s_waitcnt lgkmcnt(8)
    v_mfma_f32_32x32x16_bf16 v[64:79], v[240:243], v[244:247], v[64:79]
    v_pk_add_f32 v[218:219], v[218:219], s[48:49] op_sel_hi:[1,0]
    v_pk_add_f32 v[220:221], v[220:221], s[48:49] op_sel_hi:[1,0]
    v_pk_add_f32 v[222:223], v[222:223], s[48:49] op_sel_hi:[1,0]
    v_rcp_f32 v216, v216
    s_waitcnt lgkmcnt(5)
    v_mfma_f32_32x32x16_bf16 v[48:63], v[252:255], v[248:251], v[48:63]
    v_rcp_f32 v217, v217
    v_rcp_f32 v218, v218
    v_rcp_f32 v219, v219
    s_waitcnt lgkmcnt(4)
    v_mfma_f32_32x32x16_bf16 v[64:79], v[252:255], v[144:147], v[64:79]
    v_rcp_f32 v220, v220
    v_rcp_f32 v221, v221
    v_rcp_f32 v222, v222
    s_waitcnt lgkmcnt(1)
    v_mfma_f32_32x32x16_bf16 v[48:63], v[152:155], v[148:151], v[48:63]
    v_rcp_f32 v223, v223
    v_pk_mul_f32 v[216:217], v[216:217], v[40:41]
    v_pk_mul_f32 v[218:219], v[218:219], v[42:43]
    v_pk_mul_f32 v[220:221], v[220:221], v[44:45]
    v_pk_mul_f32 v[222:223], v[222:223], v[46:47]
    s_waitcnt lgkmcnt(0)
    v_mfma_f32_32x32x16_bf16 v[64:79], v[152:155], v[156:159], v[64:79]
    v_cvt_pk_bf16_f32 v224, v216, v217
    v_cvt_pk_bf16_f32 v225, v218, v219
    v_cvt_pk_bf16_f32 v226, v220, v221
    v_cvt_pk_bf16_f32 v227, v222, v223
    buffer_store_dwordx4 v[224:227], v228, s[32:35], s59 offen offset:0 sc1
    v_pk_mul_f32 v[204:205], v[48:49], s[54:55] op_sel:[0,1] op_sel_hi:[1,1]
    v_pk_mul_f32 v[206:207], v[50:51], s[54:55] op_sel:[0,1] op_sel_hi:[1,1]
    v_pk_mul_f32 v[208:209], v[52:53], s[54:55] op_sel:[0,1] op_sel_hi:[1,1]
    v_pk_mul_f32 v[210:211], v[54:55], s[54:55] op_sel:[0,1] op_sel_hi:[1,1]
    v_exp_f32 v204, v204
ST_A_52:
    s_cbranch_execz ST_C_52
    v_exp_f32 v205, v205
    v_exp_f32 v206, v206
    v_exp_f32 v207, v207
    v_exp_f32 v208, v208
    v_exp_f32 v209, v209
    v_exp_f32 v210, v210
    v_exp_f32 v211, v211
    v_pk_add_f32 v[204:205], v[204:205], s[48:49] op_sel_hi:[1,0]
    v_pk_add_f32 v[206:207], v[206:207], s[48:49] op_sel_hi:[1,0]
    v_pk_add_f32 v[208:209], v[208:209], s[48:49] op_sel_hi:[1,0]
    v_pk_add_f32 v[210:211], v[210:211], s[48:49] op_sel_hi:[1,0]
    v_rcp_f32 v204, v204
    v_rcp_f32 v205, v205
    v_rcp_f32 v206, v206
    v_rcp_f32 v207, v207
    v_rcp_f32 v208, v208
    v_rcp_f32 v209, v209
    v_rcp_f32 v210, v210
    v_rcp_f32 v211, v211
    v_pk_mul_f32 v[204:205], v[204:205], v[56:57]
    v_pk_mul_f32 v[206:207], v[206:207], v[58:59]
    v_pk_mul_f32 v[208:209], v[208:209], v[60:61]
    v_pk_mul_f32 v[210:211], v[210:211], v[62:63]
    v_cvt_pk_bf16_f32 v212, v204, v205
    v_cvt_pk_bf16_f32 v213, v206, v207
    v_cvt_pk_bf16_f32 v214, v208, v209
    v_cvt_pk_bf16_f32 v215, v210, v211
    buffer_store_dwordx4 v[212:215], v228, s[32:35], s58 offen offset:1024 sc1
    v_pk_mul_f32 v[216:217], v[64:65], s[54:55] op_sel:[0,1] op_sel_hi:[1,1]
    v_pk_mul_f32 v[218:219], v[66:67], s[54:55] op_sel:[0,1] op_sel_hi:[1,1]
    v_pk_mul_f32 v[220:221], v[68:69], s[54:55] op_sel:[0,1] op_sel_hi:[1,1]
    v_pk_mul_f32 v[222:223], v[70:71], s[54:55] op_sel:[0,1] op_sel_hi:[1,1]
    v_exp_f32 v216, v216
    v_exp_f32 v217, v217
    v_exp_f32 v218, v218
    v_exp_f32 v219, v219
    v_exp_f32 v220, v220
    v_exp_f32 v221, v221
    v_exp_f32 v222, v222
    v_exp_f32 v223, v223
    v_pk_add_f32 v[216:217], v[216:217], s[48:49] op_sel_hi:[1,0]
    v_pk_add_f32 v[218:219], v[218:219], s[48:49] op_sel_hi:[1,0]
    v_pk_add_f32 v[220:221], v[220:221], s[48:49] op_sel_hi:[1,0]
ST_A_53:
    s_cbranch_execz ST_C_53
    v_pk_add_f32 v[222:223], v[222:223], s[48:49] op_sel_hi:[1,0]
    v_rcp_f32 v216, v216
    v_rcp_f32 v217, v217
    v_rcp_f32 v218, v218
    v_rcp_f32 v219, v219
    v_rcp_f32 v220, v220
    v_rcp_f32 v221, v221
    v_rcp_f32 v222, v222
    v_rcp_f32 v223, v223
    v_pk_mul_f32 v[216:217], v[216:217], v[72:73]
    v_pk_mul_f32 v[218:219], v[218:219], v[74:75]
    v_pk_mul_f32 v[220:221], v[220:221], v[76:77]
    v_pk_mul_f32 v[222:223], v[222:223], v[78:79]
    v_cvt_pk_bf16_f32 v224, v216, v217
    v_cvt_pk_bf16_f32 v225, v218, v219
    v_cvt_pk_bf16_f32 v226, v220, v221
    v_cvt_pk_bf16_f32 v227, v222, v223
    buffer_store_dwordx4 v[224:227], v228, s[32:35], s59 offen offset:1024 sc1
    s_endpgm
K1_LD1:
    s_mul_i32 s46, s42, 21504
    s_lshl_b32 s8, s41, 7
    s_add_u32 s46, s46, s8
    s_add_u32 s46, s46, 1792
    s_add_u32 m0, s45, 0
    s_lshl_b32 s11, s72, 7
    s_add_u32 s11, s11, s43
    buffer_load_dwordx4 v2, s[36:39], s11 offen lds
    s_add_u32 m0, s45, 4096
    s_lshl_b32 s11, s72, 7
    s_add_u32 s11, s11, s43
    s_add_u32 s11, s11, 28672
    buffer_load_dwordx4 v2, s[36:39], s11 offen lds
    s_add_u32 m0, s45, 8192
    s_lshl_b32 s11, s72, 7
    s_add_u32 s11, s11, s43
    s_add_u32 s11, s11, 57344
    buffer_load_dwordx4 v2, s[36:39], s11 offen lds
    s_add_u32 m0, s45, 12288
    s_lshl_b32 s11, s72, 7
    s_add_u32 s11, s11, s43
    s_add_u32 s11, s11, 86016
    s_nop 0
ST_A_54:
    s_cbranch_execz ST_C_54
    buffer_load_dwordx4 v2, s[36:39], s11 offen lds
    s_mul_i32 s13, s72, 172032
    s_add_u32 s13, s13, s46
    s_add_u32 m0, s44, 0
    s_add_u32 s11, s13, 0
    buffer_load_dwordx4 v9, s[52:55], s11 offen lds
    s_add_u32 m0, s44, 4096
    s_add_u32 s11, s13, 43008
    buffer_load_dwordx4 v9, s[52:55], s11 offen lds
    s_mul_i32 s13, s72, 172032
    s_add_u32 s13, s13, s46
    s_add_u32 m0, s44, 8192
    s_add_u32 s11, s13, 86016
    buffer_load_dwordx4 v9, s[52:55], s11 offen lds
    s_add_u32 m0, s44, 12288
    s_add_u32 s11, s13, 129024
    buffer_load_dwordx4 v9, s[52:55], s11 offen lds
    s_add_u32 s73, s72, 1
    s_cmp_eq_u32 s73, 7
    s_cselect_b32 s73, 0, s73
    s_add_u32 m0, s45, 16384
    s_lshl_b32 s11, s73, 7
    s_add_u32 s11, s11, s43
    buffer_load_dwordx4 v2, s[36:39], s11 offen lds
    s_add_u32 m0, s45, 20480
    s_lshl_b32 s11, s73, 7
    s_add_u32 s11, s11, s43
    s_add_u32 s11, s11, 28672
    buffer_load_dwordx4 v2, s[36:39], s11 offen lds
    s_add_u32 m0, s45, 24576
    s_lshl_b32 s11, s73, 7
    s_add_u32 s11, s11, s43
    s_add_u32 s11, s11, 57344
    buffer_load_dwordx4 v2, s[36:39], s11 offen lds
    s_add_u32 m0, s45, 28672
    s_lshl_b32 s11, s73, 7
    s_add_u32 s11, s11, s43
    s_add_u32 s11, s11, 86016
    buffer_load_dwordx4 v2, s[36:39], s11 offen lds
ST_A_55:
    s_cbranch_execz K1_CONS
    s_mul_i32 s13, s73, 172032
    s_add_u32 s13, s13, s46
    s_add_u32 m0, s44, 16384
    s_add_u32 s11, s13, 0
    buffer_load_dwordx4 v9, s[52:55], s11 offen lds
    s_add_u32 m0, s44, 20480
    s_add_u32 s11, s13, 43008
    buffer_load_dwordx4 v9, s[52:55], s11 offen lds
    s_mul_i32 s13, s73, 172032
    s_add_u32 s13, s13, s46
    s_add_u32 m0, s44, 24576
    s_add_u32 s11, s13, 86016
    buffer_load_dwordx4 v9, s[52:55], s11 offen lds
    s_add_u32 m0, s44, 28672
    s_add_u32 s11, s13, 129024
    buffer_load_dwordx4 v9, s[52:55], s11 offen lds
    v_lshl_add_u32 v20, v1, 4, s44
    s_waitcnt vmcnt(10)
    s_barrier
    s_add_u32 s74, s73, 1
    s_cmp_eq_u32 s74, 7
    s_cselect_b32 s74, 0, s74
    s_mul_i32 s13, s74, 172032
    s_add_u32 s13, s13, s46
    s_add_u32 m0, s44, 32768
    s_add_u32 s11, s13, 0
    buffer_load_dwordx4 v9, s[52:55], s11 offen lds
    s_add_u32 m0, s44, 36864
    s_add_u32 s11, s13, 43008
    buffer_load_dwordx4 v9, s[52:55], s11 offen lds
    s_add_u32 m0, s45, 32768
    s_lshl_b32 s11, s74, 7
    s_add_u32 s11, s11, s43
    buffer_load_dwordx4 v2, s[36:39], s11 offen lds
    s_add_u32 m0, s45, 36864
    s_lshl_b32 s11, s74, 7
    s_add_u32 s11, s11, s43
    s_add_u32 s11, s11, 28672
    s_nop 0
ST_A_56:
    s_cbranch_execz K1_CONS
    buffer_load_dwordx4 v2, s[36:39], s11 offen lds
    s_add_u32 m0, s45, 40960
    s_lshl_b32 s11, s74, 7
    s_add_u32 s11, s11, s43
    s_add_u32 s11, s11, 57344
    buffer_load_dwordx4 v2, s[36:39], s11 offen lds
    s_waitcnt vmcnt(13)
    s_barrier
    s_mul_i32 s13, s74, 172032
    s_add_u32 s13, s13, s46
    s_add_u32 m0, s44, 40960
    s_add_u32 s11, s13, 86016
    buffer_load_dwordx4 v9, s[52:55], s11 offen lds
    s_add_u32 m0, s44, 45056
    s_add_u32 s11, s13, 129024
    buffer_load_dwordx4 v9, s[52:55], s11 offen lds
    s_add_u32 m0, s45, 45056
    s_lshl_b32 s11, s74, 7
    s_add_u32 s11, s11, s43
    s_add_u32 s11, s11, 86016
    buffer_load_dwordx4 v2, s[36:39], s11 offen lds
    s_add_u32 s75, s74, 1
    s_cmp_eq_u32 s75, 7
    s_cselect_b32 s75, 0, s75
    s_add_u32 m0, s45, 49152
    s_lshl_b32 s11, s75, 7
    s_add_u32 s11, s11, s43
    buffer_load_dwordx4 v2, s[36:39], s11 offen lds
    s_add_u32 m0, s45, 53248
    s_lshl_b32 s11, s75, 7
    s_add_u32 s11, s11, s43
    s_add_u32 s11, s11, 28672
    buffer_load_dwordx4 v2, s[36:39], s11 offen lds
    s_waitcnt vmcnt(12)
    s_barrier
    s_mul_i32 s13, s75, 172032
    s_add_u32 s13, s13, s46
    s_add_u32 m0, s44, 0
    s_add_u32 s11, s13, 0
    buffer_load_dwordx4 v9, s[52:55], s11 offen lds
    s_add_u32 m0, s44, 4096
ST_A_57:
    s_cbranch_execz K1_CONS
    s_add_u32 s11, s13, 43008
    buffer_load_dwordx4 v9, s[52:55], s11 offen lds
    s_add_u32 m0, s45, 57344
    s_lshl_b32 s11, s75, 7
    s_add_u32 s11, s11, s43
    s_add_u32 s11, s11, 57344
    buffer_load_dwordx4 v2, s[36:39], s11 offen lds
    s_add_u32 m0, s45, 61440
    s_lshl_b32 s11, s75, 7
    s_add_u32 s11, s11, s43
    s_add_u32 s11, s11, 86016
    buffer_load_dwordx4 v2, s[36:39], s11 offen lds
    s_add_u32 s76, s75, 1
    s_cmp_eq_u32 s76, 7
    s_cselect_b32 s76, 0, s76
    s_add_u32 m0, s45, 65536
    s_lshl_b32 s11, s76, 7
    s_add_u32 s11, s11, s43
    buffer_load_dwordx4 v2, s[36:39], s11 offen lds
    s_waitcnt vmcnt(15)
    s_barrier
    s_mul_i32 s13, s75, 172032
    s_add_u32 s13, s13, s46
    s_add_u32 m0, s44, 8192
    s_add_u32 s11, s13, 86016
    buffer_load_dwordx4 v9, s[52:55], s11 offen lds
    s_add_u32 m0, s44, 12288
    s_add_u32 s11, s13, 129024
    buffer_load_dwordx4 v9, s[52:55], s11 offen lds
    s_add_u32 m0, s45, 69632
    s_lshl_b32 s11, s76, 7
    s_add_u32 s11, s11, s43
    s_add_u32 s11, s11, 28672
    buffer_load_dwordx4 v2, s[36:39], s11 offen lds
    s_add_u32 m0, s45, 73728
    s_lshl_b32 s11, s76, 7
    s_add_u32 s11, s11, s43
    s_add_u32 s11, s11, 57344
    buffer_load_dwordx4 v2, s[36:39], s11 offen lds
    s_nop 0
ST_A_58:
    s_cbranch_execz K1_CONS
    s_add_u32 m0, s45, 77824
    s_lshl_b32 s11, s76, 7
    s_add_u32 s11, s11, s43
    s_add_u32 s11, s11, 86016
    buffer_load_dwordx4 v2, s[36:39], s11 offen lds
    s_waitcnt vmcnt(12)
    s_barrier
    s_mul_i32 s13, s76, 172032
    s_add_u32 s13, s13, s46
    s_add_u32 m0, s44, 16384
    s_add_u32 s11, s13, 0
    buffer_load_dwordx4 v9, s[52:55], s11 offen lds
    s_add_u32 m0, s44, 20480
    s_add_u32 s11, s13, 43008
    buffer_load_dwordx4 v9, s[52:55], s11 offen lds
    s_add_u32 s77, s76, 1
    s_cmp_eq_u32 s77, 7
    s_cselect_b32 s77, 0, s77
    s_add_u32 m0, s45, 81920
    s_lshl_b32 s11, s77, 7
    s_add_u32 s11, s11, s43
    buffer_load_dwordx4 v2, s[36:39], s11 offen lds
    s_add_u32 m0, s45, 86016
    s_lshl_b32 s11, s77, 7
    s_add_u32 s11, s11, s43
    s_add_u32 s11, s11, 28672
    buffer_load_dwordx4 v2, s[36:39], s11 offen lds
    s_add_u32 m0, s45, 90112
    s_lshl_b32 s11, s77, 7
    s_add_u32 s11, s11, s43
    s_add_u32 s11, s11, 57344
    buffer_load_dwordx4 v2, s[36:39], s11 offen lds
    s_barrier
    s_mul_i32 s13, s76, 172032
    s_add_u32 s13, s13, s46
    s_add_u32 m0, s44, 24576
    s_add_u32 s11, s13, 86016
    buffer_load_dwordx4 v9, s[52:55], s11 offen lds
    s_add_u32 m0, s44, 28672
    s_add_u32 s11, s13, 129024
ST_A_59:
    s_cbranch_execz K1_CONS
    buffer_load_dwordx4 v9, s[52:55], s11 offen lds
    s_add_u32 m0, s45, 94208
    s_lshl_b32 s11, s77, 7
    s_add_u32 s11, s11, s43
    s_add_u32 s11, s11, 86016
    buffer_load_dwordx4 v2, s[36:39], s11 offen lds
    s_add_u32 s78, s77, 1
    s_cmp_eq_u32 s78, 7
    s_cselect_b32 s78, 0, s78
    s_add_u32 m0, s45, 98304
    s_lshl_b32 s11, s78, 7
    s_add_u32 s11, s11, s43
    buffer_load_dwordx4 v2, s[36:39], s11 offen lds
    s_add_u32 m0, s45, 102400
    s_lshl_b32 s11, s78, 7
    s_add_u32 s11, s11, s43
    s_add_u32 s11, s11, 28672
    buffer_load_dwordx4 v2, s[36:39], s11 offen lds
    s_waitcnt vmcnt(16)
    s_barrier
    s_mul_i32 s13, s77, 172032
    s_add_u32 s13, s13, s46
    s_add_u32 m0, s44, 32768
    s_add_u32 s11, s13, 0
    buffer_load_dwordx4 v9, s[52:55], s11 offen lds
    s_add_u32 m0, s44, 36864
    s_add_u32 s11, s13, 43008
    buffer_load_dwordx4 v9, s[52:55], s11 offen lds
    s_add_u32 m0, s45, 106496
    s_lshl_b32 s11, s78, 7
    s_add_u32 s11, s11, s43
    s_add_u32 s11, s11, 57344
    buffer_load_dwordx4 v2, s[36:39], s11 offen lds
    s_add_u32 m0, s45, 110592
    s_lshl_b32 s11, s78, 7
    s_add_u32 s11, s11, s43
    s_add_u32 s11, s11, 86016
    buffer_load_dwordx4 v2, s[36:39], s11 offen lds
    s_waitcnt vmcnt(17)
    s_barrier
    s_mul_i32 s13, s77, 172032
ST_A_60:
    s_cbranch_execz K1_CONS
    s_add_u32 s13, s13, s46
    s_add_u32 m0, s44, 40960
    s_add_u32 s11, s13, 86016
    buffer_load_dwordx4 v9, s[52:55], s11 offen lds
    s_add_u32 m0, s44, 45056
    s_add_u32 s11, s13, 129024
    buffer_load_dwordx4 v9, s[52:55], s11 offen lds
    s_waitcnt vmcnt(14)
    s_barrier
    s_mul_i32 s13, s78, 172032
    s_add_u32 s13, s13, s46
    s_add_u32 m0, s44, 0
    s_add_u32 s11, s13, 0
    buffer_load_dwordx4 v9, s[52:55], s11 offen lds
    s_add_u32 m0, s44, 4096
    s_add_u32 s11, s13, 43008
    buffer_load_dwordx4 v9, s[52:55], s11 offen lds
    s_waitcnt vmcnt(11)
    s_barrier
    s_mul_i32 s13, s78, 172032
    s_add_u32 s13, s13, s46
    s_add_u32 m0, s44, 8192
    s_add_u32 s11, s13, 86016
    buffer_load_dwordx4 v9, s[52:55], s11 offen lds
    s_add_u32 m0, s44, 12288
    s_add_u32 s11, s13, 129024
    buffer_load_dwordx4 v9, s[52:55], s11 offen lds
    s_waitcnt vmcnt(8)
    s_barrier
    s_mul_i32 s13, s72, 172032
    s_add_u32 s13, s13, s46
    s_add_u32 m0, s44, 16384
    s_add_u32 s11, s13, 256
    buffer_load_dwordx4 v9, s[52:55], s11 offen lds
    s_add_u32 m0, s44, 20480
    s_add_u32 s11, s13, 43264
    buffer_load_dwordx4 v9, s[52:55], s11 offen lds
    s_nop 0
ST_A_61:
    s_cbranch_execz K1_CONS
    s_mul_i32 s13, s72, 172032
    s_add_u32 s13, s13, s46
    s_add_u32 s11, s13, 86272
    buffer_load_dwordx4 v[24:27], v9, s[52:55], s11 offen
    s_add_u32 s11, s13, 129280
    buffer_load_dwordx4 v[28:31], v9, s[52:55], s11 offen
    s_waitcnt vmcnt(8)
    s_barrier
    s_mul_i32 s13, s73, 172032
    s_add_u32 s13, s13, s46
    s_add_u32 s11, s13, 256
    buffer_load_dwordx4 v[32:35], v9, s[52:55], s11 offen
    s_add_u32 s11, s13, 43264
    buffer_load_dwordx4 v[36:39], v9, s[52:55], s11 offen
    s_mul_i32 s13, s73, 172032
    s_add_u32 s13, s13, s46
    s_add_u32 s11, s13, 86272
    buffer_load_dwordx4 v[40:43], v9, s[52:55], s11 offen
    s_add_u32 s11, s13, 129280
    buffer_load_dwordx4 v[44:47], v9, s[52:55], s11 offen
    s_waitcnt vmcnt(10)
    s_barrier
    s_mul_i32 s13, s74, 172032
    s_add_u32 s13, s13, s46
    s_add_u32 s11, s13, 256
    buffer_load_dwordx4 v[48:51], v9, s[52:55], s11 offen
    s_add_u32 s11, s13, 43264
    buffer_load_dwordx4 v[52:55], v9, s[52:55], s11 offen
    s_mul_i32 s13, s74, 172032
    s_add_u32 s13, s13, s46
    s_add_u32 s11, s13, 86272
    buffer_load_dwordx4 v[56:59], v9, s[52:55], s11 offen
    s_add_u32 s11, s13, 129280
    buffer_load_dwordx4 v[60:63], v9, s[52:55], s11 offen
    s_waitcnt vmcnt(12)
    s_barrier
    s_waitcnt vmcnt(8)
    s_nop 0
ST_A_62:
    s_cbranch_execz K1_CONS
    ds_write_b128 v20, v[24:27] offset:24576
    ds_write_b128 v20, v[28:31] offset:28672
    s_mul_i32 s13, s75, 172032
    s_add_u32 s13, s13, s46
    s_add_u32 s11, s13, 256
    buffer_load_dwordx4 v[64:67], v9, s[52:55], s11 offen
    s_add_u32 s11, s13, 43264
    buffer_load_dwordx4 v[68:71], v9, s[52:55], s11 offen
    s_mul_i32 s13, s75, 172032
    s_add_u32 s13, s13, s46
    s_add_u32 s11, s13, 86272
    buffer_load_dwordx4 v[72:75], v9, s[52:55], s11 offen
    s_add_u32 s11, s13, 129280
    buffer_load_dwordx4 v[76:79], v9, s[52:55], s11 offen
    s_barrier
    s_waitcnt vmcnt(10)
    ds_write_b128 v20, v[32:35] offset:32768
    ds_write_b128 v20, v[36:39] offset:36864
    s_mul_i32 s13, s76, 172032
    s_add_u32 s13, s13, s46
    s_add_u32 s11, s13, 256
    buffer_load_dwordx4 v[80:83], v9, s[52:55], s11 offen
    s_add_u32 s11, s13, 43264
    buffer_load_dwordx4 v[84:87], v9, s[52:55], s11 offen
    s_mul_i32 s13, s76, 172032
    s_add_u32 s13, s13, s46
    s_add_u32 s11, s13, 86272
    buffer_load_dwordx4 v[88:91], v9, s[52:55], s11 offen
    s_add_u32 s11, s13, 129280
    buffer_load_dwordx4 v[92:95], v9, s[52:55], s11 offen
    s_waitcnt lgkmcnt(0)
    s_barrier
    s_waitcnt vmcnt(12)
    ds_write_b128 v20, v[40:43] offset:40960
    ds_write_b128 v20, v[44:47] offset:45056
    s_mul_i32 s13, s77, 172032
ST_A_63:
    s_cbranch_execz K1_CONS
    s_add_u32 s13, s13, s46
    s_add_u32 s11, s13, 256
    buffer_load_dwordx4 v[104:107], v9, s[52:55], s11 offen
    s_add_u32 s11, s13, 43264
    buffer_load_dwordx4 v[108:111], v9, s[52:55], s11 offen
    s_mul_i32 s13, s77, 172032
    s_add_u32 s13, s13, s46
    s_add_u32 s11, s13, 86272
    buffer_load_dwordx4 v[112:115], v9, s[52:55], s11 offen
    s_add_u32 s11, s13, 129280
    buffer_load_dwordx4 v[116:119], v9, s[52:55], s11 offen
    s_barrier
    s_waitcnt vmcnt(14)
    ds_write_b128 v20, v[48:51] offset:0
    ds_write_b128 v20, v[52:55] offset:4096
    s_mul_i32 s13, s78, 172032
    s_add_u32 s13, s13, s46
    s_add_u32 s11, s13, 256
    buffer_load_dwordx4 v[120:123], v9, s[52:55], s11 offen
    s_add_u32 s11, s13, 43264
    buffer_load_dwordx4 v[124:127], v9, s[52:55], s11 offen
    s_mul_i32 s13, s78, 172032
    s_add_u32 s13, s13, s46
    s_add_u32 s11, s13, 86272
    buffer_load_dwordx4 v[128:131], v9, s[52:55], s11 offen
    s_add_u32 s11, s13, 129280
    buffer_load_dwordx4 v[132:135], v9, s[52:55], s11 offen
    s_lshl2_add_u32 s8, s2, s40
    s_min_u32 s8, s8, 1007
    s_mul_i32 s9, s8, 9363
    s_lshr_b32 s9, s9, 16
    s_mul_i32 s10, s9, 7
    s_sub_u32 s8, s8, s10
    s_mul_i32 s80, s8, 294912
    s_lshl_b32 s10, s9, 10
    s_add_u32 s80, s80, s10
    s_add_u32 s80, s80, 25165824
    s_nop 0
ST_A_64:
    s_cbranch_execz K1_CONS
    s_add_u32 s81, s80, 147456
    s_lshl_b32 s8, s8, 7
    s_mul_i32 s10, s9, 14336
    s_sub_u32 s11, s9, 112
    s_lshr_b32 s12, s11, 1
    s_mul_i32 s12, s12, 3584
    s_mul_i32 s11, s11, 14336
    s_sub_u32 s11, s11, s12
    s_mov_b32 s86, 1605632
    s_mov_b32 s87, 0x00020000
    s_cmp_lt_u32 s9, 112
    s_cselect_b32 s10, s10, s11
    s_cselect_b32 s86, s86, 401408
    s_cselect_b32 s84, s28, s20
    s_cselect_b32 s85, s29, s21
    s_add_u32 s8, s8, s10
    s_add_u32 s9, s8, 7168
    v_mul_u32_u24 v21, 896, v3
    v_lshl_add_u32 v21, v5, 4, v21
    buffer_load_dwordx4 v[248:251], v21, s[84:87], s8 offen
    buffer_load_dwordx4 v[252:255], v21, s[84:87], s9 offen
    s_lshl_b32 s8, s40, 11
    s_add_u32 s8, s8, 147456
    v_lshl_add_u32 v22, v1, 4, s8
    v_lshrrev_b32 v14, 5, v1
    v_bfe_u32 v15, v1, 2, 2
    v_lshl_add_u32 v14, v14, 2, v15
    v_bfe_u32 v15, v1, 4, 1
    v_lshlrev_b32 v15, 5, v15
    v_lshl_add_u32 v14, v14, 7, v15
    v_and_b32 v15, 3, v1
    v_lshl_add_u32 v14, v15, 3, v14
    v_add_u32 v23, s8, v14
    v_lshlrev_b32 v14, 4, v1
    s_waitcnt lgkmcnt(0)
    s_barrier
    s_waitcnt vmcnt(18)
    ds_write_b128 v20, v[56:59] offset:8192
    ds_write_b128 v20, v[60:63] offset:12288
    s_barrier
ST_A_65:
    s_cbranch_execz K1_CONS
    s_waitcnt vmcnt(16)
    ds_write_b128 v20, v[64:67] offset:16384
    ds_write_b128 v20, v[68:71] offset:20480
    s_waitcnt lgkmcnt(0)
    s_barrier
    s_waitcnt vmcnt(14)
    ds_write_b128 v20, v[72:75] offset:24576
    ds_write_b128 v20, v[76:79] offset:28672
    s_barrier
    s_waitcnt vmcnt(12)
    ds_write_b128 v20, v[80:83] offset:32768
    ds_write_b128 v20, v[84:87] offset:36864
    s_waitcnt lgkmcnt(0)
    s_barrier
    s_waitcnt vmcnt(10)
    ds_write_b128 v20, v[88:91] offset:40960
    ds_write_b128 v20, v[92:95] offset:45056
    s_barrier
    s_waitcnt vmcnt(8)
    ds_write_b128 v20, v[104:107] offset:0
    ds_write_b128 v20, v[108:111] offset:4096
    s_waitcnt lgkmcnt(0)
    s_barrier
    s_waitcnt vmcnt(6)
    ds_write_b128 v20, v[112:115] offset:8192
    ds_write_b128 v20, v[116:119] offset:12288
    s_barrier
    s_waitcnt vmcnt(4)
    ds_write_b128 v20, v[120:123] offset:16384
    ds_write_b128 v20, v[124:127] offset:20480
    v_mov_b32 v16, -1
    v_mov_b32 v17, -1
    v_mov_b32 v18, -1
    v_mov_b32 v19, -1
    v_lshlrev_b32 v12, 4, v1
    s_lshr_b32 s9, s2, 2
    s_mul_i32 s9, s9, 147456
    s_and_b32 s11, s2, 3
    s_lshl_b32 s11, s11, 2
    s_add_u32 s11, s11, s40
    s_lshl_b32 s11, s11, 11
    s_add_u32 s11, s11, s9
    s_add_u32 s11, s11, 8503296
    buffer_store_dwordx4 v[16:19], v12, s[32:35], s11 offen sc1
    buffer_store_dwordx4 v[16:19], v12, s[32:35], s11 offen offset:1024 sc1
ST_A_66:
    s_cbranch_execz K1_CONS
    s_waitcnt vmcnt(2)
    ds_write_b128 v22, v[248:251] offset:0
    ds_write_b128 v22, v[252:255] offset:1024
    s_waitcnt lgkmcnt(0)
    s_barrier
    ds_write_b128 v20, v[128:131] offset:24576
    ds_write_b128 v20, v[132:135] offset:28672
    s_waitcnt lgkmcnt(0)
    ds_read_b64_tr_b16 v[248:249], v23 offset:0
    ds_read_b64_tr_b16 v[250:251], v23 offset:1024
    ds_read_b64_tr_b16 v[252:253], v23 offset:64
    ds_read_b64_tr_b16 v[254:255], v23 offset:1088
    s_barrier
    s_waitcnt lgkmcnt(0)
    buffer_store_dwordx4 v[248:251], v14, s[32:35], s80 offen sc1
    buffer_store_dwordx4 v[252:255], v14, s[32:35], s81 offen sc1
    v_mov_b32 v16, 0x3f803f80
    v_mov_b32 v17, v16
    v_mov_b32 v18, v16
    v_mov_b32 v19, v16
    v_lshrrev_b32 v12, 4, v1
    v_lshlrev_b32 v12, 17, v12
    v_bfe_u32 v13, v1, 2, 2
    v_lshl_add_u32 v12, v13, 9, v12
    v_and_b32 v13, 3, v1
    v_lshl_add_u32 v12, v13, 4, v12
    s_lshl_b32 s9, s4, 2
    s_add_u32 s9, s9, s40
    s_lshl_b32 s11, s9, 11
    s_add_u32 s11, s11, 4194752
    s_add_u32 s12, s11, 524288
    buffer_store_dwordx4 v[16:19], v12, s[32:35], s11 offen sc1
    buffer_store_dwordx4 v[16:19], v12, s[32:35], s12 offen sc1
    s_waitcnt lgkmcnt(0)
    s_barrier
    s_endpgm
K1_LD2:
    s_mul_i32 s46, s42, 21504
    s_lshl_b32 s8, s41, 7
    s_add_u32 s46, s46, s8
    s_add_u32 s46, s46, 2304
    s_add_u32 m0, s45, 0
    s_lshl_b32 s11, s72, 7
    s_add_u32 s11, s11, s43
ST_A_67:
    s_cbranch_execz K1_CONS
    buffer_load_dwordx4 v2, s[36:39], s11 offen lds
    s_add_u32 m0, s45, 4096
    s_lshl_b32 s11, s72, 7
    s_add_u32 s11, s11, s43
    s_add_u32 s11, s11, 28672
    buffer_load_dwordx4 v2, s[36:39], s11 offen lds
    s_add_u32 m0, s45, 8192
    s_lshl_b32 s11, s72, 7
    s_add_u32 s11, s11, s43
    s_add_u32 s11, s11, 57344
    buffer_load_dwordx4 v2, s[36:39], s11 offen lds
    s_add_u32 m0, s45, 12288
    s_lshl_b32 s11, s72, 7
    s_add_u32 s11, s11, s43
    s_add_u32 s11, s11, 86016
    buffer_load_dwordx4 v2, s[36:39], s11 offen lds
    s_mul_i32 s13, s72, 172032
    s_add_u32 s13, s13, s46
    s_add_u32 m0, s44, 0
    s_add_u32 s11, s13, 0
    buffer_load_dwordx4 v9, s[52:55], s11 offen lds
    s_add_u32 m0, s44, 4096
    s_add_u32 s11, s13, 43008
    buffer_load_dwordx4 v9, s[52:55], s11 offen lds
    s_mul_i32 s13, s72, 172032
    s_add_u32 s13, s13, s46
    s_add_u32 m0, s44, 8192
    s_add_u32 s11, s13, 86016
    buffer_load_dwordx4 v9, s[52:55], s11 offen lds
    s_add_u32 m0, s44, 12288
    s_add_u32 s11, s13, 129024
    buffer_load_dwordx4 v9, s[52:55], s11 offen lds
    s_add_u32 s73, s72, 1
    s_cmp_eq_u32 s73, 7
    s_cselect_b32 s73, 0, s73
    s_add_u32 m0, s45, 16384
    s_lshl_b32 s11, s73, 7
    s_add_u32 s11, s11, s43
    buffer_load_dwordx4 v2, s[36:39], s11 offen lds
ST_A_68:
    s_cbranch_execz K1_CONS
    s_add_u32 m0, s45, 20480
    s_lshl_b32 s11, s73, 7
    s_add_u32 s11, s11, s43
    s_add_u32 s11, s11, 28672
    buffer_load_dwordx4 v2, s[36:39], s11 offen lds
    s_add_u32 m0, s45, 24576
    s_lshl_b32 s11, s73, 7
    s_add_u32 s11, s11, s43
    s_add_u32 s11, s11, 57344
    buffer_load_dwordx4 v2, s[36:39], s11 offen lds
    s_add_u32 m0, s45, 28672
    s_lshl_b32 s11, s73, 7
    s_add_u32 s11, s11, s43
    s_add_u32 s11, s11, 86016
    buffer_load_dwordx4 v2, s[36:39], s11 offen lds
    s_mul_i32 s13, s73, 172032
    s_add_u32 s13, s13, s46
    s_add_u32 m0, s44, 16384
    s_add_u32 s11, s13, 0
    buffer_load_dwordx4 v9, s[52:55], s11 offen lds
    s_add_u32 m0, s44, 20480
    s_add_u32 s11, s13, 43008
    buffer_load_dwordx4 v9, s[52:55], s11 offen lds
    v_lshl_add_u32 v20, v1, 4, s44
    s_waitcnt vmcnt(8)
    s_barrier
    s_mul_i32 s13, s73, 172032
    s_add_u32 s13, s13, s46
    s_add_u32 m0, s44, 24576
    s_add_u32 s11, s13, 86016
    buffer_load_dwordx4 v9, s[52:55], s11 offen lds
    s_add_u32 m0, s44, 28672
    s_add_u32 s11, s13, 129024
    buffer_load_dwordx4 v9, s[52:55], s11 offen lds
    s_add_u32 s74, s73, 1
    s_cmp_eq_u32 s74, 7
    s_cselect_b32 s74, 0, s74
    s_add_u32 m0, s45, 32768
    s_lshl_b32 s11, s74, 7
ST_A_69:
    s_cbranch_execz K1_CONS
    s_add_u32 s11, s11, s43
    buffer_load_dwordx4 v2, s[36:39], s11 offen lds
    s_add_u32 m0, s45, 36864
    s_lshl_b32 s11, s74, 7
    s_add_u32 s11, s11, s43
    s_add_u32 s11, s11, 28672
    buffer_load_dwordx4 v2, s[36:39], s11 offen lds
    s_add_u32 m0, s45, 40960
    s_lshl_b32 s11, s74, 7
    s_add_u32 s11, s11, s43
    s_add_u32 s11, s11, 57344
    buffer_load_dwordx4 v2, s[36:39], s11 offen lds
    s_waitcnt vmcnt(11)
    s_barrier
    s_mul_i32 s13, s74, 172032
    s_add_u32 s13, s13, s46
    s_add_u32 m0, s44, 32768
    s_add_u32 s11, s13, 0
    buffer_load_dwordx4 v9, s[52:55], s11 offen lds
    s_add_u32 m0, s44, 36864
    s_add_u32 s11, s13, 43008
    buffer_load_dwordx4 v9, s[52:55], s11 offen lds
    s_add_u32 m0, s45, 45056
    s_lshl_b32 s11, s74, 7
    s_add_u32 s11, s11, s43
    s_add_u32 s11, s11, 86016
    buffer_load_dwordx4 v2, s[36:39], s11 offen lds
    s_add_u32 s75, s74, 1
    s_cmp_eq_u32 s75, 7
    s_cselect_b32 s75, 0, s75
    s_add_u32 m0, s45, 49152
    s_lshl_b32 s11, s75, 7
    s_add_u32 s11, s11, s43
    buffer_load_dwordx4 v2, s[36:39], s11 offen lds
    s_add_u32 m0, s45, 53248
    s_lshl_b32 s11, s75, 7
    s_add_u32 s11, s11, s43
    s_add_u32 s11, s11, 28672
    buffer_load_dwordx4 v2, s[36:39], s11 offen lds
    s_waitcnt vmcnt(10)
    s_barrier
    s_nop 0
ST_A_70:
    s_cbranch_execz K1_CONS
    s_mul_i32 s13, s74, 172032
    s_add_u32 s13, s13, s46
    s_add_u32 m0, s44, 0
    s_add_u32 s11, s13, 86016
    buffer_load_dwordx4 v9, s[52:55], s11 offen lds
    s_add_u32 m0, s44, 4096
    s_add_u32 s11, s13, 129024
    buffer_load_dwordx4 v9, s[52:55], s11 offen lds
    s_add_u32 m0, s45, 57344
    s_lshl_b32 s11, s75, 7
    s_add_u32 s11, s11, s43
    s_add_u32 s11, s11, 57344
    buffer_load_dwordx4 v2, s[36:39], s11 offen lds
    s_add_u32 m0, s45, 61440
    s_lshl_b32 s11, s75, 7
    s_add_u32 s11, s11, s43
    s_add_u32 s11, s11, 86016
    buffer_load_dwordx4 v2, s[36:39], s11 offen lds
    s_add_u32 s76, s75, 1
    s_cmp_eq_u32 s76, 7
    s_cselect_b32 s76, 0, s76
    s_add_u32 m0, s45, 65536
    s_lshl_b32 s11, s76, 7
    s_add_u32 s11, s11, s43
    buffer_load_dwordx4 v2, s[36:39], s11 offen lds
    s_waitcnt vmcnt(13)
    s_barrier
    s_mul_i32 s13, s75, 172032
    s_add_u32 s13, s13, s46
    s_add_u32 m0, s44, 8192
    s_add_u32 s11, s13, 0
    buffer_load_dwordx4 v9, s[52:55], s11 offen lds
    s_add_u32 m0, s44, 12288
    s_add_u32 s11, s13, 43008
    buffer_load_dwordx4 v9, s[52:55], s11 offen lds
    s_add_u32 m0, s45, 69632
    s_lshl_b32 s11, s76, 7
    s_add_u32 s11, s11, s43
    s_add_u32 s11, s11, 28672
    buffer_load_dwordx4 v2, s[36:39], s11 offen lds
ST_A_71:
    s_cbranch_execz K1_CONS
    s_add_u32 m0, s45, 73728
    s_lshl_b32 s11, s76, 7
    s_add_u32 s11, s11, s43
    s_add_u32 s11, s11, 57344
    buffer_load_dwordx4 v2, s[36:39], s11 offen lds
    s_add_u32 m0, s45, 77824
    s_lshl_b32 s11, s76, 7
    s_add_u32 s11, s11, s43
    s_add_u32 s11, s11, 86016
    buffer_load_dwordx4 v2, s[36:39], s11 offen lds
    s_waitcnt vmcnt(12)
    s_barrier
    s_mul_i32 s13, s75, 172032
    s_add_u32 s13, s13, s46
    s_add_u32 m0, s44, 16384
    s_add_u32 s11, s13, 86016
    buffer_load_dwordx4 v9, s[52:55], s11 offen lds
    s_add_u32 m0, s44, 20480
    s_add_u32 s11, s13, 129024
    buffer_load_dwordx4 v9, s[52:55], s11 offen lds
    s_add_u32 s77, s76, 1
    s_cmp_eq_u32 s77, 7
    s_cselect_b32 s77, 0, s77
    s_add_u32 m0, s45, 81920
    s_lshl_b32 s11, s77, 7
    s_add_u32 s11, s11, s43
    buffer_load_dwordx4 v2, s[36:39], s11 offen lds
    s_add_u32 m0, s45, 86016
    s_lshl_b32 s11, s77, 7
    s_add_u32 s11, s11, s43
    s_add_u32 s11, s11, 28672
    buffer_load_dwordx4 v2, s[36:39], s11 offen lds
    s_add_u32 m0, s45, 90112
    s_lshl_b32 s11, s77, 7
    s_add_u32 s11, s11, s43
    s_add_u32 s11, s11, 57344
    buffer_load_dwordx4 v2, s[36:39], s11 offen lds
    s_waitcnt vmcnt(13)
    s_barrier
    s_mul_i32 s13, s76, 172032
    s_add_u32 s13, s13, s46
ST_A_72:
    s_cbranch_execz K1_CONS
    s_add_u32 m0, s44, 24576
    s_add_u32 s11, s13, 0
    buffer_load_dwordx4 v9, s[52:55], s11 offen lds
    s_add_u32 m0, s44, 28672
    s_add_u32 s11, s13, 43008
    buffer_load_dwordx4 v9, s[52:55], s11 offen lds
    s_add_u32 m0, s45, 94208
    s_lshl_b32 s11, s77, 7
    s_add_u32 s11, s11, s43
    s_add_u32 s11, s11, 86016
    buffer_load_dwordx4 v2, s[36:39], s11 offen lds
    s_add_u32 s78, s77, 1
    s_cmp_eq_u32 s78, 7
    s_cselect_b32 s78, 0, s78
    s_add_u32 m0, s45, 98304
    s_lshl_b32 s11, s78, 7
    s_add_u32 s11, s11, s43
    buffer_load_dwordx4 v2, s[36:39], s11 offen lds
    s_add_u32 m0, s45, 102400
    s_lshl_b32 s11, s78, 7
    s_add_u32 s11, s11, s43
    s_add_u32 s11, s11, 28672
    buffer_load_dwordx4 v2, s[36:39], s11 offen lds
    s_waitcnt vmcnt(13)
    s_barrier
    s_mul_i32 s13, s76, 172032
    s_add_u32 s13, s13, s46
    s_add_u32 m0, s44, 32768
    s_add_u32 s11, s13, 86016
    buffer_load_dwordx4 v9, s[52:55], s11 offen lds
    s_add_u32 m0, s44, 36864
    s_add_u32 s11, s13, 129024
    buffer_load_dwordx4 v9, s[52:55], s11 offen lds
    s_add_u32 m0, s45, 106496
    s_lshl_b32 s11, s78, 7
    s_add_u32 s11, s11, s43
    s_add_u32 s11, s11, 57344
    buffer_load_dwordx4 v2, s[36:39], s11 offen lds
    s_add_u32 m0, s45, 110592
ST_A_73:
    s_cbranch_execz K1_CONS
    s_lshl_b32 s11, s78, 7
    s_add_u32 s11, s11, s43
    s_add_u32 s11, s11, 86016
    buffer_load_dwordx4 v2, s[36:39], s11 offen lds
    s_waitcnt vmcnt(12)
    s_barrier
    s_mul_i32 s13, s77, 172032
    s_add_u32 s13, s13, s46
    s_add_u32 m0, s44, 0
    s_add_u32 s11, s13, 0
    buffer_load_dwordx4 v9, s[52:55], s11 offen lds
    s_add_u32 m0, s44, 4096
    s_add_u32 s11, s13, 43008
    buffer_load_dwordx4 v9, s[52:55], s11 offen lds
    s_waitcnt vmcnt(9)
    s_barrier
    s_mul_i32 s13, s77, 172032
    s_add_u32 s13, s13, s46
    s_add_u32 m0, s44, 8192
    s_add_u32 s11, s13, 86016
    buffer_load_dwordx4 v9, s[52:55], s11 offen lds
    s_add_u32 m0, s44, 12288
    s_add_u32 s11, s13, 129024
    buffer_load_dwordx4 v9, s[52:55], s11 offen lds
    s_waitcnt vmcnt(6)
    s_barrier
    s_mul_i32 s13, s78, 172032
    s_add_u32 s13, s13, s46
    s_add_u32 m0, s44, 16384
    s_add_u32 s11, s13, 0
    buffer_load_dwordx4 v9, s[52:55], s11 offen lds
    s_add_u32 m0, s44, 20480
    s_add_u32 s11, s13, 43008
    buffer_load_dwordx4 v9, s[52:55], s11 offen lds
    s_waitcnt vmcnt(4)
    s_barrier
    s_mul_i32 s13, s78, 172032
    s_add_u32 s13, s13, s46
    s_add_u32 m0, s44, 24576
    s_add_u32 s11, s13, 86016
ST_A_74:
    s_cbranch_execz K1_CONS
    buffer_load_dwordx4 v9, s[52:55], s11 offen lds
    s_add_u32 m0, s44, 28672
    s_add_u32 s11, s13, 129024
    buffer_load_dwordx4 v9, s[52:55], s11 offen lds
    s_mul_i32 s13, s72, 172032
    s_add_u32 s13, s13, s56
    s_add_u32 s11, s13, 0
    buffer_load_dwordx4 v[24:27], v9, s[52:55], s11 offen
    s_add_u32 s11, s13, 86016
    buffer_load_dwordx4 v[28:31], v9, s[52:55], s11 offen
    s_mov_b32 s68, s30
    s_mov_b32 s69, s31
    s_mov_b32 s70, 896
    s_mov_b32 s71, 0x00020000
    s_lshl_b32 s8, s72, 3
    v_add_u32 v12, s8, v1
    v_subrev_u32 v13, 56, v12
    v_cmp_gt_u32 vcc, 56, v12
    s_nop 1
    v_cndmask_b32 v12, v13, v12, vcc
    v_lshlrev_b32 v12, 4, v12
    s_add_u32 m0, s45, 155648
    s_nop 0
    buffer_load_dwordx4 v12, s[68:71], 0 offen lds
    s_waitcnt vmcnt(7)
    s_barrier
    s_mul_i32 s13, s73, 172032
    s_add_u32 s13, s13, s56
    s_add_u32 s11, s13, 0
    buffer_load_dwordx4 v[32:35], v9, s[52:55], s11 offen
    s_add_u32 s11, s13, 86016
    buffer_load_dwordx4 v[36:39], v9, s[52:55], s11 offen
    s_mul_i32 s13, s74, 172032
    s_add_u32 s13, s13, s56
    s_add_u32 s11, s13, 0
    buffer_load_dwordx4 v[40:43], v9, s[52:55], s11 offen
    s_add_u32 s11, s13, 86016
    buffer_load_dwordx4 v[44:47], v9, s[52:55], s11 offen
    s_waitcnt vmcnt(9)
    s_barrier
    s_waitcnt vmcnt(5)
    ds_write_b128 v20, v[24:27] offset:32768
ST_A_75:
    s_cbranch_execz K1_CONS
    ds_write_b128 v20, v[28:31] offset:36864
    s_mul_i32 s13, s75, 172032
    s_add_u32 s13, s13, s56
    s_add_u32 s11, s13, 0
    buffer_load_dwordx4 v[48:51], v9, s[52:55], s11 offen
    s_add_u32 s11, s13, 86016
    buffer_load_dwordx4 v[52:55], v9, s[52:55], s11 offen
    s_mul_i32 s13, s76, 172032
    s_add_u32 s13, s13, s56
    s_add_u32 s11, s13, 0
    buffer_load_dwordx4 v[56:59], v9, s[52:55], s11 offen
    s_add_u32 s11, s13, 86016
    buffer_load_dwordx4 v[60:63], v9, s[52:55], s11 offen
    s_barrier
    s_waitcnt vmcnt(6)
    ds_write_b128 v20, v[32:35] offset:0
    ds_write_b128 v20, v[36:39] offset:4096
    s_mul_i32 s13, s77, 172032
    s_add_u32 s13, s13, s56
    s_add_u32 s11, s13, 0
    buffer_load_dwordx4 v[64:67], v9, s[52:55], s11 offen
    s_add_u32 s11, s13, 86016
    buffer_load_dwordx4 v[68:71], v9, s[52:55], s11 offen
    s_mul_i32 s13, s78, 172032
    s_add_u32 s13, s13, s56
    s_add_u32 s11, s13, 0
    buffer_load_dwordx4 v[72:75], v9, s[52:55], s11 offen
    s_add_u32 s11, s13, 86016
    buffer_load_dwordx4 v[76:79], v9, s[52:55], s11 offen
    s_lshl2_add_u32 s8, s2, s40
    s_min_u32 s8, s8, 1007
    s_mul_i32 s9, s8, 9363
    s_lshr_b32 s9, s9, 16
    s_mul_i32 s10, s9, 7
    s_sub_u32 s8, s8, s10
    s_mul_i32 s80, s8, 294912
    s_lshl_b32 s10, s9, 10
    s_add_u32 s80, s80, s10
    s_add_u32 s80, s80, 25165824
    s_nop 0
ST_A_76:
    s_cbranch_execz K1_CONS
    s_add_u32 s81, s80, 147456
    s_lshl_b32 s8, s8, 7
    s_mul_i32 s10, s9, 14336
    s_sub_u32 s11, s9, 112
    s_lshr_b32 s12, s11, 1
    s_mul_i32 s12, s12, 3584
    s_mul_i32 s11, s11, 14336
    s_sub_u32 s11, s11, s12
    s_mov_b32 s86, 1605632
    s_mov_b32 s87, 0x00020000
    s_cmp_lt_u32 s9, 112
    s_cselect_b32 s10, s10, s11
    s_cselect_b32 s86, s86, 401408
    s_cselect_b32 s84, s28, s20
    s_cselect_b32 s85, s29, s21
    s_add_u32 s8, s8, s10
    s_add_u32 s9, s8, 7168
    v_mul_u32_u24 v21, 896, v3
    v_lshl_add_u32 v21, v5, 4, v21
    buffer_load_dwordx4 v[248:251], v21, s[84:87], s8 offen
    buffer_load_dwordx4 v[252:255], v21, s[84:87], s9 offen
    s_lshl_b32 s8, s40, 11
    s_add_u32 s8, s8, 122880
    v_lshl_add_u32 v22, v1, 4, s8
    v_lshrrev_b32 v14, 5, v1
    v_bfe_u32 v15, v1, 2, 2
    v_lshl_add_u32 v14, v14, 2, v15
    v_bfe_u32 v15, v1, 4, 1
    v_lshlrev_b32 v15, 5, v15
    v_lshl_add_u32 v14, v14, 7, v15
    v_and_b32 v15, 3, v1
    v_lshl_add_u32 v14, v15, 3, v14
    v_add_u32 v23, s8, v14
    v_lshlrev_b32 v14, 4, v1
    s_waitcnt lgkmcnt(0)
    s_barrier
    s_waitcnt vmcnt(10)
    ds_write_b128 v20, v[40:43] offset:8192
    ds_write_b128 v20, v[44:47] offset:12288
    s_barrier
ST_A_77:
    s_cbranch_execz K1_CONS
    s_waitcnt vmcnt(8)
    ds_write_b128 v20, v[48:51] offset:16384
    ds_write_b128 v20, v[52:55] offset:20480
    s_waitcnt lgkmcnt(0)
    s_barrier
    s_waitcnt vmcnt(6)
    ds_write_b128 v20, v[56:59] offset:24576
    ds_write_b128 v20, v[60:63] offset:28672
    s_barrier
    s_waitcnt vmcnt(4)
    ds_write_b128 v20, v[64:67] offset:32768
    ds_write_b128 v20, v[68:71] offset:36864
    v_mov_b32 v16, -1
    v_mov_b32 v17, -1
    v_mov_b32 v18, -1
    v_mov_b32 v19, -1
    v_lshlrev_b32 v12, 4, v1
    s_lshr_b32 s9, s2, 2
    s_mul_i32 s9, s9, 147456
    s_and_b32 s11, s2, 3
    s_lshl_b32 s11, s11, 2
    s_add_u32 s11, s11, s40
    s_lshl_b32 s11, s11, 11
    s_add_u32 s11, s11, s9
    s_add_u32 s11, s11, 8503296
    buffer_store_dwordx4 v[16:19], v12, s[32:35], s11 offen sc1
    buffer_store_dwordx4 v[16:19], v12, s[32:35], s11 offen offset:1024 sc1
    s_waitcnt lgkmcnt(0)
    s_barrier
    s_waitcnt vmcnt(4)
    ds_write_b128 v20, v[72:75] offset:0
    ds_write_b128 v20, v[76:79] offset:4096
    s_waitcnt vmcnt(2)
    ds_write_b128 v22, v[248:251] offset:0
    ds_write_b128 v22, v[252:255] offset:1024
    s_barrier
    s_waitcnt lgkmcnt(0)
    ds_read_b64_tr_b16 v[248:249], v23 offset:0
    ds_read_b64_tr_b16 v[250:251], v23 offset:1024
    ds_read_b64_tr_b16 v[252:253], v23 offset:64
    ds_read_b64_tr_b16 v[254:255], v23 offset:1088
    v_mov_b32 v16, 0x3f803f80
    v_mov_b32 v17, v16
    v_mov_b32 v18, v16
ST_A_78:
    s_cbranch_execz K1_CONS
    v_mov_b32 v19, v16
    v_lshrrev_b32 v12, 4, v1
    v_lshlrev_b32 v12, 17, v12
    v_bfe_u32 v13, v1, 2, 2
    v_lshl_add_u32 v12, v13, 9, v12
    v_and_b32 v13, 3, v1
    v_lshl_add_u32 v12, v13, 4, v12
    s_lshl_b32 s9, s4, 2
    s_add_u32 s9, s9, s40
    s_lshl_b32 s11, s9, 11
    s_add_u32 s11, s11, 5243328
    s_add_u32 s12, s11, 524288
    buffer_store_dwordx4 v[16:19], v12, s[32:35], s11 offen sc1
    buffer_store_dwordx4 v[16:19], v12, s[32:35], s12 offen sc1
    s_waitcnt lgkmcnt(0)
    s_barrier
    s_waitcnt lgkmcnt(0)
    buffer_store_dwordx4 v[248:251], v14, s[32:35], s80 offen sc1
    buffer_store_dwordx4 v[252:255], v14, s[32:35], s81 offen sc1
    s_endpgm
K1_CV:
    v_lshlrev_b32 v11, 1, v9
    v_xor_b32 v10, v6, v11
    s_lshl_b32 s8, s41, 11
    v_add_u32 v11, s8, v8
    v_lshl_add_u32 v200, v10, 5, v11
    v_xor_b32 v201, 64, v200
    s_lshl_b32 s52, s42, 11
    s_add_u32 s52, s52, 4194304
    s_add_u32 s53, s52, 2048
    s_sub_u32 s8, s5, 14
    s_lshl_b32 s9, s8, 8
    s_lshl_b32 s10, s41, 6
    s_add_u32 s9, s9, s10
    s_lshl_b32 s10, s41, 5
    s_add_u32 s10, s10, 384
    v_add_u32 v10, s9, v3
    v_add_u32 v10, 0, v10
    v_mul_u32_u24 v11, 2341, v10
    v_lshrrev_b32 v11, 16, v11
    v_mul_u32_u24 v12, 28, v11
    v_sub_u32 v10, v10, v12
    v_lshl_add_u32 v10, v4, 5, v10
    v_lshlrev_b32 v11, 17, v11
    v_lshl_add_u32 v230, v10, 4, v11
    v_add_u32 v10, s9, v3
    v_add_u32 v10, 32, v10
    s_nop 0
ST_A_79:
    s_cbranch_execz K1_CONS
    v_mul_u32_u24 v11, 2341, v10
    v_lshrrev_b32 v11, 16, v11
    v_mul_u32_u24 v12, 28, v11
    v_sub_u32 v10, v10, v12
    v_lshl_add_u32 v10, v4, 5, v10
    v_lshlrev_b32 v11, 17, v11
    v_lshl_add_u32 v231, v10, 4, v11
    v_add_u32 v10, s9, v3
    v_add_u32 v10, 128, v10
    v_mul_u32_u24 v11, 2341, v10
    v_lshrrev_b32 v11, 16, v11
    v_mul_u32_u24 v12, 28, v11
    v_sub_u32 v10, v10, v12
    v_lshl_add_u32 v10, v4, 5, v10
    v_lshlrev_b32 v11, 17, v11
    v_lshl_add_u32 v232, v10, 4, v11
    v_add_u32 v10, s9, v3
    v_add_u32 v10, 160, v10
    v_mul_u32_u24 v11, 2341, v10
    v_lshrrev_b32 v11, 16, v11
    v_mul_u32_u24 v12, 28, v11
    v_sub_u32 v10, v10, v12
    v_lshl_add_u32 v10, v4, 5, v10
    v_lshlrev_b32 v11, 17, v11
    v_lshl_add_u32 v233, v10, 4, v11
    v_add_u32 v10, s10, v3
    v_add_u32 v10, 0, v10
    v_mul_u32_u24 v11, 2341, v10
    v_lshrrev_b32 v11, 16, v11
    v_mul_u32_u24 v12, 28, v11
    v_sub_u32 v10, v10, v12
    v_lshl_add_u32 v10, v4, 5, v10
    v_lshlrev_b32 v11, 17, v11
    v_lshl_add_u32 v234, v10, 4, v11
    v_lshlrev_b32 v235, 4, v4
    v_add_u32 v235, 155648, v235
    s_lshl_b32 s8, s42, 5
    v_add_u32 v236, s8, v3
    v_lshlrev_b32 v236, 2, v236
    s_mov_b32 s56, 18874368
    s_mov_b32 s44, 0x10000000
    s_mov_b32 s45, 0x10000000
    s_cmp_eq_u32 s5, 15
    s_cbranch_scc1 K1_CB
    s_barrier
ST_A_80:
    s_cbranch_execz K1_CONS
    ds_read_b128 v[144:147], v192 offset:0
    ds_read_b64_tr_b16 v[148:149], v200 offset:0
    ds_read_b64_tr_b16 v[150:151], v200 offset:512
    ds_read_b128 v[152:155], v192 offset:4096
    ds_read_b64_tr_b16 v[156:157], v201 offset:0
    ds_read_b64_tr_b16 v[158:159], v201 offset:512
    ds_read_b128 v[160:163], v193 offset:0
    ds_read_b64_tr_b16 v[164:165], v200 offset:4096
    ds_read_b64_tr_b16 v[166:167], v200 offset:4608
    ds_read_b128 v[168:171], v193 offset:4096
    ds_read_b64_tr_b16 v[172:173], v201 offset:4096
    ds_read_b64_tr_b16 v[174:175], v201 offset:4608
    s_barrier
    ds_read_b128 v[176:179], v194 offset:0
    ds_read_b64_tr_b16 v[180:181], v200 offset:8192
    ds_read_b64_tr_b16 v[182:183], v200 offset:8704
    s_waitcnt lgkmcnt(12)
    v_mfma_f32_32x32x16_bf16 v[16:31], v[144:147], v[148:151], 0
    ds_read_b128 v[184:187], v194 offset:4096
    ds_read_b64_tr_b16 v[188:189], v201 offset:8192
    ds_read_b64_tr_b16 v[190:191], v201 offset:8704
    s_waitcnt lgkmcnt(14)
    v_mfma_f32_32x32x16_bf16 v[32:47], v[152:155], v[148:151], 0
    ds_read_b128 v[240:243], v195 offset:0
    s_waitcnt lgkmcnt(13)
    v_mfma_f32_32x32x16_bf16 v[48:63], v[144:147], v[156:159], 0
    ds_read_b64_tr_b16 v[244:245], v200 offset:12288
    ds_read_b64_tr_b16 v[246:247], v200 offset:12800
    v_mfma_f32_32x32x16_bf16 v[64:79], v[152:155], v[156:159], 0
    s_waitcnt lgkmcnt(12)
    v_mfma_f32_32x32x16_bf16 v[16:31], v[160:163], v[164:167], v[16:31]
    ds_read_b128 v[248:251], v195 offset:4096
    ds_read_b64_tr_b16 v[252:253], v201 offset:12288
    ds_read_b64_tr_b16 v[254:255], v201 offset:12800
ST_A_81:
    s_cbranch_execz K1_CONS
    s_waitcnt lgkmcnt(14)
    v_mfma_f32_32x32x16_bf16 v[32:47], v[168:171], v[164:167], v[32:47]
    s_waitcnt lgkmcnt(12)
    s_barrier
    ds_read_b128 v[148:151], v192 offset:16384
    ds_read_b64_tr_b16 v[144:145], v200 offset:16384
    ds_read_b64_tr_b16 v[146:147], v200 offset:16896
    v_mfma_f32_32x32x16_bf16 v[48:63], v[160:163], v[172:175], v[48:63]
    v_mfma_f32_32x32x16_bf16 v[64:79], v[168:171], v[172:175], v[64:79]
    s_waitcnt lgkmcnt(12)
    v_mfma_f32_32x32x16_bf16 v[16:31], v[176:179], v[180:183], v[16:31]
    ds_read_b128 v[152:155], v192 offset:20480
    ds_read_b64_tr_b16 v[156:157], v201 offset:16384
    ds_read_b64_tr_b16 v[158:159], v201 offset:16896
    s_waitcnt lgkmcnt(14)
    v_mfma_f32_32x32x16_bf16 v[32:47], v[184:187], v[180:183], v[32:47]
    ds_read_b128 v[164:167], v193 offset:16384
    s_waitcnt lgkmcnt(13)
    v_mfma_f32_32x32x16_bf16 v[48:63], v[176:179], v[188:191], v[48:63]
    ds_read_b64_tr_b16 v[160:161], v200 offset:20480
    ds_read_b64_tr_b16 v[162:163], v200 offset:20992
    v_mfma_f32_32x32x16_bf16 v[64:79], v[184:187], v[188:191], v[64:79]
    s_waitcnt lgkmcnt(12)
    v_mfma_f32_32x32x16_bf16 v[16:31], v[240:243], v[244:247], v[16:31]
    ds_read_b128 v[168:171], v193 offset:20480
    ds_read_b64_tr_b16 v[172:173], v201 offset:20480
    ds_read_b64_tr_b16 v[174:175], v201 offset:20992
    s_waitcnt lgkmcnt(14)
    v_mfma_f32_32x32x16_bf16 v[32:47], v[248:251], v[244:247], v[32:47]
    s_waitcnt lgkmcnt(12)
    s_barrier
    ds_read_b128 v[180:183], v194 offset:16384
    ds_read_b64_tr_b16 v[176:177], v200 offset:24576
    ds_read_b64_tr_b16 v[178:179], v200 offset:25088
    v_mfma_f32_32x32x16_bf16 v[48:63], v[240:243], v[252:255], v[48:63]
    v_mfma_f32_32x32x16_bf16 v[64:79], v[248:251], v[252:255], v[64:79]
    s_waitcnt lgkmcnt(12)
ST_A_82:
    s_cbranch_execz K1_CONS
    v_mfma_f32_32x32x16_bf16 v[16:31], v[148:151], v[144:147], v[16:31]
    ds_read_b128 v[184:187], v194 offset:20480
    ds_read_b64_tr_b16 v[188:189], v201 offset:24576
    ds_read_b64_tr_b16 v[190:191], v201 offset:25088
    s_waitcnt lgkmcnt(14)
    v_mfma_f32_32x32x16_bf16 v[32:47], v[152:155], v[144:147], v[32:47]
    ds_read_b128 v[244:247], v195 offset:16384
    s_waitcnt lgkmcnt(13)
    v_mfma_f32_32x32x16_bf16 v[48:63], v[148:151], v[156:159], v[48:63]
    ds_read_b64_tr_b16 v[240:241], v200 offset:28672
    ds_read_b64_tr_b16 v[242:243], v200 offset:29184
    v_mfma_f32_32x32x16_bf16 v[64:79], v[152:155], v[156:159], v[64:79]
    s_waitcnt lgkmcnt(12)
    v_mfma_f32_32x32x16_bf16 v[16:31], v[164:167], v[160:163], v[16:31]
    ds_read_b128 v[248:251], v195 offset:20480
    ds_read_b64_tr_b16 v[252:253], v201 offset:28672
    ds_read_b64_tr_b16 v[254:255], v201 offset:29184
    s_waitcnt lgkmcnt(14)
    v_mfma_f32_32x32x16_bf16 v[32:47], v[168:171], v[160:163], v[32:47]
    s_waitcnt lgkmcnt(12)
    s_barrier
    ds_read_b128 v[144:147], v192 offset:32768
    ds_read_b64_tr_b16 v[148:149], v200 offset:32768
    ds_read_b64_tr_b16 v[150:151], v200 offset:33280
    v_mfma_f32_32x32x16_bf16 v[48:63], v[164:167], v[172:175], v[48:63]
    v_mfma_f32_32x32x16_bf16 v[64:79], v[168:171], v[172:175], v[64:79]
    s_waitcnt lgkmcnt(12)
    v_mfma_f32_32x32x16_bf16 v[16:31], v[180:183], v[176:179], v[16:31]
    ds_read_b128 v[152:155], v192 offset:36864
    ds_read_b64_tr_b16 v[156:157], v201 offset:32768
    ds_read_b64_tr_b16 v[158:159], v201 offset:33280
    s_waitcnt lgkmcnt(14)
    v_mfma_f32_32x32x16_bf16 v[32:47], v[184:187], v[176:179], v[32:47]
    ds_read_b128 v[160:163], v193 offset:32768
    s_waitcnt lgkmcnt(13)
    v_mfma_f32_32x32x16_bf16 v[48:63], v[180:183], v[188:191], v[48:63]
ST_A_83:
    s_cbranch_execz K1_CONS
    ds_read_b64_tr_b16 v[164:165], v200 offset:36864
    ds_read_b64_tr_b16 v[166:167], v200 offset:37376
    v_mfma_f32_32x32x16_bf16 v[64:79], v[184:187], v[188:191], v[64:79]
    s_waitcnt lgkmcnt(12)
    v_mfma_f32_32x32x16_bf16 v[16:31], v[244:247], v[240:243], v[16:31]
    ds_read_b128 v[168:171], v193 offset:36864
    ds_read_b64_tr_b16 v[172:173], v201 offset:36864
    ds_read_b64_tr_b16 v[174:175], v201 offset:37376
    s_waitcnt lgkmcnt(14)
    v_mfma_f32_32x32x16_bf16 v[32:47], v[248:251], v[240:243], v[32:47]
    s_waitcnt lgkmcnt(12)
    s_barrier
    ds_read_b128 v[176:179], v194 offset:32768
    ds_read_b64_tr_b16 v[180:181], v200 offset:40960
    ds_read_b64_tr_b16 v[182:183], v200 offset:41472
    v_mfma_f32_32x32x16_bf16 v[48:63], v[244:247], v[252:255], v[48:63]
    v_mfma_f32_32x32x16_bf16 v[64:79], v[248:251], v[252:255], v[64:79]
    s_waitcnt lgkmcnt(12)
    v_mfma_f32_32x32x16_bf16 v[16:31], v[144:147], v[148:151], v[16:31]
    ds_read_b128 v[184:187], v194 offset:36864
    ds_read_b64_tr_b16 v[188:189], v201 offset:40960
    ds_read_b64_tr_b16 v[190:191], v201 offset:41472
    s_waitcnt lgkmcnt(14)
    v_mfma_f32_32x32x16_bf16 v[32:47], v[152:155], v[148:151], v[32:47]
    ds_read_b128 v[240:243], v195 offset:32768
    s_waitcnt lgkmcnt(13)
    v_mfma_f32_32x32x16_bf16 v[48:63], v[144:147], v[156:159], v[48:63]
    ds_read_b64_tr_b16 v[244:245], v200 offset:45056
    ds_read_b64_tr_b16 v[246:247], v200 offset:45568
    v_mfma_f32_32x32x16_bf16 v[64:79], v[152:155], v[156:159], v[64:79]
    s_waitcnt lgkmcnt(12)
    v_mfma_f32_32x32x16_bf16 v[16:31], v[160:163], v[164:167], v[16:31]
    ds_read_b128 v[248:251], v195 offset:36864
    ds_read_b64_tr_b16 v[252:253], v201 offset:45056
    ds_read_b64_tr_b16 v[254:255], v201 offset:45568
    s_waitcnt lgkmcnt(14)
ST_A_84:
    s_cbranch_execz K1_CONS
    v_mfma_f32_32x32x16_bf16 v[32:47], v[168:171], v[164:167], v[32:47]
    s_waitcnt lgkmcnt(12)
    s_barrier
    ds_read_b128 v[148:151], v192 offset:49152
    ds_read_b64_tr_b16 v[144:145], v200 offset:0
    ds_read_b64_tr_b16 v[146:147], v200 offset:512
    v_mfma_f32_32x32x16_bf16 v[48:63], v[160:163], v[172:175], v[48:63]
    v_mfma_f32_32x32x16_bf16 v[64:79], v[168:171], v[172:175], v[64:79]
    s_waitcnt lgkmcnt(12)
    v_mfma_f32_32x32x16_bf16 v[16:31], v[176:179], v[180:183], v[16:31]
    ds_read_b128 v[152:155], v192 offset:53248
    ds_read_b64_tr_b16 v[156:157], v201 offset:0
    ds_read_b64_tr_b16 v[158:159], v201 offset:512
    s_waitcnt lgkmcnt(14)
    v_mfma_f32_32x32x16_bf16 v[32:47], v[184:187], v[180:183], v[32:47]
    ds_read_b128 v[164:167], v193 offset:49152
    s_waitcnt lgkmcnt(13)
    v_mfma_f32_32x32x16_bf16 v[48:63], v[176:179], v[188:191], v[48:63]
    ds_read_b64_tr_b16 v[160:161], v200 offset:4096
    ds_read_b64_tr_b16 v[162:163], v200 offset:4608
    v_mfma_f32_32x32x16_bf16 v[64:79], v[184:187], v[188:191], v[64:79]
    s_waitcnt lgkmcnt(12)
    v_mfma_f32_32x32x16_bf16 v[16:31], v[240:243], v[244:247], v[16:31]
    ds_read_b128 v[168:171], v193 offset:53248
    ds_read_b64_tr_b16 v[172:173], v201 offset:4096
    ds_read_b64_tr_b16 v[174:175], v201 offset:4608
    s_waitcnt lgkmcnt(14)
    v_mfma_f32_32x32x16_bf16 v[32:47], v[248:251], v[244:247], v[32:47]
    s_waitcnt lgkmcnt(12)
    s_barrier
    ds_read_b128 v[180:183], v194 offset:49152
    ds_read_b64_tr_b16 v[176:177], v200 offset:8192
    ds_read_b64_tr_b16 v[178:179], v200 offset:8704
    v_mfma_f32_32x32x16_bf16 v[48:63], v[240:243], v[252:255], v[48:63]
    v_mfma_f32_32x32x16_bf16 v[64:79], v[248:251], v[252:255], v[64:79]
    s_waitcnt lgkmcnt(12)
    s_nop 0
ST_A_85:
    s_cbranch_execz K1_CONS
    v_mfma_f32_32x32x16_bf16 v[16:31], v[148:151], v[144:147], v[16:31]
    ds_read_b128 v[184:187], v194 offset:53248
    ds_read_b64_tr_b16 v[188:189], v201 offset:8192
    ds_read_b64_tr_b16 v[190:191], v201 offset:8704
    s_waitcnt lgkmcnt(14)
    v_mfma_f32_32x32x16_bf16 v[32:47], v[152:155], v[144:147], v[32:47]
    ds_read_b128 v[244:247], v195 offset:49152
    s_waitcnt lgkmcnt(13)
    v_mfma_f32_32x32x16_bf16 v[48:63], v[148:151], v[156:159], v[48:63]
    ds_read_b64_tr_b16 v[240:241], v200 offset:12288
    ds_read_b64_tr_b16 v[242:243], v200 offset:12800
    v_mfma_f32_32x32x16_bf16 v[64:79], v[152:155], v[156:159], v[64:79]
    s_waitcnt lgkmcnt(12)
    v_mfma_f32_32x32x16_bf16 v[16:31], v[164:167], v[160:163], v[16:31]
    ds_read_b128 v[248:251], v195 offset:53248
    ds_read_b64_tr_b16 v[252:253], v201 offset:12288
    ds_read_b64_tr_b16 v[254:255], v201 offset:12800
    s_waitcnt lgkmcnt(14)
    v_mfma_f32_32x32x16_bf16 v[32:47], v[168:171], v[160:163], v[32:47]
    s_waitcnt lgkmcnt(12)
    s_barrier
    ds_read_b128 v[144:147], v196 offset:0
    ds_read_b64_tr_b16 v[148:149], v200 offset:16384
    ds_read_b64_tr_b16 v[150:151], v200 offset:16896
    v_mfma_f32_32x32x16_bf16 v[48:63], v[164:167], v[172:175], v[48:63]
    v_mfma_f32_32x32x16_bf16 v[64:79], v[168:171], v[172:175], v[64:79]
    s_waitcnt lgkmcnt(12)
    v_mfma_f32_32x32x16_bf16 v[16:31], v[180:183], v[176:179], v[16:31]
    ds_read_b128 v[152:155], v196 offset:4096
    ds_read_b64_tr_b16 v[156:157], v201 offset:16384
    ds_read_b64_tr_b16 v[158:159], v201 offset:16896
    s_waitcnt lgkmcnt(14)
    v_mfma_f32_32x32x16_bf16 v[32:47], v[184:187], v[176:179], v[32:47]
    ds_read_b128 v[160:163], v197 offset:0
    s_waitcnt lgkmcnt(13)
    v_mfma_f32_32x32x16_bf16 v[48:63], v[180:183], v[188:191], v[48:63]
ST_A_86:
    s_cbranch_execz K1_CONS
    ds_read_b64_tr_b16 v[164:165], v200 offset:20480
    ds_read_b64_tr_b16 v[166:167], v200 offset:20992
    v_mfma_f32_32x32x16_bf16 v[64:79], v[184:187], v[188:191], v[64:79]
    s_waitcnt lgkmcnt(12)
    v_mfma_f32_32x32x16_bf16 v[16:31], v[244:247], v[240:243], v[16:31]
    ds_read_b128 v[168:171], v197 offset:4096
    ds_read_b64_tr_b16 v[172:173], v201 offset:20480
    ds_read_b64_tr_b16 v[174:175], v201 offset:20992
    s_waitcnt lgkmcnt(14)
    v_mfma_f32_32x32x16_bf16 v[32:47], v[248:251], v[240:243], v[32:47]
    s_waitcnt lgkmcnt(12)
    s_barrier
    ds_read_b128 v[176:179], v198 offset:0
    ds_read_b64_tr_b16 v[180:181], v200 offset:24576
    ds_read_b64_tr_b16 v[182:183], v200 offset:25088
    v_mfma_f32_32x32x16_bf16 v[48:63], v[244:247], v[252:255], v[48:63]
    v_mfma_f32_32x32x16_bf16 v[64:79], v[248:251], v[252:255], v[64:79]
    s_waitcnt lgkmcnt(12)
    v_mfma_f32_32x32x16_bf16 v[16:31], v[144:147], v[148:151], v[16:31]
    ds_read_b128 v[184:187], v198 offset:4096
    ds_read_b64_tr_b16 v[188:189], v201 offset:24576
    ds_read_b64_tr_b16 v[190:191], v201 offset:25088
    s_waitcnt lgkmcnt(14)
    v_mfma_f32_32x32x16_bf16 v[32:47], v[152:155], v[148:151], v[32:47]
    ds_read_b128 v[240:243], v199 offset:0
    s_waitcnt lgkmcnt(13)
    v_mfma_f32_32x32x16_bf16 v[48:63], v[144:147], v[156:159], v[48:63]
    ds_read_b64_tr_b16 v[244:245], v200 offset:28672
    ds_read_b64_tr_b16 v[246:247], v200 offset:29184
    v_mfma_f32_32x32x16_bf16 v[64:79], v[152:155], v[156:159], v[64:79]
    s_waitcnt lgkmcnt(12)
    v_mfma_f32_32x32x16_bf16 v[16:31], v[160:163], v[164:167], v[16:31]
    ds_read_b128 v[248:251], v199 offset:4096
    ds_read_b64_tr_b16 v[252:253], v201 offset:28672
    ds_read_b64_tr_b16 v[254:255], v201 offset:29184
    s_waitcnt lgkmcnt(14)
ST_A_87:
    s_cbranch_execz K1_CONS
    v_mfma_f32_32x32x16_bf16 v[32:47], v[168:171], v[164:167], v[32:47]
    s_waitcnt lgkmcnt(12)
    s_barrier
    ds_read_b128 v[148:151], v196 offset:16384
    ds_read_b64_tr_b16 v[144:145], v200 offset:32768
    ds_read_b64_tr_b16 v[146:147], v200 offset:33280
    v_mfma_f32_32x32x16_bf16 v[48:63], v[160:163], v[172:175], v[48:63]
    v_mfma_f32_32x32x16_bf16 v[64:79], v[168:171], v[172:175], v[64:79]
    s_waitcnt lgkmcnt(12)
    v_mfma_f32_32x32x16_bf16 v[16:31], v[176:179], v[180:183], v[16:31]
    ds_read_b128 v[152:155], v196 offset:20480
    ds_read_b64_tr_b16 v[156:157], v201 offset:32768
    ds_read_b64_tr_b16 v[158:159], v201 offset:33280
    s_waitcnt lgkmcnt(14)
    v_mfma_f32_32x32x16_bf16 v[32:47], v[184:187], v[180:183], v[32:47]
    ds_read_b128 v[164:167], v197 offset:16384
    s_waitcnt lgkmcnt(13)
    v_mfma_f32_32x32x16_bf16 v[48:63], v[176:179], v[188:191], v[48:63]
    ds_read_b64_tr_b16 v[160:161], v200 offset:36864
    ds_read_b64_tr_b16 v[162:163], v200 offset:37376
    v_mfma_f32_32x32x16_bf16 v[64:79], v[184:187], v[188:191], v[64:79]
    s_waitcnt lgkmcnt(12)
    v_mfma_f32_32x32x16_bf16 v[16:31], v[240:243], v[244:247], v[16:31]
    ds_read_b128 v[168:171], v197 offset:20480
    ds_read_b64_tr_b16 v[172:173], v201 offset:36864
    ds_read_b64_tr_b16 v[174:175], v201 offset:37376
    s_waitcnt lgkmcnt(14)
    v_mfma_f32_32x32x16_bf16 v[32:47], v[248:251], v[244:247], v[32:47]
    s_waitcnt lgkmcnt(12)
    s_barrier
    ds_read_b128 v[180:183], v198 offset:16384
    ds_read_b64_tr_b16 v[176:177], v200 offset:40960
    ds_read_b64_tr_b16 v[178:179], v200 offset:41472
    v_mfma_f32_32x32x16_bf16 v[48:63], v[240:243], v[252:255], v[48:63]
    v_mfma_f32_32x32x16_bf16 v[64:79], v[248:251], v[252:255], v[64:79]
    s_waitcnt lgkmcnt(12)
    s_nop 0
ST_A_88:
    s_cbranch_execz K1_CONS
    v_mfma_f32_32x32x16_bf16 v[16:31], v[148:151], v[144:147], v[16:31]
    ds_read_b128 v[184:187], v198 offset:20480
    ds_read_b64_tr_b16 v[188:189], v201 offset:40960
    ds_read_b64_tr_b16 v[190:191], v201 offset:41472
    s_waitcnt lgkmcnt(14)
    v_mfma_f32_32x32x16_bf16 v[32:47], v[152:155], v[144:147], v[32:47]
    ds_read_b128 v[244:247], v199 offset:16384
    s_waitcnt lgkmcnt(13)
    v_mfma_f32_32x32x16_bf16 v[48:63], v[148:151], v[156:159], v[48:63]
    ds_read_b64_tr_b16 v[240:241], v200 offset:45056
    ds_read_b64_tr_b16 v[242:243], v200 offset:45568
    v_mfma_f32_32x32x16_bf16 v[64:79], v[152:155], v[156:159], v[64:79]
    s_waitcnt lgkmcnt(12)
    v_mfma_f32_32x32x16_bf16 v[16:31], v[164:167], v[160:163], v[16:31]
    ds_read_b128 v[248:251], v199 offset:20480
    ds_read_b64_tr_b16 v[252:253], v201 offset:45056
    ds_read_b64_tr_b16 v[254:255], v201 offset:45568
    s_waitcnt lgkmcnt(14)
    v_mfma_f32_32x32x16_bf16 v[32:47], v[168:171], v[160:163], v[32:47]
    s_waitcnt lgkmcnt(12)
    s_barrier
    ds_read_b128 v[144:147], v196 offset:32768
    ds_read_b64_tr_b16 v[148:149], v200 offset:0
    ds_read_b64_tr_b16 v[150:151], v200 offset:512
    v_mfma_f32_32x32x16_bf16 v[48:63], v[164:167], v[172:175], v[48:63]
    v_mfma_f32_32x32x16_bf16 v[64:79], v[168:171], v[172:175], v[64:79]
    s_waitcnt lgkmcnt(12)
    v_mfma_f32_32x32x16_bf16 v[16:31], v[180:183], v[176:179], v[16:31]
    ds_read_b128 v[152:155], v196 offset:36864
    ds_read_b64_tr_b16 v[156:157], v201 offset:0
    ds_read_b64_tr_b16 v[158:159], v201 offset:512
    s_waitcnt lgkmcnt(14)
    v_mfma_f32_32x32x16_bf16 v[32:47], v[184:187], v[176:179], v[32:47]
    ds_read_b128 v[160:163], v197 offset:32768
    s_waitcnt lgkmcnt(13)
    v_mfma_f32_32x32x16_bf16 v[48:63], v[180:183], v[188:191], v[48:63]
ST_A_89:
    s_cbranch_execz K1_CONS
    ds_read_b64_tr_b16 v[164:165], v200 offset:4096
    ds_read_b64_tr_b16 v[166:167], v200 offset:4608
    v_mfma_f32_32x32x16_bf16 v[64:79], v[184:187], v[188:191], v[64:79]
    s_waitcnt lgkmcnt(12)
    v_mfma_f32_32x32x16_bf16 v[16:31], v[244:247], v[240:243], v[16:31]
    ds_read_b128 v[168:171], v197 offset:36864
    ds_read_b64_tr_b16 v[172:173], v201 offset:4096
    ds_read_b64_tr_b16 v[174:175], v201 offset:4608
    s_waitcnt lgkmcnt(14)
    v_mfma_f32_32x32x16_bf16 v[32:47], v[248:251], v[240:243], v[32:47]
    s_waitcnt lgkmcnt(12)
    s_barrier
    ds_read_b128 v[176:179], v198 offset:32768
    ds_read_b64_tr_b16 v[180:181], v200 offset:8192
    ds_read_b64_tr_b16 v[182:183], v200 offset:8704
    v_mfma_f32_32x32x16_bf16 v[48:63], v[244:247], v[252:255], v[48:63]
    v_mfma_f32_32x32x16_bf16 v[64:79], v[248:251], v[252:255], v[64:79]
    s_waitcnt lgkmcnt(12)
    v_mfma_f32_32x32x16_bf16 v[16:31], v[144:147], v[148:151], v[16:31]
    ds_read_b128 v[184:187], v198 offset:36864
    ds_read_b64_tr_b16 v[188:189], v201 offset:8192
    ds_read_b64_tr_b16 v[190:191], v201 offset:8704
    s_waitcnt lgkmcnt(14)
    v_mfma_f32_32x32x16_bf16 v[32:47], v[152:155], v[148:151], v[32:47]
    ds_read_b128 v[240:243], v199 offset:32768
    s_waitcnt lgkmcnt(13)
    v_mfma_f32_32x32x16_bf16 v[48:63], v[144:147], v[156:159], v[48:63]
    ds_read_b64_tr_b16 v[244:245], v200 offset:12288
    ds_read_b64_tr_b16 v[246:247], v200 offset:12800
    v_mfma_f32_32x32x16_bf16 v[64:79], v[152:155], v[156:159], v[64:79]
    s_waitcnt lgkmcnt(12)
    v_mfma_f32_32x32x16_bf16 v[16:31], v[160:163], v[164:167], v[16:31]
    ds_read_b128 v[248:251], v199 offset:36864
    ds_read_b64_tr_b16 v[252:253], v201 offset:12288
    ds_read_b64_tr_b16 v[254:255], v201 offset:12800
    s_waitcnt lgkmcnt(14)
ST_A_90:
    s_cbranch_execz K1_CONS
    v_mfma_f32_32x32x16_bf16 v[32:47], v[168:171], v[164:167], v[32:47]
    s_waitcnt lgkmcnt(12)
    s_barrier
    ds_read_b128 v[148:151], v192 offset:0
    ds_read_b64_tr_b16 v[144:145], v200 offset:16384
    ds_read_b64_tr_b16 v[146:147], v200 offset:16896
    v_mfma_f32_32x32x16_bf16 v[48:63], v[160:163], v[172:175], v[48:63]
    v_mfma_f32_32x32x16_bf16 v[64:79], v[168:171], v[172:175], v[64:79]
    s_waitcnt lgkmcnt(12)
    v_mfma_f32_32x32x16_bf16 v[16:31], v[176:179], v[180:183], v[16:31]
    ds_read_b128 v[152:155], v192 offset:4096
    ds_read_b64_tr_b16 v[156:157], v201 offset:16384
    ds_read_b64_tr_b16 v[158:159], v201 offset:16896
    s_waitcnt lgkmcnt(14)
    v_mfma_f32_32x32x16_bf16 v[32:47], v[184:187], v[180:183], v[32:47]
    ds_read_b128 v[164:167], v193 offset:0
    s_waitcnt lgkmcnt(13)
    v_mfma_f32_32x32x16_bf16 v[48:63], v[176:179], v[188:191], v[48:63]
    ds_read_b64_tr_b16 v[160:161], v200 offset:20480
    ds_read_b64_tr_b16 v[162:163], v200 offset:20992
    v_mfma_f32_32x32x16_bf16 v[64:79], v[184:187], v[188:191], v[64:79]
    s_waitcnt lgkmcnt(12)
    v_mfma_f32_32x32x16_bf16 v[16:31], v[240:243], v[244:247], v[16:31]
    ds_read_b128 v[168:171], v193 offset:4096
    ds_read_b64_tr_b16 v[172:173], v201 offset:20480
    ds_read_b64_tr_b16 v[174:175], v201 offset:20992
    s_waitcnt lgkmcnt(14)
    v_mfma_f32_32x32x16_bf16 v[32:47], v[248:251], v[244:247], v[32:47]
    s_waitcnt lgkmcnt(12)
    s_barrier
    ds_read_b128 v[180:183], v194 offset:0
    ds_read_b64_tr_b16 v[176:177], v200 offset:24576
    ds_read_b64_tr_b16 v[178:179], v200 offset:25088
    v_mfma_f32_32x32x16_bf16 v[48:63], v[240:243], v[252:255], v[48:63]
    s_nop 0
    v_cvt_pk_bf16_f32 v204, v16, v17
    s_nop 0
ST_A_91:
    s_cbranch_execz K1_CONS
    v_cvt_pk_bf16_f32 v205, v18, v19
    v_cvt_pk_bf16_f32 v206, v20, v21
    v_cvt_pk_bf16_f32 v207, v22, v23
    v_cvt_pk_bf16_f32 v208, v24, v25
    v_mfma_f32_32x32x16_bf16 v[64:79], v[248:251], v[252:255], v[64:79]
    v_cvt_pk_bf16_f32 v209, v26, v27
    v_cvt_pk_bf16_f32 v210, v28, v29
    v_cvt_pk_bf16_f32 v211, v30, v31
    s_waitcnt lgkmcnt(12)
    v_mfma_f32_32x32x16_bf16 v[80:95], v[148:151], v[144:147], 0
    ds_read_b128 v[184:187], v194 offset:4096
    ds_read_b64_tr_b16 v[188:189], v201 offset:24576
    ds_read_b64_tr_b16 v[190:191], v201 offset:25088
    buffer_store_dwordx4 v[204:207], v230, s[32:35], s52 offen offset:0 sc1
    buffer_store_dwordx4 v[208:211], v230, s[32:35], s52 offen offset:1024 sc1
    s_waitcnt lgkmcnt(14)
    v_mfma_f32_32x32x16_bf16 v[96:111], v[152:155], v[144:147], 0
    ds_read_b128 v[244:247], v195 offset:0
    v_cvt_pk_bf16_f32 v216, v32, v33
    v_cvt_pk_bf16_f32 v217, v34, v35
    s_waitcnt lgkmcnt(13)
    v_mfma_f32_32x32x16_bf16 v[112:127], v[148:151], v[156:159], 0
    ds_read_b64_tr_b16 v[240:241], v200 offset:28672
    ds_read_b64_tr_b16 v[242:243], v200 offset:29184
    v_cvt_pk_bf16_f32 v218, v36, v37
    v_cvt_pk_bf16_f32 v219, v38, v39
    v_cvt_pk_bf16_f32 v220, v40, v41
    v_mfma_f32_32x32x16_bf16 v[128:143], v[152:155], v[156:159], 0
    v_cvt_pk_bf16_f32 v221, v42, v43
    v_cvt_pk_bf16_f32 v222, v44, v45
    v_cvt_pk_bf16_f32 v223, v46, v47
    s_waitcnt lgkmcnt(12)
    v_mfma_f32_32x32x16_bf16 v[80:95], v[164:167], v[160:163], v[80:95]
    s_nop 0
ST_A_92:
    s_cbranch_execz K1_CONS
    ds_read_b128 v[248:251], v195 offset:4096
    ds_read_b64_tr_b16 v[252:253], v201 offset:28672
    ds_read_b64_tr_b16 v[254:255], v201 offset:29184
    buffer_store_dwordx4 v[216:219], v230, s[32:35], s53 offen offset:0 sc1
    buffer_store_dwordx4 v[220:223], v230, s[32:35], s53 offen offset:1024 sc1
    s_waitcnt lgkmcnt(14)
    v_mfma_f32_32x32x16_bf16 v[96:111], v[168:171], v[160:163], v[96:111]
    s_waitcnt lgkmcnt(12)
    s_barrier
    ds_read_b128 v[144:147], v192 offset:16384
    ds_read_b64_tr_b16 v[148:149], v200 offset:32768
    ds_read_b64_tr_b16 v[150:151], v200 offset:33280
    v_cvt_pk_bf16_f32 v204, v48, v49
    v_cvt_pk_bf16_f32 v205, v50, v51
    v_mfma_f32_32x32x16_bf16 v[112:127], v[164:167], v[172:175], v[112:127]
    v_cvt_pk_bf16_f32 v206, v52, v53
    v_cvt_pk_bf16_f32 v207, v54, v55
    v_cvt_pk_bf16_f32 v208, v56, v57
    v_mfma_f32_32x32x16_bf16 v[128:143], v[168:171], v[172:175], v[128:143]
    v_cvt_pk_bf16_f32 v209, v58, v59
    v_cvt_pk_bf16_f32 v210, v60, v61
    v_cvt_pk_bf16_f32 v211, v62, v63
    s_waitcnt lgkmcnt(12)
    v_mfma_f32_32x32x16_bf16 v[80:95], v[180:183], v[176:179], v[80:95]
    ds_read_b128 v[152:155], v192 offset:20480
    ds_read_b64_tr_b16 v[156:157], v201 offset:32768
    ds_read_b64_tr_b16 v[158:159], v201 offset:33280
    buffer_store_dwordx4 v[204:207], v231, s[32:35], s52 offen offset:0 sc1
    buffer_store_dwordx4 v[208:211], v231, s[32:35], s52 offen offset:1024 sc1
    s_waitcnt lgkmcnt(14)
    v_mfma_f32_32x32x16_bf16 v[96:111], v[184:187], v[176:179], v[96:111]
    ds_read_b128 v[160:163], v193 offset:16384
    v_cvt_pk_bf16_f32 v216, v64, v65
    v_cvt_pk_bf16_f32 v217, v66, v67
ST_A_93:
    s_cbranch_execz K1_CONS
    s_waitcnt lgkmcnt(13)
    v_mfma_f32_32x32x16_bf16 v[112:127], v[180:183], v[188:191], v[112:127]
    ds_read_b64_tr_b16 v[164:165], v200 offset:36864
    ds_read_b64_tr_b16 v[166:167], v200 offset:37376
    v_cvt_pk_bf16_f32 v218, v68, v69
    v_cvt_pk_bf16_f32 v219, v70, v71
    v_cvt_pk_bf16_f32 v220, v72, v73
    v_mfma_f32_32x32x16_bf16 v[128:143], v[184:187], v[188:191], v[128:143]
    v_cvt_pk_bf16_f32 v221, v74, v75
    v_cvt_pk_bf16_f32 v222, v76, v77
    v_cvt_pk_bf16_f32 v223, v78, v79
    s_waitcnt lgkmcnt(12)
    v_mfma_f32_32x32x16_bf16 v[80:95], v[244:247], v[240:243], v[80:95]
    ds_read_b128 v[168:171], v193 offset:20480
    ds_read_b64_tr_b16 v[172:173], v201 offset:36864
    ds_read_b64_tr_b16 v[174:175], v201 offset:37376
    buffer_store_dwordx4 v[216:219], v231, s[32:35], s53 offen offset:0 sc1
    buffer_store_dwordx4 v[220:223], v231, s[32:35], s53 offen offset:1024 sc1
    s_waitcnt lgkmcnt(14)
    v_mfma_f32_32x32x16_bf16 v[96:111], v[248:251], v[240:243], v[96:111]
    s_waitcnt lgkmcnt(12)
    s_barrier
    ds_read_b128 v[176:179], v194 offset:16384
    ds_read_b64_tr_b16 v[180:181], v200 offset:40960
    ds_read_b64_tr_b16 v[182:183], v200 offset:41472
    v_mfma_f32_32x32x16_bf16 v[112:127], v[244:247], v[252:255], v[112:127]
    v_mfma_f32_32x32x16_bf16 v[128:143], v[248:251], v[252:255], v[128:143]
    s_waitcnt lgkmcnt(12)
    v_mfma_f32_32x32x16_bf16 v[80:95], v[144:147], v[148:151], v[80:95]
    ds_read_b128 v[184:187], v194 offset:20480
    ds_read_b64_tr_b16 v[188:189], v201 offset:40960
    ds_read_b64_tr_b16 v[190:191], v201 offset:41472
    s_waitcnt lgkmcnt(14)
    v_mfma_f32_32x32x16_bf16 v[96:111], v[152:155], v[148:151], v[96:111]
    ds_read_b128 v[240:243], v195 offset:16384
ST_A_94:
    s_cbranch_execz K1_CONS
    s_waitcnt lgkmcnt(13)
    v_mfma_f32_32x32x16_bf16 v[112:127], v[144:147], v[156:159], v[112:127]
    ds_read_b64_tr_b16 v[244:245], v200 offset:45056
    ds_read_b64_tr_b16 v[246:247], v200 offset:45568
    v_mfma_f32_32x32x16_bf16 v[128:143], v[152:155], v[156:159], v[128:143]
    s_waitcnt lgkmcnt(12)
    v_mfma_f32_32x32x16_bf16 v[80:95], v[160:163], v[164:167], v[80:95]
    ds_read_b128 v[248:251], v195 offset:20480
    ds_read_b64_tr_b16 v[252:253], v201 offset:45056
    ds_read_b64_tr_b16 v[254:255], v201 offset:45568
    s_waitcnt lgkmcnt(14)
    v_mfma_f32_32x32x16_bf16 v[96:111], v[168:171], v[164:167], v[96:111]
    s_waitcnt lgkmcnt(12)
    s_barrier
    ds_read_b128 v[148:151], v192 offset:32768
    ds_read_b64_tr_b16 v[144:145], v200 offset:0
    ds_read_b64_tr_b16 v[146:147], v200 offset:512
    v_mfma_f32_32x32x16_bf16 v[112:127], v[160:163], v[172:175], v[112:127]
    v_mfma_f32_32x32x16_bf16 v[128:143], v[168:171], v[172:175], v[128:143]
    s_waitcnt lgkmcnt(12)
    v_mfma_f32_32x32x16_bf16 v[80:95], v[176:179], v[180:183], v[80:95]
    ds_read_b128 v[152:155], v192 offset:36864
    ds_read_b64_tr_b16 v[156:157], v201 offset:0
    ds_read_b64_tr_b16 v[158:159], v201 offset:512
    s_waitcnt lgkmcnt(14)
    v_mfma_f32_32x32x16_bf16 v[96:111], v[184:187], v[180:183], v[96:111]
    ds_read_b128 v[164:167], v193 offset:32768
    s_waitcnt lgkmcnt(13)
    v_mfma_f32_32x32x16_bf16 v[112:127], v[176:179], v[188:191], v[112:127]
    ds_read_b64_tr_b16 v[160:161], v200 offset:4096
    ds_read_b64_tr_b16 v[162:163], v200 offset:4608
    v_mfma_f32_32x32x16_bf16 v[128:143], v[184:187], v[188:191], v[128:143]
    s_waitcnt lgkmcnt(12)
    v_mfma_f32_32x32x16_bf16 v[80:95], v[240:243], v[244:247], v[80:95]
    ds_read_b128 v[168:171], v193 offset:36864
    ds_read_b64_tr_b16 v[172:173], v201 offset:4096
ST_A_95:
    s_cbranch_execz K1_CONS
    ds_read_b64_tr_b16 v[174:175], v201 offset:4608
    s_waitcnt lgkmcnt(14)
    v_mfma_f32_32x32x16_bf16 v[96:111], v[248:251], v[244:247], v[96:111]
    s_waitcnt lgkmcnt(12)
    s_barrier
    ds_read_b128 v[180:183], v194 offset:32768
    ds_read_b64_tr_b16 v[176:177], v200 offset:8192
    ds_read_b64_tr_b16 v[178:179], v200 offset:8704
    v_mfma_f32_32x32x16_bf16 v[112:127], v[240:243], v[252:255], v[112:127]
    v_mfma_f32_32x32x16_bf16 v[128:143], v[248:251], v[252:255], v[128:143]
    s_waitcnt lgkmcnt(12)
    v_mfma_f32_32x32x16_bf16 v[80:95], v[148:151], v[144:147], v[80:95]
    ds_read_b128 v[184:187], v194 offset:36864
    ds_read_b64_tr_b16 v[188:189], v201 offset:8192
    ds_read_b64_tr_b16 v[190:191], v201 offset:8704
    s_waitcnt lgkmcnt(14)
    v_mfma_f32_32x32x16_bf16 v[96:111], v[152:155], v[144:147], v[96:111]
    ds_read_b128 v[244:247], v195 offset:32768
    s_waitcnt lgkmcnt(13)
    v_mfma_f32_32x32x16_bf16 v[112:127], v[148:151], v[156:159], v[112:127]
    ds_read_b64_tr_b16 v[240:241], v200 offset:12288
    ds_read_b64_tr_b16 v[242:243], v200 offset:12800
    v_mfma_f32_32x32x16_bf16 v[128:143], v[152:155], v[156:159], v[128:143]
    s_waitcnt lgkmcnt(12)
    v_mfma_f32_32x32x16_bf16 v[80:95], v[164:167], v[160:163], v[80:95]
    ds_read_b128 v[248:251], v195 offset:36864
    ds_read_b64_tr_b16 v[252:253], v201 offset:12288
    ds_read_b64_tr_b16 v[254:255], v201 offset:12800
    s_waitcnt lgkmcnt(14)
    v_mfma_f32_32x32x16_bf16 v[96:111], v[168:171], v[160:163], v[96:111]
    s_waitcnt lgkmcnt(12)
    s_barrier
    ds_read_b128 v[144:147], v192 offset:49152
    ds_read_b64_tr_b16 v[148:149], v200 offset:16384
    ds_read_b64_tr_b16 v[150:151], v200 offset:16896
    v_mfma_f32_32x32x16_bf16 v[112:127], v[164:167], v[172:175], v[112:127]
    s_nop 0
ST_A_96:
    s_cbranch_execz K1_CONS
    v_mfma_f32_32x32x16_bf16 v[128:143], v[168:171], v[172:175], v[128:143]
    s_waitcnt lgkmcnt(12)
    v_mfma_f32_32x32x16_bf16 v[80:95], v[180:183], v[176:179], v[80:95]
    ds_read_b128 v[152:155], v192 offset:53248
    ds_read_b64_tr_b16 v[156:157], v201 offset:16384
    ds_read_b64_tr_b16 v[158:159], v201 offset:16896
    s_waitcnt lgkmcnt(14)
    v_mfma_f32_32x32x16_bf16 v[96:111], v[184:187], v[176:179], v[96:111]
    ds_read_b128 v[160:163], v193 offset:49152
    s_waitcnt lgkmcnt(13)
    v_mfma_f32_32x32x16_bf16 v[112:127], v[180:183], v[188:191], v[112:127]
    ds_read_b64_tr_b16 v[164:165], v200 offset:20480
    ds_read_b64_tr_b16 v[166:167], v200 offset:20992
    v_mfma_f32_32x32x16_bf16 v[128:143], v[184:187], v[188:191], v[128:143]
    s_waitcnt lgkmcnt(12)
    v_mfma_f32_32x32x16_bf16 v[80:95], v[244:247], v[240:243], v[80:95]
    ds_read_b128 v[168:171], v193 offset:53248
    ds_read_b64_tr_b16 v[172:173], v201 offset:20480
    ds_read_b64_tr_b16 v[174:175], v201 offset:20992
    s_waitcnt lgkmcnt(14)
    v_mfma_f32_32x32x16_bf16 v[96:111], v[248:251], v[240:243], v[96:111]
    s_waitcnt lgkmcnt(12)
    s_barrier
    ds_read_b128 v[176:179], v194 offset:49152
    ds_read_b64_tr_b16 v[180:181], v200 offset:24576
    ds_read_b64_tr_b16 v[182:183], v200 offset:25088
    v_mfma_f32_32x32x16_bf16 v[112:127], v[244:247], v[252:255], v[112:127]
    v_mfma_f32_32x32x16_bf16 v[128:143], v[248:251], v[252:255], v[128:143]
    s_waitcnt lgkmcnt(12)
    v_mfma_f32_32x32x16_bf16 v[80:95], v[144:147], v[148:151], v[80:95]
    ds_read_b128 v[184:187], v194 offset:53248
    ds_read_b64_tr_b16 v[188:189], v201 offset:24576
    ds_read_b64_tr_b16 v[190:191], v201 offset:25088
    s_waitcnt lgkmcnt(14)
    v_mfma_f32_32x32x16_bf16 v[96:111], v[152:155], v[148:151], v[96:111]
    ds_read_b128 v[240:243], v195 offset:49152
ST_A_97:
    s_cbranch_execz K1_CONS
    s_waitcnt lgkmcnt(13)
    v_mfma_f32_32x32x16_bf16 v[112:127], v[144:147], v[156:159], v[112:127]
    ds_read_b64_tr_b16 v[244:245], v200 offset:28672
    ds_read_b64_tr_b16 v[246:247], v200 offset:29184
    v_mfma_f32_32x32x16_bf16 v[128:143], v[152:155], v[156:159], v[128:143]
    s_waitcnt lgkmcnt(12)
    v_mfma_f32_32x32x16_bf16 v[80:95], v[160:163], v[164:167], v[80:95]
    ds_read_b128 v[248:251], v195 offset:53248
    ds_read_b64_tr_b16 v[252:253], v201 offset:28672
    ds_read_b64_tr_b16 v[254:255], v201 offset:29184
    s_waitcnt lgkmcnt(14)
    v_mfma_f32_32x32x16_bf16 v[96:111], v[168:171], v[164:167], v[96:111]
    s_waitcnt lgkmcnt(12)
    s_barrier
    ds_read_b128 v[148:151], v196 offset:0
    ds_read_b64_tr_b16 v[144:145], v200 offset:32768
    ds_read_b64_tr_b16 v[146:147], v200 offset:33280
    v_mfma_f32_32x32x16_bf16 v[112:127], v[160:163], v[172:175], v[112:127]
    v_mfma_f32_32x32x16_bf16 v[128:143], v[168:171], v[172:175], v[128:143]
    s_waitcnt lgkmcnt(12)
    v_mfma_f32_32x32x16_bf16 v[80:95], v[176:179], v[180:183], v[80:95]
    ds_read_b128 v[152:155], v196 offset:4096
    ds_read_b64_tr_b16 v[156:157], v201 offset:32768
    ds_read_b64_tr_b16 v[158:159], v201 offset:33280
    s_waitcnt lgkmcnt(14)
    v_mfma_f32_32x32x16_bf16 v[96:111], v[184:187], v[180:183], v[96:111]
    ds_read_b128 v[164:167], v197 offset:0
    s_waitcnt lgkmcnt(13)
    v_mfma_f32_32x32x16_bf16 v[112:127], v[176:179], v[188:191], v[112:127]
    ds_read_b64_tr_b16 v[160:161], v200 offset:36864
    ds_read_b64_tr_b16 v[162:163], v200 offset:37376
    v_mfma_f32_32x32x16_bf16 v[128:143], v[184:187], v[188:191], v[128:143]
    s_waitcnt lgkmcnt(12)
    v_mfma_f32_32x32x16_bf16 v[80:95], v[240:243], v[244:247], v[80:95]
    ds_read_b128 v[168:171], v197 offset:4096
    ds_read_b64_tr_b16 v[172:173], v201 offset:36864
ST_A_98:
    s_cbranch_execz K1_CONS
    ds_read_b64_tr_b16 v[174:175], v201 offset:37376
    s_waitcnt lgkmcnt(14)
    v_mfma_f32_32x32x16_bf16 v[96:111], v[248:251], v[244:247], v[96:111]
    s_waitcnt lgkmcnt(12)
    s_barrier
    ds_read_b128 v[180:183], v198 offset:0
    ds_read_b64_tr_b16 v[176:177], v200 offset:40960
    ds_read_b64_tr_b16 v[178:179], v200 offset:41472
    v_mfma_f32_32x32x16_bf16 v[112:127], v[240:243], v[252:255], v[112:127]
    v_mfma_f32_32x32x16_bf16 v[128:143], v[248:251], v[252:255], v[128:143]
    s_waitcnt lgkmcnt(12)
    v_mfma_f32_32x32x16_bf16 v[80:95], v[148:151], v[144:147], v[80:95]
    ds_read_b128 v[184:187], v198 offset:4096
    ds_read_b64_tr_b16 v[188:189], v201 offset:40960
    ds_read_b64_tr_b16 v[190:191], v201 offset:41472
    s_waitcnt lgkmcnt(14)
    v_mfma_f32_32x32x16_bf16 v[96:111], v[152:155], v[144:147], v[96:111]
    ds_read_b128 v[244:247], v199 offset:0
    s_waitcnt lgkmcnt(13)
    v_mfma_f32_32x32x16_bf16 v[112:127], v[148:151], v[156:159], v[112:127]
    ds_read_b64_tr_b16 v[240:241], v200 offset:45056
    ds_read_b64_tr_b16 v[242:243], v200 offset:45568
    v_mfma_f32_32x32x16_bf16 v[128:143], v[152:155], v[156:159], v[128:143]
    s_waitcnt lgkmcnt(12)
    v_mfma_f32_32x32x16_bf16 v[80:95], v[164:167], v[160:163], v[80:95]
    ds_read_b128 v[248:251], v199 offset:4096
    ds_read_b64_tr_b16 v[252:253], v201 offset:45056
    ds_read_b64_tr_b16 v[254:255], v201 offset:45568
    s_waitcnt lgkmcnt(14)
    v_mfma_f32_32x32x16_bf16 v[96:111], v[168:171], v[160:163], v[96:111]
    s_waitcnt lgkmcnt(12)
    s_barrier
    ds_read_b128 v[144:147], v196 offset:16384
    ds_read_b64_tr_b16 v[148:149], v200 offset:0
    ds_read_b64_tr_b16 v[150:151], v200 offset:512
    v_mfma_f32_32x32x16_bf16 v[112:127], v[164:167], v[172:175], v[112:127]
    s_nop 0
ST_A_99:
    s_cbranch_execz K1_CONS
    v_mfma_f32_32x32x16_bf16 v[128:143], v[168:171], v[172:175], v[128:143]
    s_waitcnt lgkmcnt(12)
    v_mfma_f32_32x32x16_bf16 v[80:95], v[180:183], v[176:179], v[80:95]
    ds_read_b128 v[152:155], v196 offset:20480
    ds_read_b128 v[156:159], v197 offset:16384
    s_waitcnt lgkmcnt(13)
    v_mfma_f32_32x32x16_bf16 v[96:111], v[184:187], v[176:179], v[96:111]
    ds_read_b64_tr_b16 v[160:161], v200 offset:4096
    ds_read_b64_tr_b16 v[162:163], v200 offset:4608
    s_waitcnt lgkmcnt(13)
    v_mfma_f32_32x32x16_bf16 v[112:127], v[180:183], v[188:191], v[112:127]
    ds_read_b128 v[164:167], v197 offset:20480
    s_waitcnt lgkmcnt(8)
    s_barrier
    ds_read_b128 v[168:171], v198 offset:16384
    v_mfma_f32_32x32x16_bf16 v[128:143], v[184:187], v[188:191], v[128:143]
    ds_read_b64_tr_b16 v[172:173], v200 offset:8192
    ds_read_b64_tr_b16 v[174:175], v200 offset:8704
    v_mfma_f32_32x32x16_bf16 v[80:95], v[244:247], v[240:243], v[80:95]
    ds_read_b128 v[176:179], v198 offset:20480
    ds_read_b128 v[180:183], v199 offset:16384
    v_mfma_f32_32x32x16_bf16 v[96:111], v[248:251], v[240:243], v[96:111]
    ds_read_b64_tr_b16 v[184:185], v200 offset:12288
    ds_read_b64_tr_b16 v[186:187], v200 offset:12800
    v_mfma_f32_32x32x16_bf16 v[112:127], v[244:247], v[252:255], v[112:127]
    v_mfma_f32_32x32x16_bf16 v[128:143], v[248:251], v[252:255], v[128:143]
    s_waitcnt lgkmcnt(12)
    v_mfma_f32_32x32x16_bf16 v[80:95], v[144:147], v[148:151], v[80:95]
    ds_read_b128 v[188:191], v199 offset:20480
    s_waitcnt lgkmcnt(8)
    s_barrier
    ds_read_b128 v[240:243], v196 offset:32768
    v_mfma_f32_32x32x16_bf16 v[96:111], v[152:155], v[148:151], v[96:111]
    ds_read_b64_tr_b16 v[244:245], v200 offset:16384
    ds_read_b64_tr_b16 v[246:247], v200 offset:16896
    s_nop 0
ST_A_100:
    s_cbranch_execz K1_CONS
    v_mfma_f32_32x32x16_bf16 v[80:95], v[156:159], v[160:163], v[80:95]
    ds_read_b128 v[248:251], v196 offset:36864
    ds_read_b128 v[252:255], v197 offset:32768
    v_mfma_f32_32x32x16_bf16 v[96:111], v[164:167], v[160:163], v[96:111]
    ds_read_b64_tr_b16 v[144:145], v200 offset:20480
    ds_read_b64_tr_b16 v[146:147], v200 offset:20992
    s_waitcnt lgkmcnt(12)
    v_mfma_f32_32x32x16_bf16 v[80:95], v[168:171], v[172:175], v[80:95]
    ds_read_b128 v[148:151], v197 offset:36864
    s_waitcnt lgkmcnt(8)
    s_barrier
    ds_read_b128 v[152:155], v198 offset:32768
    v_mfma_f32_32x32x16_bf16 v[96:111], v[176:179], v[172:175], v[96:111]
    ds_read_b64_tr_b16 v[156:157], v200 offset:24576
    ds_read_b64_tr_b16 v[158:159], v200 offset:25088
    v_mfma_f32_32x32x16_bf16 v[80:95], v[180:183], v[184:187], v[80:95]
    ds_read_b128 v[160:163], v198 offset:36864
    ds_read_b128 v[164:167], v199 offset:32768
    v_mfma_f32_32x32x16_bf16 v[96:111], v[188:191], v[184:187], v[96:111]
    ds_read_b64_tr_b16 v[168:169], v200 offset:28672
    ds_read_b64_tr_b16 v[170:171], v200 offset:29184
    s_waitcnt lgkmcnt(12)
    v_mfma_f32_32x32x16_bf16 v[80:95], v[240:243], v[244:247], v[80:95]
    ds_read_b128 v[172:175], v199 offset:36864
    ds_read_b128 v[176:179], v196 offset:16384
    s_waitcnt lgkmcnt(13)
    v_mfma_f32_32x32x16_bf16 v[96:111], v[248:251], v[244:247], v[96:111]
    ds_read_b64_tr_b16 v[180:181], v201 offset:0
    ds_read_b64_tr_b16 v[182:183], v201 offset:512
    s_waitcnt lgkmcnt(12)
    v_mfma_f32_32x32x16_bf16 v[80:95], v[252:255], v[144:147], v[80:95]
    ds_read_b128 v[184:187], v196 offset:20480
    ds_read_b128 v[188:191], v197 offset:16384
    s_waitcnt lgkmcnt(13)
    v_mfma_f32_32x32x16_bf16 v[96:111], v[148:151], v[144:147], v[96:111]
ST_A_101:
    s_cbranch_execz K1_CONS
    ds_read_b64_tr_b16 v[240:241], v201 offset:4096
    ds_read_b64_tr_b16 v[242:243], v201 offset:4608
    s_waitcnt lgkmcnt(12)
    v_mfma_f32_32x32x16_bf16 v[80:95], v[152:155], v[156:159], v[80:95]
    ds_read_b128 v[244:247], v197 offset:20480
    ds_read_b128 v[248:251], v198 offset:16384
    s_waitcnt lgkmcnt(13)
    v_mfma_f32_32x32x16_bf16 v[96:111], v[160:163], v[156:159], v[96:111]
    ds_read_b64_tr_b16 v[252:253], v201 offset:8192
    ds_read_b64_tr_b16 v[254:255], v201 offset:8704
    s_waitcnt lgkmcnt(12)
    v_mfma_f32_32x32x16_bf16 v[80:95], v[164:167], v[168:171], v[80:95]
    ds_read_b128 v[144:147], v198 offset:20480
    ds_read_b128 v[148:151], v199 offset:16384
    s_waitcnt lgkmcnt(13)
    v_mfma_f32_32x32x16_bf16 v[96:111], v[172:175], v[168:171], v[96:111]
    ds_read_b64_tr_b16 v[152:153], v201 offset:12288
    ds_read_b64_tr_b16 v[154:155], v201 offset:12800
    s_waitcnt lgkmcnt(12)
    v_mfma_f32_32x32x16_bf16 v[112:127], v[176:179], v[180:183], v[112:127]
    ds_read_b128 v[156:159], v199 offset:20480
    ds_read_b128 v[160:163], v196 offset:32768
    s_nop 1
    v_cvt_pk_bf16_f32 v204, v80, v81
    v_cvt_pk_bf16_f32 v205, v82, v83
    v_cvt_pk_bf16_f32 v206, v84, v85
    v_cvt_pk_bf16_f32 v207, v86, v87
    v_cvt_pk_bf16_f32 v208, v88, v89
    v_cvt_pk_bf16_f32 v209, v90, v91
    v_cvt_pk_bf16_f32 v210, v92, v93
    v_cvt_pk_bf16_f32 v211, v94, v95
    buffer_store_dwordx4 v[204:207], v232, s[32:35], s52 offen offset:0 sc1
    s_waitcnt lgkmcnt(13)
    v_mfma_f32_32x32x16_bf16 v[128:143], v[184:187], v[180:183], v[128:143]
    ds_read_b64_tr_b16 v[164:165], v201 offset:16384
ST_A_102:
    s_cbranch_execz K1_CONS
    ds_read_b64_tr_b16 v[166:167], v201 offset:16896
    buffer_store_dwordx4 v[208:211], v232, s[32:35], s52 offen offset:1024 sc1
    v_cvt_pk_bf16_f32 v216, v96, v97
    v_cvt_pk_bf16_f32 v217, v98, v99
    v_cvt_pk_bf16_f32 v218, v100, v101
    s_waitcnt lgkmcnt(12)
    v_mfma_f32_32x32x16_bf16 v[112:127], v[188:191], v[240:243], v[112:127]
    ds_read_b128 v[168:171], v196 offset:36864
    ds_read_b128 v[172:175], v197 offset:32768
    v_cvt_pk_bf16_f32 v219, v102, v103
    v_cvt_pk_bf16_f32 v220, v104, v105
    v_cvt_pk_bf16_f32 v221, v106, v107
    v_cvt_pk_bf16_f32 v222, v108, v109
    v_cvt_pk_bf16_f32 v223, v110, v111
    s_waitcnt lgkmcnt(13)
    v_mfma_f32_32x32x16_bf16 v[128:143], v[244:247], v[240:243], v[128:143]
    ds_read_b64_tr_b16 v[176:177], v201 offset:20480
    ds_read_b64_tr_b16 v[178:179], v201 offset:20992
    buffer_store_dwordx4 v[216:219], v232, s[32:35], s53 offen offset:0 sc1
    buffer_store_dwordx4 v[220:223], v232, s[32:35], s53 offen offset:1024 sc1
    s_waitcnt lgkmcnt(12)
    v_mfma_f32_32x32x16_bf16 v[112:127], v[248:251], v[252:255], v[112:127]
    ds_read_b128 v[180:183], v197 offset:36864
    ds_read_b128 v[184:187], v198 offset:32768
    s_waitcnt lgkmcnt(13)
    v_mfma_f32_32x32x16_bf16 v[128:143], v[144:147], v[252:255], v[128:143]
    ds_read_b64_tr_b16 v[188:189], v201 offset:24576
    ds_read_b64_tr_b16 v[190:191], v201 offset:25088
    s_waitcnt lgkmcnt(12)
    v_mfma_f32_32x32x16_bf16 v[112:127], v[148:151], v[152:155], v[112:127]
    ds_read_b128 v[240:243], v198 offset:36864
    ds_read_b128 v[244:247], v199 offset:32768
    s_waitcnt lgkmcnt(13)
    v_mfma_f32_32x32x16_bf16 v[128:143], v[156:159], v[152:155], v[128:143]
    s_nop 0
ST_A_103:
    s_cbranch_execz K1_CONS
    ds_read_b64_tr_b16 v[248:249], v201 offset:28672
    ds_read_b64_tr_b16 v[250:251], v201 offset:29184
    s_waitcnt lgkmcnt(12)
    v_mfma_f32_32x32x16_bf16 v[112:127], v[160:163], v[164:167], v[112:127]
    ds_read_b128 v[252:255], v199 offset:36864
    s_waitcnt lgkmcnt(12)
    v_mfma_f32_32x32x16_bf16 v[128:143], v[168:171], v[164:167], v[128:143]
    s_waitcnt lgkmcnt(9)
    v_mfma_f32_32x32x16_bf16 v[112:127], v[172:175], v[176:179], v[112:127]
    s_waitcnt lgkmcnt(8)
    v_mfma_f32_32x32x16_bf16 v[128:143], v[180:183], v[176:179], v[128:143]
    s_waitcnt lgkmcnt(5)
    v_mfma_f32_32x32x16_bf16 v[112:127], v[184:187], v[188:191], v[112:127]
    s_waitcnt lgkmcnt(4)
    v_mfma_f32_32x32x16_bf16 v[128:143], v[240:243], v[188:191], v[128:143]
    s_waitcnt lgkmcnt(1)
    v_mfma_f32_32x32x16_bf16 v[112:127], v[244:247], v[248:251], v[112:127]
    s_waitcnt lgkmcnt(0)
    v_mfma_f32_32x32x16_bf16 v[128:143], v[252:255], v[248:251], v[128:143]
    s_nop 9
    v_cvt_pk_bf16_f32 v204, v112, v113
    v_cvt_pk_bf16_f32 v205, v114, v115
    v_cvt_pk_bf16_f32 v206, v116, v117
    v_cvt_pk_bf16_f32 v207, v118, v119
    v_cvt_pk_bf16_f32 v208, v120, v121
    v_cvt_pk_bf16_f32 v209, v122, v123
    v_cvt_pk_bf16_f32 v210, v124, v125
    v_cvt_pk_bf16_f32 v211, v126, v127
    buffer_store_dwordx4 v[204:207], v233, s[32:35], s52 offen offset:0 sc1
    buffer_store_dwordx4 v[208:211], v233, s[32:35], s52 offen offset:1024 sc1
    v_cvt_pk_bf16_f32 v216, v128, v129
    v_cvt_pk_bf16_f32 v217, v130, v131
    v_cvt_pk_bf16_f32 v218, v132, v133
    v_cvt_pk_bf16_f32 v219, v134, v135
    v_cvt_pk_bf16_f32 v220, v136, v137
    v_cvt_pk_bf16_f32 v221, v138, v139
ST_A_104:
    s_cbranch_execz K1_CONS
    v_cvt_pk_bf16_f32 v222, v140, v141
    v_cvt_pk_bf16_f32 v223, v142, v143
    buffer_store_dwordx4 v[216:219], v233, s[32:35], s53 offen offset:0 sc1
    buffer_store_dwordx4 v[220:223], v233, s[32:35], s53 offen offset:1024 sc1
    s_endpgm
K1_CB:
    s_barrier
    ds_read_b128 v[144:147], v192 offset:0
    ds_read_b64_tr_b16 v[148:149], v200 offset:0
    ds_read_b64_tr_b16 v[150:151], v200 offset:512
    ds_read_b128 v[152:155], v192 offset:4096
    ds_read_b64_tr_b16 v[156:157], v201 offset:0
    ds_read_b64_tr_b16 v[158:159], v201 offset:512
    ds_read_b128 v[160:163], v193 offset:0
    ds_read_b64_tr_b16 v[164:165], v200 offset:4096
    ds_read_b64_tr_b16 v[166:167], v200 offset:4608
    ds_read_b128 v[168:171], v193 offset:4096
    ds_read_b64_tr_b16 v[172:173], v201 offset:4096
    ds_read_b64_tr_b16 v[174:175], v201 offset:4608
    s_barrier
    ds_read_b128 v[176:179], v194 offset:0
    ds_read_b64_tr_b16 v[180:181], v200 offset:8192
    ds_read_b64_tr_b16 v[182:183], v200 offset:8704
    s_waitcnt lgkmcnt(12)
    v_mfma_f32_32x32x16_bf16 v[16:31], v[144:147], v[148:151], 0
    ds_read_b128 v[184:187], v194 offset:4096
    ds_read_b64_tr_b16 v[188:189], v201 offset:8192
    ds_read_b64_tr_b16 v[190:191], v201 offset:8704
    s_waitcnt lgkmcnt(14)
    v_mfma_f32_32x32x16_bf16 v[32:47], v[152:155], v[148:151], 0
    ds_read_b128 v[240:243], v195 offset:0
    s_waitcnt lgkmcnt(13)
    v_mfma_f32_32x32x16_bf16 v[48:63], v[144:147], v[156:159], 0
    ds_read_b64_tr_b16 v[244:245], v200 offset:12288
    ds_read_b64_tr_b16 v[246:247], v200 offset:12800
    s_nop 0
ST_A_105:
    s_cbranch_execz K1_CONS
    v_mfma_f32_32x32x16_bf16 v[64:79], v[152:155], v[156:159], 0
    s_waitcnt lgkmcnt(12)
    v_mfma_f32_32x32x16_bf16 v[16:31], v[160:163], v[164:167], v[16:31]
    ds_read_b128 v[248:251], v195 offset:4096
    ds_read_b64_tr_b16 v[252:253], v201 offset:12288
    ds_read_b64_tr_b16 v[254:255], v201 offset:12800
    s_waitcnt lgkmcnt(14)
    v_mfma_f32_32x32x16_bf16 v[32:47], v[168:171], v[164:167], v[32:47]
    s_waitcnt lgkmcnt(12)
    s_barrier
    ds_read_b128 v[148:151], v192 offset:16384
    ds_read_b64_tr_b16 v[144:145], v200 offset:16384
    ds_read_b64_tr_b16 v[146:147], v200 offset:16896
    v_mfma_f32_32x32x16_bf16 v[48:63], v[160:163], v[172:175], v[48:63]
    v_mfma_f32_32x32x16_bf16 v[64:79], v[168:171], v[172:175], v[64:79]
    s_waitcnt lgkmcnt(12)
    v_mfma_f32_32x32x16_bf16 v[16:31], v[176:179], v[180:183], v[16:31]
    ds_read_b128 v[152:155], v192 offset:20480
    ds_read_b64_tr_b16 v[156:157], v201 offset:16384
    ds_read_b64_tr_b16 v[158:159], v201 offset:16896
    s_waitcnt lgkmcnt(14)
    v_mfma_f32_32x32x16_bf16 v[32:47], v[184:187], v[180:183], v[32:47]
    ds_read_b128 v[164:167], v193 offset:16384
    s_waitcnt lgkmcnt(13)
    v_mfma_f32_32x32x16_bf16 v[48:63], v[176:179], v[188:191], v[48:63]
    ds_read_b64_tr_b16 v[160:161], v200 offset:20480
    ds_read_b64_tr_b16 v[162:163], v200 offset:20992
    v_mfma_f32_32x32x16_bf16 v[64:79], v[184:187], v[188:191], v[64:79]
    s_waitcnt lgkmcnt(12)
    v_mfma_f32_32x32x16_bf16 v[16:31], v[240:243], v[244:247], v[16:31]
    ds_read_b128 v[168:171], v193 offset:20480
    ds_read_b64_tr_b16 v[172:173], v201 offset:20480
    ds_read_b64_tr_b16 v[174:175], v201 offset:20992
    s_waitcnt lgkmcnt(14)
    v_mfma_f32_32x32x16_bf16 v[32:47], v[248:251], v[244:247], v[32:47]
    s_waitcnt lgkmcnt(12)
    s_barrier
ST_A_106:
    s_cbranch_execz K1_CONS
    ds_read_b128 v[180:183], v194 offset:16384
    ds_read_b64_tr_b16 v[176:177], v200 offset:24576
    ds_read_b64_tr_b16 v[178:179], v200 offset:25088
    v_mfma_f32_32x32x16_bf16 v[48:63], v[240:243], v[252:255], v[48:63]
    v_mfma_f32_32x32x16_bf16 v[64:79], v[248:251], v[252:255], v[64:79]
    s_waitcnt lgkmcnt(12)
    v_mfma_f32_32x32x16_bf16 v[16:31], v[148:151], v[144:147], v[16:31]
    ds_read_b128 v[184:187], v194 offset:20480
    ds_read_b64_tr_b16 v[188:189], v201 offset:24576
    ds_read_b64_tr_b16 v[190:191], v201 offset:25088
    s_waitcnt lgkmcnt(14)
    v_mfma_f32_32x32x16_bf16 v[32:47], v[152:155], v[144:147], v[32:47]
    ds_read_b128 v[244:247], v195 offset:16384
    s_waitcnt lgkmcnt(13)
    v_mfma_f32_32x32x16_bf16 v[48:63], v[148:151], v[156:159], v[48:63]
    ds_read_b64_tr_b16 v[240:241], v200 offset:28672
    ds_read_b64_tr_b16 v[242:243], v200 offset:29184
    v_mfma_f32_32x32x16_bf16 v[64:79], v[152:155], v[156:159], v[64:79]
    s_waitcnt lgkmcnt(12)
    v_mfma_f32_32x32x16_bf16 v[16:31], v[164:167], v[160:163], v[16:31]
    ds_read_b128 v[248:251], v195 offset:20480
    ds_read_b64_tr_b16 v[252:253], v201 offset:28672
    ds_read_b64_tr_b16 v[254:255], v201 offset:29184
    s_waitcnt lgkmcnt(14)
    v_mfma_f32_32x32x16_bf16 v[32:47], v[168:171], v[160:163], v[32:47]
    s_waitcnt lgkmcnt(12)
    s_barrier
    ds_read_b128 v[144:147], v192 offset:32768
    ds_read_b64_tr_b16 v[148:149], v200 offset:32768
    ds_read_b64_tr_b16 v[150:151], v200 offset:33280
    v_mfma_f32_32x32x16_bf16 v[48:63], v[164:167], v[172:175], v[48:63]
    v_mfma_f32_32x32x16_bf16 v[64:79], v[168:171], v[172:175], v[64:79]
    s_waitcnt lgkmcnt(12)
    v_mfma_f32_32x32x16_bf16 v[16:31], v[180:183], v[176:179], v[16:31]
    ds_read_b128 v[152:155], v192 offset:36864
    s_nop 0
ST_A_107:
    s_cbranch_execz K1_CONS
    ds_read_b64_tr_b16 v[156:157], v201 offset:32768
    ds_read_b64_tr_b16 v[158:159], v201 offset:33280
    s_waitcnt lgkmcnt(14)
    v_mfma_f32_32x32x16_bf16 v[32:47], v[184:187], v[176:179], v[32:47]
    ds_read_b128 v[160:163], v193 offset:32768
    s_waitcnt lgkmcnt(13)
    v_mfma_f32_32x32x16_bf16 v[48:63], v[180:183], v[188:191], v[48:63]
    ds_read_b64_tr_b16 v[164:165], v200 offset:36864
    ds_read_b64_tr_b16 v[166:167], v200 offset:37376
    v_mfma_f32_32x32x16_bf16 v[64:79], v[184:187], v[188:191], v[64:79]
    s_waitcnt lgkmcnt(12)
    v_mfma_f32_32x32x16_bf16 v[16:31], v[244:247], v[240:243], v[16:31]
    ds_read_b128 v[168:171], v193 offset:36864
    ds_read_b64_tr_b16 v[172:173], v201 offset:36864
    ds_read_b64_tr_b16 v[174:175], v201 offset:37376
    s_waitcnt lgkmcnt(14)
    v_mfma_f32_32x32x16_bf16 v[32:47], v[248:251], v[240:243], v[32:47]
    s_waitcnt lgkmcnt(12)
    s_barrier
    ds_read_b128 v[176:179], v194 offset:32768
    ds_read_b64_tr_b16 v[180:181], v200 offset:0
    ds_read_b64_tr_b16 v[182:183], v200 offset:512
    v_mfma_f32_32x32x16_bf16 v[48:63], v[244:247], v[252:255], v[48:63]
    v_mfma_f32_32x32x16_bf16 v[64:79], v[248:251], v[252:255], v[64:79]
    s_waitcnt lgkmcnt(12)
    v_mfma_f32_32x32x16_bf16 v[16:31], v[144:147], v[148:151], v[16:31]
    ds_read_b128 v[184:187], v194 offset:36864
    ds_read_b64_tr_b16 v[188:189], v201 offset:0
    ds_read_b64_tr_b16 v[190:191], v201 offset:512
    s_waitcnt lgkmcnt(14)
    v_mfma_f32_32x32x16_bf16 v[32:47], v[152:155], v[148:151], v[32:47]
    ds_read_b128 v[240:243], v195 offset:32768
    s_waitcnt lgkmcnt(13)
    v_mfma_f32_32x32x16_bf16 v[48:63], v[144:147], v[156:159], v[48:63]
    ds_read_b64_tr_b16 v[244:245], v200 offset:4096
    ds_read_b64_tr_b16 v[246:247], v200 offset:4608
ST_A_108:
    s_cbranch_execz K1_CONS
    v_mfma_f32_32x32x16_bf16 v[64:79], v[152:155], v[156:159], v[64:79]
    s_waitcnt lgkmcnt(12)
    v_mfma_f32_32x32x16_bf16 v[16:31], v[160:163], v[164:167], v[16:31]
    ds_read_b128 v[248:251], v195 offset:36864
    ds_read_b64_tr_b16 v[252:253], v201 offset:4096
    ds_read_b64_tr_b16 v[254:255], v201 offset:4608
    s_waitcnt lgkmcnt(14)
    v_mfma_f32_32x32x16_bf16 v[32:47], v[168:171], v[164:167], v[32:47]
    s_waitcnt lgkmcnt(12)
    s_barrier
    ds_read_b128 v[148:151], v192 offset:49152
    ds_read_b64_tr_b16 v[144:145], v200 offset:8192
    ds_read_b64_tr_b16 v[146:147], v200 offset:8704
    v_mfma_f32_32x32x16_bf16 v[48:63], v[160:163], v[172:175], v[48:63]
    v_mfma_f32_32x32x16_bf16 v[64:79], v[168:171], v[172:175], v[64:79]
    s_waitcnt lgkmcnt(12)
    v_mfma_f32_32x32x16_bf16 v[16:31], v[176:179], v[180:183], v[16:31]
    ds_read_b128 v[152:155], v192 offset:53248
    ds_read_b64_tr_b16 v[156:157], v201 offset:8192
    ds_read_b64_tr_b16 v[158:159], v201 offset:8704
    s_waitcnt lgkmcnt(14)
    v_mfma_f32_32x32x16_bf16 v[32:47], v[184:187], v[180:183], v[32:47]
    ds_read_b128 v[164:167], v193 offset:49152
    s_waitcnt lgkmcnt(13)
    v_mfma_f32_32x32x16_bf16 v[48:63], v[176:179], v[188:191], v[48:63]
    ds_read_b64_tr_b16 v[160:161], v200 offset:12288
    ds_read_b64_tr_b16 v[162:163], v200 offset:12800
    v_mfma_f32_32x32x16_bf16 v[64:79], v[184:187], v[188:191], v[64:79]
    s_waitcnt lgkmcnt(12)
    v_mfma_f32_32x32x16_bf16 v[16:31], v[240:243], v[244:247], v[16:31]
    ds_read_b128 v[168:171], v193 offset:53248
    ds_read_b64_tr_b16 v[172:173], v201 offset:12288
    ds_read_b64_tr_b16 v[174:175], v201 offset:12800
    s_waitcnt lgkmcnt(14)
    v_mfma_f32_32x32x16_bf16 v[32:47], v[248:251], v[244:247], v[32:47]
    s_waitcnt lgkmcnt(12)
    s_barrier
ST_A_109:
    s_cbranch_execz K1_CONS
    ds_read_b128 v[180:183], v194 offset:49152
    ds_read_b64_tr_b16 v[176:177], v200 offset:16384
    ds_read_b64_tr_b16 v[178:179], v200 offset:16896
    v_mfma_f32_32x32x16_bf16 v[48:63], v[240:243], v[252:255], v[48:63]
    v_mfma_f32_32x32x16_bf16 v[64:79], v[248:251], v[252:255], v[64:79]
    s_waitcnt lgkmcnt(12)
    v_mfma_f32_32x32x16_bf16 v[16:31], v[148:151], v[144:147], v[16:31]
    ds_read_b128 v[184:187], v194 offset:53248
    ds_read_b64_tr_b16 v[188:189], v201 offset:16384
    ds_read_b64_tr_b16 v[190:191], v201 offset:16896
    s_waitcnt lgkmcnt(14)
    v_mfma_f32_32x32x16_bf16 v[32:47], v[152:155], v[144:147], v[32:47]
    ds_read_b128 v[244:247], v195 offset:49152
    s_waitcnt lgkmcnt(13)
    v_mfma_f32_32x32x16_bf16 v[48:63], v[148:151], v[156:159], v[48:63]
    ds_read_b64_tr_b16 v[240:241], v200 offset:20480
    ds_read_b64_tr_b16 v[242:243], v200 offset:20992
    v_mfma_f32_32x32x16_bf16 v[64:79], v[152:155], v[156:159], v[64:79]
    s_waitcnt lgkmcnt(12)
    v_mfma_f32_32x32x16_bf16 v[16:31], v[164:167], v[160:163], v[16:31]
    ds_read_b128 v[248:251], v195 offset:53248
    ds_read_b64_tr_b16 v[252:253], v201 offset:20480
    ds_read_b64_tr_b16 v[254:255], v201 offset:20992
    s_waitcnt lgkmcnt(14)
    v_mfma_f32_32x32x16_bf16 v[32:47], v[168:171], v[160:163], v[32:47]
    s_waitcnt lgkmcnt(12)
    s_barrier
    ds_read_b128 v[144:147], v196 offset:0
    ds_read_b64_tr_b16 v[148:149], v200 offset:24576
    ds_read_b64_tr_b16 v[150:151], v200 offset:25088
    v_mfma_f32_32x32x16_bf16 v[48:63], v[164:167], v[172:175], v[48:63]
    v_mfma_f32_32x32x16_bf16 v[64:79], v[168:171], v[172:175], v[64:79]
    s_waitcnt lgkmcnt(12)
    v_mfma_f32_32x32x16_bf16 v[16:31], v[180:183], v[176:179], v[16:31]
    ds_read_b128 v[152:155], v196 offset:4096
    s_nop 0
ST_A_110:
    s_cbranch_execz K1_CONS
    ds_read_b64_tr_b16 v[156:157], v201 offset:24576
    ds_read_b64_tr_b16 v[158:159], v201 offset:25088
    s_waitcnt lgkmcnt(14)
    v_mfma_f32_32x32x16_bf16 v[32:47], v[184:187], v[176:179], v[32:47]
    ds_read_b128 v[160:163], v197 offset:0
    s_waitcnt lgkmcnt(13)
    v_mfma_f32_32x32x16_bf16 v[48:63], v[180:183], v[188:191], v[48:63]
    ds_read_b64_tr_b16 v[164:165], v200 offset:28672
    ds_read_b64_tr_b16 v[166:167], v200 offset:29184
    v_mfma_f32_32x32x16_bf16 v[64:79], v[184:187], v[188:191], v[64:79]
    s_waitcnt lgkmcnt(12)
    v_mfma_f32_32x32x16_bf16 v[16:31], v[244:247], v[240:243], v[16:31]
    ds_read_b128 v[168:171], v197 offset:4096
    ds_read_b64_tr_b16 v[172:173], v201 offset:28672
    ds_read_b64_tr_b16 v[174:175], v201 offset:29184
    s_waitcnt lgkmcnt(14)
    v_mfma_f32_32x32x16_bf16 v[32:47], v[248:251], v[240:243], v[32:47]
    s_waitcnt lgkmcnt(12)
    s_barrier
    ds_read_b128 v[176:179], v198 offset:0
    ds_read_b64_tr_b16 v[180:181], v200 offset:32768
    ds_read_b64_tr_b16 v[182:183], v200 offset:33280
    v_mfma_f32_32x32x16_bf16 v[48:63], v[244:247], v[252:255], v[48:63]
    v_mfma_f32_32x32x16_bf16 v[64:79], v[248:251], v[252:255], v[64:79]
    s_waitcnt lgkmcnt(12)
    v_mfma_f32_32x32x16_bf16 v[16:31], v[144:147], v[148:151], v[16:31]
    ds_read_b128 v[184:187], v198 offset:4096
    ds_read_b64_tr_b16 v[188:189], v201 offset:32768
    ds_read_b64_tr_b16 v[190:191], v201 offset:33280
    s_waitcnt lgkmcnt(14)
    v_mfma_f32_32x32x16_bf16 v[32:47], v[152:155], v[148:151], v[32:47]
    ds_read_b128 v[240:243], v199 offset:0
    s_waitcnt lgkmcnt(13)
    v_mfma_f32_32x32x16_bf16 v[48:63], v[144:147], v[156:159], v[48:63]
    ds_read_b64_tr_b16 v[244:245], v200 offset:36864
    ds_read_b64_tr_b16 v[246:247], v200 offset:37376
ST_A_111:
    s_cbranch_execz K1_CONS
    v_mfma_f32_32x32x16_bf16 v[64:79], v[152:155], v[156:159], v[64:79]
    s_waitcnt lgkmcnt(12)
    v_mfma_f32_32x32x16_bf16 v[16:31], v[160:163], v[164:167], v[16:31]
    ds_read_b128 v[248:251], v199 offset:4096
    ds_read_b64_tr_b16 v[252:253], v201 offset:36864
    ds_read_b64_tr_b16 v[254:255], v201 offset:37376
    s_waitcnt lgkmcnt(14)
    v_mfma_f32_32x32x16_bf16 v[32:47], v[168:171], v[164:167], v[32:47]
    s_waitcnt lgkmcnt(12)
    s_barrier
    ds_read_b128 v[148:151], v196 offset:16384
    ds_read_b64_tr_b16 v[144:145], v200 offset:0
    ds_read_b64_tr_b16 v[146:147], v200 offset:512
    v_mfma_f32_32x32x16_bf16 v[48:63], v[160:163], v[172:175], v[48:63]
    v_mfma_f32_32x32x16_bf16 v[64:79], v[168:171], v[172:175], v[64:79]
    s_waitcnt lgkmcnt(12)
    v_mfma_f32_32x32x16_bf16 v[16:31], v[176:179], v[180:183], v[16:31]
    ds_read_b128 v[152:155], v196 offset:20480
    ds_read_b64_tr_b16 v[156:157], v201 offset:0
    ds_read_b64_tr_b16 v[158:159], v201 offset:512
    s_waitcnt lgkmcnt(14)
    v_mfma_f32_32x32x16_bf16 v[32:47], v[184:187], v[180:183], v[32:47]
    ds_read_b128 v[164:167], v197 offset:16384
    s_waitcnt lgkmcnt(13)
    v_mfma_f32_32x32x16_bf16 v[48:63], v[176:179], v[188:191], v[48:63]
    ds_read_b64_tr_b16 v[160:161], v200 offset:4096
    ds_read_b64_tr_b16 v[162:163], v200 offset:4608
    v_mfma_f32_32x32x16_bf16 v[64:79], v[184:187], v[188:191], v[64:79]
    s_waitcnt lgkmcnt(12)
    v_mfma_f32_32x32x16_bf16 v[16:31], v[240:243], v[244:247], v[16:31]
    ds_read_b128 v[168:171], v197 offset:20480
    ds_read_b64_tr_b16 v[172:173], v201 offset:4096
    ds_read_b64_tr_b16 v[174:175], v201 offset:4608
    s_waitcnt lgkmcnt(14)
    v_mfma_f32_32x32x16_bf16 v[32:47], v[248:251], v[244:247], v[32:47]
    s_waitcnt lgkmcnt(12)
    s_barrier
ST_A_112:
    s_cbranch_execz K1_CONS
    ds_read_b128 v[180:183], v198 offset:16384
    ds_read_b64_tr_b16 v[176:177], v200 offset:8192
    ds_read_b64_tr_b16 v[178:179], v200 offset:8704
    v_mfma_f32_32x32x16_bf16 v[48:63], v[240:243], v[252:255], v[48:63]
    v_mfma_f32_32x32x16_bf16 v[64:79], v[248:251], v[252:255], v[64:79]
    s_waitcnt lgkmcnt(12)
    v_mfma_f32_32x32x16_bf16 v[16:31], v[148:151], v[144:147], v[16:31]
    ds_read_b128 v[184:187], v198 offset:20480
    ds_read_b64_tr_b16 v[188:189], v201 offset:8192
    ds_read_b64_tr_b16 v[190:191], v201 offset:8704
    s_waitcnt lgkmcnt(14)
    v_mfma_f32_32x32x16_bf16 v[32:47], v[152:155], v[144:147], v[32:47]
    ds_read_b128 v[244:247], v199 offset:16384
    s_waitcnt lgkmcnt(13)
    v_mfma_f32_32x32x16_bf16 v[48:63], v[148:151], v[156:159], v[48:63]
    ds_read_b64_tr_b16 v[240:241], v200 offset:12288
    ds_read_b64_tr_b16 v[242:243], v200 offset:12800
    v_mfma_f32_32x32x16_bf16 v[64:79], v[152:155], v[156:159], v[64:79]
    s_waitcnt lgkmcnt(12)
    v_mfma_f32_32x32x16_bf16 v[16:31], v[164:167], v[160:163], v[16:31]
    ds_read_b128 v[248:251], v199 offset:20480
    ds_read_b64_tr_b16 v[252:253], v201 offset:12288
    ds_read_b64_tr_b16 v[254:255], v201 offset:12800
    s_waitcnt lgkmcnt(14)
    v_mfma_f32_32x32x16_bf16 v[32:47], v[168:171], v[160:163], v[32:47]
    s_waitcnt lgkmcnt(12)
    s_barrier
    ds_read_b128 v[144:147], v196 offset:32768
    ds_read_b64_tr_b16 v[148:149], v200 offset:16384
    ds_read_b64_tr_b16 v[150:151], v200 offset:16896
    v_mfma_f32_32x32x16_bf16 v[48:63], v[164:167], v[172:175], v[48:63]
    v_mfma_f32_32x32x16_bf16 v[64:79], v[168:171], v[172:175], v[64:79]
    s_waitcnt lgkmcnt(12)
    v_mfma_f32_32x32x16_bf16 v[16:31], v[180:183], v[176:179], v[16:31]
    ds_read_b128 v[152:155], v196 offset:36864
    s_nop 0
ST_A_113:
    s_cbranch_execz K1_CONS
    ds_read_b64_tr_b16 v[156:157], v201 offset:16384
    ds_read_b64_tr_b16 v[158:159], v201 offset:16896
    s_waitcnt lgkmcnt(14)
    v_mfma_f32_32x32x16_bf16 v[32:47], v[184:187], v[176:179], v[32:47]
    ds_read_b128 v[160:163], v197 offset:32768
    s_waitcnt lgkmcnt(13)
    v_mfma_f32_32x32x16_bf16 v[48:63], v[180:183], v[188:191], v[48:63]
    ds_read_b64_tr_b16 v[164:165], v200 offset:20480
    ds_read_b64_tr_b16 v[166:167], v200 offset:20992
    v_mfma_f32_32x32x16_bf16 v[64:79], v[184:187], v[188:191], v[64:79]
    s_waitcnt lgkmcnt(12)
    v_mfma_f32_32x32x16_bf16 v[16:31], v[244:247], v[240:243], v[16:31]
    ds_read_b128 v[168:171], v197 offset:36864
    ds_read_b64_tr_b16 v[172:173], v201 offset:20480
    ds_read_b64_tr_b16 v[174:175], v201 offset:20992
    s_waitcnt lgkmcnt(14)
    v_mfma_f32_32x32x16_bf16 v[32:47], v[248:251], v[240:243], v[32:47]
    s_waitcnt lgkmcnt(12)
    s_barrier
    ds_read_b128 v[176:179], v198 offset:32768
    ds_read_b64_tr_b16 v[180:181], v200 offset:24576
    ds_read_b64_tr_b16 v[182:183], v200 offset:25088
    v_mfma_f32_32x32x16_bf16 v[48:63], v[244:247], v[252:255], v[48:63]
    v_mfma_f32_32x32x16_bf16 v[64:79], v[248:251], v[252:255], v[64:79]
    s_waitcnt lgkmcnt(12)
    v_mfma_f32_32x32x16_bf16 v[16:31], v[144:147], v[148:151], v[16:31]
    ds_read_b128 v[184:187], v198 offset:36864
    ds_read_b64_tr_b16 v[188:189], v201 offset:24576
    ds_read_b64_tr_b16 v[190:191], v201 offset:25088
    s_waitcnt lgkmcnt(14)
    v_mfma_f32_32x32x16_bf16 v[32:47], v[152:155], v[148:151], v[32:47]
    ds_read_b128 v[240:243], v199 offset:32768
    s_waitcnt lgkmcnt(13)
    v_mfma_f32_32x32x16_bf16 v[48:63], v[144:147], v[156:159], v[48:63]
    ds_read_b64_tr_b16 v[244:245], v200 offset:28672
    ds_read_b64_tr_b16 v[246:247], v200 offset:29184
ST_A_114:
    s_cbranch_execz K1_CONS
    v_mfma_f32_32x32x16_bf16 v[64:79], v[152:155], v[156:159], v[64:79]
    s_waitcnt lgkmcnt(12)
    v_mfma_f32_32x32x16_bf16 v[16:31], v[160:163], v[164:167], v[16:31]
    ds_read_b128 v[248:251], v199 offset:36864
    ds_read_b64_tr_b16 v[252:253], v201 offset:28672
    ds_read_b64_tr_b16 v[254:255], v201 offset:29184
    s_waitcnt lgkmcnt(14)
    v_mfma_f32_32x32x16_bf16 v[32:47], v[168:171], v[164:167], v[32:47]
    s_waitcnt lgkmcnt(12)
    s_barrier
    ds_read_b128 v[148:151], v192 offset:0
    ds_read_b64_tr_b16 v[144:145], v203 offset:32768
    ds_read_b64_tr_b16 v[146:147], v203 offset:33280
    v_mfma_f32_32x32x16_bf16 v[48:63], v[160:163], v[172:175], v[48:63]
    v_mfma_f32_32x32x16_bf16 v[64:79], v[168:171], v[172:175], v[64:79]
    s_waitcnt lgkmcnt(12)
    v_mfma_f32_32x32x16_bf16 v[16:31], v[176:179], v[180:183], v[16:31]
    ds_read_b128 v[152:155], v192 offset:4096
    ds_read_b128 v[156:159], v235 offset:0
    s_waitcnt lgkmcnt(13)
    v_mfma_f32_32x32x16_bf16 v[32:47], v[184:187], v[180:183], v[32:47]
    ds_read_b128 v[164:167], v193 offset:0
    s_waitcnt lgkmcnt(12)
    v_mfma_f32_32x32x16_bf16 v[48:63], v[176:179], v[188:191], v[48:63]
    ds_read_b64_tr_b16 v[160:161], v203 offset:34816
    ds_read_b64_tr_b16 v[162:163], v203 offset:35328
    v_mfma_f32_32x32x16_bf16 v[64:79], v[184:187], v[188:191], v[64:79]
    ds_read_b128 v[168:171], v193 offset:4096
    s_waitcnt lgkmcnt(12)
    v_mfma_f32_32x32x16_bf16 v[16:31], v[240:243], v[244:247], v[16:31]
    ds_read_b128 v[172:175], v235 offset:32
    s_waitcnt lgkmcnt(12)
    v_mfma_f32_32x32x16_bf16 v[32:47], v[248:251], v[244:247], v[32:47]
    ds_read_b128 v[180:183], v194 offset:0
    ds_read_b64_tr_b16 v[176:177], v203 offset:36864
    ds_read_b64_tr_b16 v[178:179], v203 offset:37376
ST_A_115:
    s_cbranch_execz K1_CONS
    s_waitcnt lgkmcnt(13)
    v_mfma_f32_32x32x16_bf16 v[48:63], v[240:243], v[252:255], v[48:63]
    ds_read_b128 v[184:187], v194 offset:4096
    s_nop 2
    v_cvt_pk_bf16_f32 v204, v16, v17
    v_cvt_pk_bf16_f32 v205, v18, v19
    v_cvt_pk_bf16_f32 v206, v20, v21
    v_cvt_pk_bf16_f32 v207, v22, v23
    v_cvt_pk_bf16_f32 v208, v24, v25
    v_mfma_f32_32x32x16_bf16 v[64:79], v[248:251], v[252:255], v[64:79]
    ds_read_b128 v[188:191], v235 offset:64
    v_cvt_pk_bf16_f32 v209, v26, v27
    v_cvt_pk_bf16_f32 v210, v28, v29
    v_cvt_pk_bf16_f32 v211, v30, v31
    s_waitcnt lgkmcnt(12)
    v_mfma_f32_32x32x16_bf16 v[80:95], v[148:151], v[144:147], 0
    buffer_store_dwordx4 v[204:207], v230, s[32:35], s52 offen offset:0 sc1
    buffer_store_dwordx4 v[208:211], v230, s[32:35], s52 offen offset:1024 sc1
    s_waitcnt lgkmcnt(11)
    v_mfma_f32_32x32x16_bf16 v[96:111], v[152:155], v[144:147], 0
    ds_read_b128 v[244:247], v195 offset:0
    ds_read_b64_tr_b16 v[240:241], v203 offset:38912
    ds_read_b64_tr_b16 v[242:243], v203 offset:39424
    v_cvt_pk_bf16_f32 v216, v32, v33
    v_cvt_pk_bf16_f32 v217, v34, v35
    s_waitcnt lgkmcnt(13)
    v_mfma_f32_32x32x16_bf16 v[112:127], v[156:159], v[148:151], 0
    ds_read_b128 v[248:251], v195 offset:4096
    v_cvt_pk_bf16_f32 v218, v36, v37
    v_cvt_pk_bf16_f32 v219, v38, v39
    v_cvt_pk_bf16_f32 v220, v40, v41
    v_mfma_f32_32x32x16_bf16 v[128:143], v[156:159], v[152:155], 0
    ds_read_b128 v[252:255], v235 offset:96
    v_cvt_pk_bf16_f32 v221, v42, v43
ST_A_116:
    s_cbranch_execz K1_CONS
    v_cvt_pk_bf16_f32 v222, v44, v45
    v_cvt_pk_bf16_f32 v223, v46, v47
    s_waitcnt lgkmcnt(12)
    v_mfma_f32_32x32x16_bf16 v[80:95], v[164:167], v[160:163], v[80:95]
    buffer_store_dwordx4 v[216:219], v230, s[32:35], s53 offen offset:0 sc1
    buffer_store_dwordx4 v[220:223], v230, s[32:35], s53 offen offset:1024 sc1
    s_waitcnt lgkmcnt(11)
    v_mfma_f32_32x32x16_bf16 v[96:111], v[168:171], v[160:163], v[96:111]
    s_barrier
    ds_read_b128 v[144:147], v192 offset:16384
    ds_read_b64_tr_b16 v[148:149], v203 offset:0
    ds_read_b64_tr_b16 v[150:151], v203 offset:512
    v_cvt_pk_bf16_f32 v204, v48, v49
    v_cvt_pk_bf16_f32 v205, v50, v51
    s_waitcnt lgkmcnt(13)
    v_mfma_f32_32x32x16_bf16 v[112:127], v[172:175], v[164:167], v[112:127]
    ds_read_b128 v[152:155], v192 offset:20480
    v_cvt_pk_bf16_f32 v206, v52, v53
    v_cvt_pk_bf16_f32 v207, v54, v55
    v_cvt_pk_bf16_f32 v208, v56, v57
    v_mfma_f32_32x32x16_bf16 v[128:143], v[172:175], v[168:171], v[128:143]
    ds_read_b128 v[156:159], v235 offset:128
    v_cvt_pk_bf16_f32 v209, v58, v59
    v_cvt_pk_bf16_f32 v210, v60, v61
    v_cvt_pk_bf16_f32 v211, v62, v63
    s_waitcnt lgkmcnt(12)
    v_mfma_f32_32x32x16_bf16 v[80:95], v[180:183], v[176:179], v[80:95]
    buffer_store_dwordx4 v[204:207], v231, s[32:35], s52 offen offset:0 sc1
    buffer_store_dwordx4 v[208:211], v231, s[32:35], s52 offen offset:1024 sc1
    s_waitcnt lgkmcnt(11)
    v_mfma_f32_32x32x16_bf16 v[96:111], v[184:187], v[176:179], v[96:111]
    ds_read_b128 v[160:163], v193 offset:16384
    ds_read_b64_tr_b16 v[164:165], v203 offset:2048
    ds_read_b64_tr_b16 v[166:167], v203 offset:2560
    s_nop 0
ST_A_117:
    s_cbranch_execz K1_CONS
    v_cvt_pk_bf16_f32 v216, v64, v65
    v_cvt_pk_bf16_f32 v217, v66, v67
    s_waitcnt lgkmcnt(13)
    v_mfma_f32_32x32x16_bf16 v[112:127], v[188:191], v[180:183], v[112:127]
    ds_read_b128 v[168:171], v193 offset:20480
    v_cvt_pk_bf16_f32 v218, v68, v69
    v_cvt_pk_bf16_f32 v219, v70, v71
    v_cvt_pk_bf16_f32 v220, v72, v73
    v_mfma_f32_32x32x16_bf16 v[128:143], v[188:191], v[184:187], v[128:143]
    ds_read_b128 v[172:175], v235 offset:160
    v_cvt_pk_bf16_f32 v221, v74, v75
    v_cvt_pk_bf16_f32 v222, v76, v77
    v_cvt_pk_bf16_f32 v223, v78, v79
    s_waitcnt lgkmcnt(12)
    v_mfma_f32_32x32x16_bf16 v[80:95], v[244:247], v[240:243], v[80:95]
    buffer_store_dwordx4 v[216:219], v231, s[32:35], s53 offen offset:0 sc1
    buffer_store_dwordx4 v[220:223], v231, s[32:35], s53 offen offset:1024 sc1
    s_waitcnt lgkmcnt(11)
    v_mfma_f32_32x32x16_bf16 v[96:111], v[248:251], v[240:243], v[96:111]
    ds_read_b128 v[176:179], v194 offset:16384
    ds_read_b64_tr_b16 v[180:181], v203 offset:4096
    ds_read_b64_tr_b16 v[182:183], v203 offset:4608
    s_waitcnt lgkmcnt(13)
    v_mfma_f32_32x32x16_bf16 v[112:127], v[252:255], v[244:247], v[112:127]
    ds_read_b128 v[184:187], v194 offset:20480
    v_mfma_f32_32x32x16_bf16 v[128:143], v[252:255], v[248:251], v[128:143]
    ds_read_b128 v[188:191], v235 offset:192
    s_waitcnt lgkmcnt(12)
    v_mfma_f32_32x32x16_bf16 v[80:95], v[144:147], v[148:151], v[80:95]
    s_waitcnt lgkmcnt(11)
    v_mfma_f32_32x32x16_bf16 v[96:111], v[152:155], v[148:151], v[96:111]
    ds_read_b128 v[240:243], v195 offset:16384
    ds_read_b64_tr_b16 v[244:245], v203 offset:6144
    ds_read_b64_tr_b16 v[246:247], v203 offset:6656
    s_waitcnt lgkmcnt(13)
ST_A_118:
    s_cbranch_execz K1_CONS
    v_mfma_f32_32x32x16_bf16 v[112:127], v[156:159], v[144:147], v[112:127]
    ds_read_b128 v[248:251], v195 offset:20480
    v_mfma_f32_32x32x16_bf16 v[128:143], v[156:159], v[152:155], v[128:143]
    ds_read_b128 v[252:255], v235 offset:224
    s_waitcnt lgkmcnt(12)
    v_mfma_f32_32x32x16_bf16 v[80:95], v[160:163], v[164:167], v[80:95]
    s_waitcnt lgkmcnt(11)
    v_mfma_f32_32x32x16_bf16 v[96:111], v[168:171], v[164:167], v[96:111]
    s_barrier
    ds_read_b128 v[148:151], v192 offset:32768
    ds_read_b64_tr_b16 v[144:145], v203 offset:8192
    ds_read_b64_tr_b16 v[146:147], v203 offset:8704
    s_waitcnt lgkmcnt(13)
    v_mfma_f32_32x32x16_bf16 v[112:127], v[172:175], v[160:163], v[112:127]
    ds_read_b128 v[152:155], v192 offset:36864
    v_mfma_f32_32x32x16_bf16 v[128:143], v[172:175], v[168:171], v[128:143]
    ds_read_b128 v[156:159], v235 offset:256
    s_waitcnt lgkmcnt(12)
    v_mfma_f32_32x32x16_bf16 v[80:95], v[176:179], v[180:183], v[80:95]
    s_waitcnt lgkmcnt(11)
    v_mfma_f32_32x32x16_bf16 v[96:111], v[184:187], v[180:183], v[96:111]
    ds_read_b128 v[164:167], v193 offset:32768
    ds_read_b64_tr_b16 v[160:161], v203 offset:10240
    ds_read_b64_tr_b16 v[162:163], v203 offset:10752
    s_waitcnt lgkmcnt(13)
    v_mfma_f32_32x32x16_bf16 v[112:127], v[188:191], v[176:179], v[112:127]
    ds_read_b128 v[168:171], v193 offset:36864
    v_mfma_f32_32x32x16_bf16 v[128:143], v[188:191], v[184:187], v[128:143]
    ds_read_b128 v[172:175], v235 offset:288
    s_waitcnt lgkmcnt(12)
    v_mfma_f32_32x32x16_bf16 v[80:95], v[240:243], v[244:247], v[80:95]
    s_waitcnt lgkmcnt(11)
    v_mfma_f32_32x32x16_bf16 v[96:111], v[248:251], v[244:247], v[96:111]
    ds_read_b128 v[180:183], v194 offset:32768
    ds_read_b64_tr_b16 v[176:177], v203 offset:12288
    ds_read_b64_tr_b16 v[178:179], v203 offset:12800
ST_A_119:
    s_cbranch_execz K1_CONS
    s_waitcnt lgkmcnt(13)
    v_mfma_f32_32x32x16_bf16 v[112:127], v[252:255], v[240:243], v[112:127]
    ds_read_b128 v[184:187], v194 offset:36864
    v_mfma_f32_32x32x16_bf16 v[128:143], v[252:255], v[248:251], v[128:143]
    ds_read_b128 v[188:191], v235 offset:320
    s_waitcnt lgkmcnt(12)
    v_mfma_f32_32x32x16_bf16 v[80:95], v[148:151], v[144:147], v[80:95]
    s_waitcnt lgkmcnt(11)
    v_mfma_f32_32x32x16_bf16 v[96:111], v[152:155], v[144:147], v[96:111]
    ds_read_b128 v[244:247], v195 offset:32768
    ds_read_b64_tr_b16 v[240:241], v203 offset:14336
    ds_read_b64_tr_b16 v[242:243], v203 offset:14848
    s_waitcnt lgkmcnt(13)
    v_mfma_f32_32x32x16_bf16 v[112:127], v[156:159], v[148:151], v[112:127]
    ds_read_b128 v[248:251], v195 offset:36864
    v_mfma_f32_32x32x16_bf16 v[128:143], v[156:159], v[152:155], v[128:143]
    ds_read_b128 v[252:255], v235 offset:352
    s_waitcnt lgkmcnt(12)
    v_mfma_f32_32x32x16_bf16 v[80:95], v[164:167], v[160:163], v[80:95]
    s_waitcnt lgkmcnt(11)
    v_mfma_f32_32x32x16_bf16 v[96:111], v[168:171], v[160:163], v[96:111]
    s_barrier
    ds_read_b128 v[144:147], v192 offset:49152
    ds_read_b64_tr_b16 v[148:149], v203 offset:16384
    ds_read_b64_tr_b16 v[150:151], v203 offset:16896
    s_waitcnt lgkmcnt(13)
    v_mfma_f32_32x32x16_bf16 v[112:127], v[172:175], v[164:167], v[112:127]
    ds_read_b128 v[152:155], v192 offset:53248
    v_mfma_f32_32x32x16_bf16 v[128:143], v[172:175], v[168:171], v[128:143]
    ds_read_b128 v[156:159], v235 offset:384
    s_waitcnt lgkmcnt(12)
    v_mfma_f32_32x32x16_bf16 v[80:95], v[180:183], v[176:179], v[80:95]
    s_waitcnt lgkmcnt(11)
    v_mfma_f32_32x32x16_bf16 v[96:111], v[184:187], v[176:179], v[96:111]
    ds_read_b128 v[160:163], v193 offset:49152
    ds_read_b64_tr_b16 v[164:165], v203 offset:18432
    s_nop 0
ST_A_120:
    s_cbranch_execz K1_CONS
    ds_read_b64_tr_b16 v[166:167], v203 offset:18944
    s_waitcnt lgkmcnt(13)
    v_mfma_f32_32x32x16_bf16 v[112:127], v[188:191], v[180:183], v[112:127]
    ds_read_b128 v[168:171], v193 offset:53248
    v_mfma_f32_32x32x16_bf16 v[128:143], v[188:191], v[184:187], v[128:143]
    ds_read_b128 v[172:175], v235 offset:416
    s_waitcnt lgkmcnt(12)
    v_mfma_f32_32x32x16_bf16 v[80:95], v[244:247], v[240:243], v[80:95]
    s_waitcnt lgkmcnt(11)
    v_mfma_f32_32x32x16_bf16 v[96:111], v[248:251], v[240:243], v[96:111]
    ds_read_b128 v[176:179], v194 offset:49152
    ds_read_b64_tr_b16 v[180:181], v203 offset:20480
    ds_read_b64_tr_b16 v[182:183], v203 offset:20992
    s_waitcnt lgkmcnt(13)
    v_mfma_f32_32x32x16_bf16 v[112:127], v[252:255], v[244:247], v[112:127]
    ds_read_b128 v[184:187], v194 offset:53248
    v_mfma_f32_32x32x16_bf16 v[128:143], v[252:255], v[248:251], v[128:143]
    ds_read_b128 v[188:191], v235 offset:448
    s_waitcnt lgkmcnt(12)
    v_mfma_f32_32x32x16_bf16 v[80:95], v[144:147], v[148:151], v[80:95]
    s_waitcnt lgkmcnt(11)
    v_mfma_f32_32x32x16_bf16 v[96:111], v[152:155], v[148:151], v[96:111]
    ds_read_b128 v[240:243], v195 offset:49152
    ds_read_b64_tr_b16 v[244:245], v203 offset:22528
    ds_read_b64_tr_b16 v[246:247], v203 offset:23040
    s_waitcnt lgkmcnt(13)
    v_mfma_f32_32x32x16_bf16 v[112:127], v[156:159], v[144:147], v[112:127]
    ds_read_b128 v[248:251], v195 offset:53248
    v_mfma_f32_32x32x16_bf16 v[128:143], v[156:159], v[152:155], v[128:143]
    ds_read_b128 v[252:255], v235 offset:480
    s_waitcnt lgkmcnt(12)
    v_mfma_f32_32x32x16_bf16 v[80:95], v[160:163], v[164:167], v[80:95]
    s_waitcnt lgkmcnt(11)
    v_mfma_f32_32x32x16_bf16 v[96:111], v[168:171], v[164:167], v[96:111]
    s_barrier
    ds_read_b128 v[148:151], v196 offset:0
    s_nop 0
ST_A_121:
    s_cbranch_execz K1_CONS
    ds_read_b64_tr_b16 v[144:145], v203 offset:24576
    ds_read_b64_tr_b16 v[146:147], v203 offset:25088
    s_waitcnt lgkmcnt(13)
    v_mfma_f32_32x32x16_bf16 v[112:127], v[172:175], v[160:163], v[112:127]
    ds_read_b128 v[152:155], v196 offset:4096
    v_mfma_f32_32x32x16_bf16 v[128:143], v[172:175], v[168:171], v[128:143]
    ds_read_b128 v[156:159], v235 offset:512
    s_waitcnt lgkmcnt(12)
    v_mfma_f32_32x32x16_bf16 v[80:95], v[176:179], v[180:183], v[80:95]
    s_waitcnt lgkmcnt(11)
    v_mfma_f32_32x32x16_bf16 v[96:111], v[184:187], v[180:183], v[96:111]
    ds_read_b128 v[164:167], v197 offset:0
    ds_read_b64_tr_b16 v[160:161], v203 offset:26624
    ds_read_b64_tr_b16 v[162:163], v203 offset:27136
    s_waitcnt lgkmcnt(13)
    v_mfma_f32_32x32x16_bf16 v[112:127], v[188:191], v[176:179], v[112:127]
    ds_read_b128 v[168:171], v197 offset:4096
    v_mfma_f32_32x32x16_bf16 v[128:143], v[188:191], v[184:187], v[128:143]
    ds_read_b128 v[172:175], v235 offset:544
    s_waitcnt lgkmcnt(12)
    v_mfma_f32_32x32x16_bf16 v[80:95], v[240:243], v[244:247], v[80:95]
    s_waitcnt lgkmcnt(11)
    v_mfma_f32_32x32x16_bf16 v[96:111], v[248:251], v[244:247], v[96:111]
    ds_read_b128 v[180:183], v198 offset:0
    ds_read_b64_tr_b16 v[176:177], v203 offset:28672
    ds_read_b64_tr_b16 v[178:179], v203 offset:29184
    s_waitcnt lgkmcnt(13)
    v_mfma_f32_32x32x16_bf16 v[112:127], v[252:255], v[240:243], v[112:127]
    ds_read_b128 v[184:187], v198 offset:4096
    v_mfma_f32_32x32x16_bf16 v[128:143], v[252:255], v[248:251], v[128:143]
    ds_read_b128 v[188:191], v235 offset:576
    s_waitcnt lgkmcnt(12)
    v_mfma_f32_32x32x16_bf16 v[80:95], v[148:151], v[144:147], v[80:95]
    s_waitcnt lgkmcnt(11)
    v_mfma_f32_32x32x16_bf16 v[96:111], v[152:155], v[144:147], v[96:111]
    ds_read_b128 v[244:247], v199 offset:0
ST_A_122:
    s_cbranch_execz K1_CONS
    ds_read_b64_tr_b16 v[240:241], v203 offset:30720
    ds_read_b64_tr_b16 v[242:243], v203 offset:31232
    s_waitcnt lgkmcnt(13)
    v_mfma_f32_32x32x16_bf16 v[112:127], v[156:159], v[148:151], v[112:127]
    ds_read_b128 v[248:251], v199 offset:4096
    v_mfma_f32_32x32x16_bf16 v[128:143], v[156:159], v[152:155], v[128:143]
    ds_read_b128 v[252:255], v235 offset:608
    s_waitcnt lgkmcnt(12)
    v_mfma_f32_32x32x16_bf16 v[80:95], v[164:167], v[160:163], v[80:95]
    s_waitcnt lgkmcnt(11)
    v_mfma_f32_32x32x16_bf16 v[96:111], v[168:171], v[160:163], v[96:111]
    s_barrier
    ds_read_b128 v[144:147], v196 offset:16384
    ds_read_b64_tr_b16 v[148:149], v203 offset:32768
    ds_read_b64_tr_b16 v[150:151], v203 offset:33280
    s_waitcnt lgkmcnt(13)
    v_mfma_f32_32x32x16_bf16 v[112:127], v[172:175], v[164:167], v[112:127]
    ds_read_b128 v[152:155], v196 offset:20480
    v_mfma_f32_32x32x16_bf16 v[128:143], v[172:175], v[168:171], v[128:143]
    ds_read_b128 v[156:159], v235 offset:640
    s_waitcnt lgkmcnt(12)
    v_mfma_f32_32x32x16_bf16 v[80:95], v[180:183], v[176:179], v[80:95]
    s_waitcnt lgkmcnt(11)
    v_mfma_f32_32x32x16_bf16 v[96:111], v[184:187], v[176:179], v[96:111]
    ds_read_b128 v[160:163], v197 offset:16384
    ds_read_b64_tr_b16 v[164:165], v203 offset:34816
    ds_read_b64_tr_b16 v[166:167], v203 offset:35328
    s_waitcnt lgkmcnt(13)
    v_mfma_f32_32x32x16_bf16 v[112:127], v[188:191], v[180:183], v[112:127]
    ds_read_b128 v[168:171], v197 offset:20480
    v_mfma_f32_32x32x16_bf16 v[128:143], v[188:191], v[184:187], v[128:143]
    ds_read_b128 v[172:175], v235 offset:672
    s_waitcnt lgkmcnt(12)
    v_mfma_f32_32x32x16_bf16 v[80:95], v[244:247], v[240:243], v[80:95]
    s_waitcnt lgkmcnt(11)
    v_mfma_f32_32x32x16_bf16 v[96:111], v[248:251], v[240:243], v[96:111]
    s_nop 0
ST_A_123:
    s_cbranch_execz K1_CONS
    ds_read_b128 v[176:179], v198 offset:16384
    ds_read_b64_tr_b16 v[180:181], v203 offset:36864
    ds_read_b64_tr_b16 v[182:183], v203 offset:37376
    s_waitcnt lgkmcnt(13)
    v_mfma_f32_32x32x16_bf16 v[112:127], v[252:255], v[244:247], v[112:127]
    ds_read_b128 v[184:187], v198 offset:20480
    v_mfma_f32_32x32x16_bf16 v[128:143], v[252:255], v[248:251], v[128:143]
    ds_read_b128 v[188:191], v235 offset:704
    s_waitcnt lgkmcnt(12)
    v_mfma_f32_32x32x16_bf16 v[80:95], v[144:147], v[148:151], v[80:95]
    s_waitcnt lgkmcnt(11)
    v_mfma_f32_32x32x16_bf16 v[96:111], v[152:155], v[148:151], v[96:111]
    ds_read_b128 v[240:243], v199 offset:16384
    ds_read_b64_tr_b16 v[244:245], v203 offset:38912
    ds_read_b64_tr_b16 v[246:247], v203 offset:39424
    s_waitcnt lgkmcnt(13)
    v_mfma_f32_32x32x16_bf16 v[112:127], v[156:159], v[144:147], v[112:127]
    ds_read_b128 v[248:251], v199 offset:20480
    v_mfma_f32_32x32x16_bf16 v[128:143], v[156:159], v[152:155], v[128:143]
    ds_read_b128 v[252:255], v235 offset:736
    s_waitcnt lgkmcnt(12)
    v_mfma_f32_32x32x16_bf16 v[80:95], v[160:163], v[164:167], v[80:95]
    s_waitcnt lgkmcnt(11)
    v_mfma_f32_32x32x16_bf16 v[96:111], v[168:171], v[164:167], v[96:111]
    s_barrier
    ds_read_b128 v[148:151], v196 offset:32768
    ds_read_b64_tr_b16 v[144:145], v203 offset:0
    ds_read_b64_tr_b16 v[146:147], v203 offset:512
    s_waitcnt lgkmcnt(13)
    v_mfma_f32_32x32x16_bf16 v[112:127], v[172:175], v[160:163], v[112:127]
    ds_read_b128 v[152:155], v196 offset:36864
    v_mfma_f32_32x32x16_bf16 v[128:143], v[172:175], v[168:171], v[128:143]
    ds_read_b128 v[156:159], v235 offset:768
    s_waitcnt lgkmcnt(12)
    v_mfma_f32_32x32x16_bf16 v[80:95], v[176:179], v[180:183], v[80:95]
    s_waitcnt lgkmcnt(11)
    s_nop 0
ST_A_124:
    s_cbranch_execz K1_CONS
    v_mfma_f32_32x32x16_bf16 v[96:111], v[184:187], v[180:183], v[96:111]
    ds_read_b128 v[164:167], v197 offset:32768
    ds_read_b64_tr_b16 v[160:161], v203 offset:2048
    ds_read_b64_tr_b16 v[162:163], v203 offset:2560
    s_waitcnt lgkmcnt(13)
    v_mfma_f32_32x32x16_bf16 v[112:127], v[188:191], v[176:179], v[112:127]
    ds_read_b128 v[168:171], v197 offset:36864
    v_mfma_f32_32x32x16_bf16 v[128:143], v[188:191], v[184:187], v[128:143]
    ds_read_b128 v[172:175], v235 offset:800
    s_waitcnt lgkmcnt(12)
    v_mfma_f32_32x32x16_bf16 v[80:95], v[240:243], v[244:247], v[80:95]
    s_waitcnt lgkmcnt(11)
    v_mfma_f32_32x32x16_bf16 v[96:111], v[248:251], v[244:247], v[96:111]
    ds_read_b128 v[180:183], v198 offset:32768
    ds_read_b64_tr_b16 v[176:177], v203 offset:4096
    ds_read_b64_tr_b16 v[178:179], v203 offset:4608
    s_waitcnt lgkmcnt(13)
    v_mfma_f32_32x32x16_bf16 v[112:127], v[252:255], v[240:243], v[112:127]
    ds_read_b128 v[184:187], v198 offset:36864
    v_mfma_f32_32x32x16_bf16 v[128:143], v[252:255], v[248:251], v[128:143]
    ds_read_b128 v[188:191], v235 offset:832
    s_waitcnt lgkmcnt(12)
    v_mfma_f32_32x32x16_bf16 v[80:95], v[148:151], v[144:147], v[80:95]
    s_waitcnt lgkmcnt(11)
    v_mfma_f32_32x32x16_bf16 v[96:111], v[152:155], v[144:147], v[96:111]
    ds_read_b128 v[244:247], v199 offset:32768
    ds_read_b64_tr_b16 v[240:241], v203 offset:6144
    ds_read_b64_tr_b16 v[242:243], v203 offset:6656
    s_waitcnt lgkmcnt(13)
    v_mfma_f32_32x32x16_bf16 v[112:127], v[156:159], v[148:151], v[112:127]
    ds_read_b128 v[248:251], v199 offset:36864
    v_mfma_f32_32x32x16_bf16 v[128:143], v[156:159], v[152:155], v[128:143]
    ds_read_b128 v[252:255], v235 offset:864
    s_waitcnt lgkmcnt(12)
    v_mfma_f32_32x32x16_bf16 v[80:95], v[164:167], v[160:163], v[80:95]
    s_waitcnt lgkmcnt(11)
ST_A_125:
    s_cbranch_execz K1_CONS
    v_mfma_f32_32x32x16_bf16 v[96:111], v[168:171], v[160:163], v[96:111]
    s_waitcnt lgkmcnt(10)
    v_mfma_f32_32x32x16_bf16 v[112:127], v[172:175], v[164:167], v[112:127]
    v_mfma_f32_32x32x16_bf16 v[128:143], v[172:175], v[168:171], v[128:143]
    s_waitcnt lgkmcnt(7)
    v_mfma_f32_32x32x16_bf16 v[80:95], v[180:183], v[176:179], v[80:95]
    s_waitcnt lgkmcnt(6)
    v_mfma_f32_32x32x16_bf16 v[96:111], v[184:187], v[176:179], v[96:111]
    s_waitcnt lgkmcnt(5)
    v_mfma_f32_32x32x16_bf16 v[112:127], v[188:191], v[180:183], v[112:127]
    v_mfma_f32_32x32x16_bf16 v[128:143], v[188:191], v[184:187], v[128:143]
    s_waitcnt lgkmcnt(2)
    v_mfma_f32_32x32x16_bf16 v[80:95], v[244:247], v[240:243], v[80:95]
    s_waitcnt lgkmcnt(1)
    v_mfma_f32_32x32x16_bf16 v[96:111], v[248:251], v[240:243], v[96:111]
    s_waitcnt lgkmcnt(0)
    v_mfma_f32_32x32x16_bf16 v[112:127], v[252:255], v[244:247], v[112:127]
    s_nop 7
    v_cvt_pk_bf16_f32 v204, v80, v81
    v_cvt_pk_bf16_f32 v205, v82, v83
    v_cvt_pk_bf16_f32 v206, v84, v85
    v_cvt_pk_bf16_f32 v207, v86, v87
    v_cvt_pk_bf16_f32 v208, v88, v89
    v_mfma_f32_32x32x16_bf16 v[128:143], v[252:255], v[248:251], v[128:143]
    v_cvt_pk_bf16_f32 v209, v90, v91
    v_cvt_pk_bf16_f32 v210, v92, v93
    v_cvt_pk_bf16_f32 v211, v94, v95
    buffer_store_dwordx4 v[204:207], v234, s[32:35], s52 offen offset:0 sc1
    buffer_store_dwordx4 v[208:211], v234, s[32:35], s52 offen offset:1024 sc1
    v_cvt_pk_bf16_f32 v216, v96, v97
    v_cvt_pk_bf16_f32 v217, v98, v99
    v_cvt_pk_bf16_f32 v218, v100, v101
    v_cvt_pk_bf16_f32 v219, v102, v103
    v_cvt_pk_bf16_f32 v220, v104, v105
    v_cvt_pk_bf16_f32 v221, v106, v107
    s_nop 0
ST_A_126:
    s_cbranch_execz K1_CONS
    v_cvt_pk_bf16_f32 v222, v108, v109
    v_cvt_pk_bf16_f32 v223, v110, v111
    buffer_store_dwordx4 v[216:219], v234, s[32:35], s53 offen offset:0 sc1
    buffer_store_dwordx4 v[220:223], v234, s[32:35], s53 offen offset:1024 sc1
    v_mul_f32 v212, s55, v112
    v_exp_f32 v212, v212
    s_nop 0
    v_add_f32 v212, 1.0, v212
    v_rcp_f32 v212, v212
    s_mov_b64 exec, s[46:47]
    buffer_store_dword v212, v236, s[32:35], s56 offen offset:0 sc1
    s_mov_b64 exec, -1
    v_mul_f32 v224, s55, v128
    v_exp_f32 v224, v224
    s_nop 0
    v_add_f32 v224, 1.0, v224
    v_rcp_f32 v224, v224
    s_mov_b64 exec, s[46:47]
    buffer_store_dword v224, v236, s[32:35], s56 offen offset:128 sc1
    s_mov_b64 exec, -1
K1_END:
    s_endpgm
.p2align 8
.globl k2_kernel
.type k2_kernel,@function
k2_kernel:
    s_cmp_ge_u32 s2, 256
ST_C_0:
    s_cbranch_execz K1_CONS
    s_cbranch_scc1 K2_END
    s_load_dwordx2 s[32:33], s[0:1], 80
    v_lshrrev_b32 v2, 6, v0
    v_and_b32 v0, 63, v0
    v_lshlrev_b32 v1, 4, v0
    v_readfirstlane_b32 s3, v2
    s_and_b32 s6, s2, 7
    s_lshr_b32 s7, s2, 3
    s_mov_b32 s66, s3
    s_mov_b32 s34, 29360128
    s_mov_b32 s35, 0x00020000
    s_cmp_ge_u32 s3, 8
    s_cbranch_scc1 K2_GEMM
    s_xor_b32 s39, s3, 4
    s_lshl_b32 s4, s6, 1
    s_and_b32 s8, s7, 1
    s_add_u32 s4, s4, s8
    s_lshr_b32 s5, s7, 1
    s_mul_i32 s8, s4, 7
    s_lshr_b32 s8, s8, 1
    s_lshl_b32 s8, s8, 9
    s_mul_i32 s10, s5, 229376
    s_add_u32 s10, s10, s8
    s_mul_i32 s38, s3, 458752
    s_add_u32 s38, s38, s8
    s_add_u32 s38, s38, 28672
    s_add_u32 s11, s10, 57344
    s_add_u32 s36, s10, 114688
    s_add_u32 s37, s10, 172032
    s_lshl_b32 s8, s4, 6
    s_lshl_b32 s9, s3, 3
    s_add_u32 s9, s9, s8
    s_lshl_b32 s12, s9, 11
    s_add_u32 s12, s12, 4194304
    s_and_b32 s42, s4, 1
    s_sub_u32 s41, s42, 1
    s_sub_u32 s42, 0, s42
    s_mov_b32 s40, 0
    s_mov_b32 s43, 0
    s_mov_b32 s14, 0
    s_lshl_b32 s15, s5, 2
    s_lshr_b32 s16, s39, 1
    s_add_u32 s15, s15, s16
    s_lshl_b32 s15, s15, 7
    s_add_u32 s15, s15, 18874368
    v_and_b32 v165, 31, v0
    v_lshlrev_b32 v165, 2, v165
    s_waitcnt lgkmcnt(0)
    buffer_load_dwordx4 v[2:5], v1, s[32:35], s10 offen offset:0
    buffer_load_dwordx4 v[6:9], v1, s[32:35], s10 offen offset:1024
ST_C_1:
    s_cbranch_execz K1_CONS
    s_add_u32 s13, s38, 0
    buffer_load_dwordx4 v[130:133], v1, s[32:35], s13 offen offset:0
    buffer_load_dwordx4 v[134:137], v1, s[32:35], s13 offen offset:1024
    s_barrier
    buffer_load_dwordx4 v[10:13], v1, s[32:35], s11 offen offset:0
    buffer_load_dwordx4 v[14:17], v1, s[32:35], s11 offen offset:1024
    buffer_load_dwordx4 v[18:21], v1, s[32:35], s36 offen offset:0
    buffer_load_dwordx4 v[22:25], v1, s[32:35], s36 offen offset:1024
    buffer_load_dwordx4 v[26:29], v1, s[32:35], s37 offen offset:0
    buffer_load_dwordx4 v[30:33], v1, s[32:35], s37 offen offset:1024
    buffer_load_dword v165, v165, s[32:35], s15 offen
K2_RUN:
    s_add_u32 s13, s12, 0
    buffer_load_dwordx4 v[146:149], v1, s[32:35], s13 offen offset:0
    buffer_load_dwordx4 v[150:153], v1, s[32:35], s13 offen offset:1024
    s_add_u32 s13, s38, 57344
    buffer_load_dwordx4 v[138:141], v1, s[32:35], s13 offen offset:0
    buffer_load_dwordx4 v[142:145], v1, s[32:35], s13 offen offset:1024
    s_add_u32 s13, s12, 2048
    buffer_load_dwordx4 v[154:157], v1, s[32:35], s13 offen offset:0
    buffer_load_dwordx4 v[158:161], v1, s[32:35], s13 offen offset:1024
    s_lshl_b32 s15, s3, 2
    s_add_u32 s15, s15, 114688
    v_lshl_add_u32 v163, v0, 5, s15
    s_waitcnt vmcnt(13)
    s_cmp_lg_u32 s14, 0
    s_cbranch_scc1 K2_FQ0
    v_cndmask_b32 v2, v2, 0, s[42:43]
    v_cndmask_b32 v3, v3, 0, s[42:43]
    v_cndmask_b32 v8, v8, 0, s[40:41]
    v_cndmask_b32 v9, v9, 0, s[40:41]
K2_FQ0:
    s_cbranch_scc0 K2_FK0
    v_mov_b32 v162, 0x3f803f80
    v_cndmask_b32 v130, v130, v162, s[42:43]
    v_cndmask_b32 v131, v131, v162, s[42:43]
    v_cndmask_b32 v136, v136, v162, s[40:41]
    v_cndmask_b32 v137, v137, v162, s[40:41]
ST_C_2:
    s_cbranch_execz K1_CONS
    s_nop 1
K2_FK0:
    s_nop 0
    v_mfma_f32_32x32x16_bf16 v[98:113], v[130:133], v[2:5], 0
    v_mfma_f32_32x32x16_bf16 v[98:113], v[134:137], v[6:9], v[98:113]
    s_cmp_ge_u32 s3, 4
    s_setprio 2
    s_cbranch_scc1 K2_AP0
    s_setprio 3
K2_AP0:
    s_nop 7
    v_exp_f32 v98, v98
    v_exp_f32 v99, v99
    v_exp_f32 v100, v100
    v_exp_f32 v101, v101
    v_exp_f32 v102, v102
    v_exp_f32 v103, v103
    v_cvt_pk_bf16_f32 v98, v98, v99
    s_waitcnt vmcnt(11)
    s_cmp_lg_u32 s14, 0
    s_cbranch_scc1 K2_FQ1
    v_cndmask_b32 v10, v10, 0, s[42:43]
    v_cndmask_b32 v11, v11, 0, s[42:43]
    v_cndmask_b32 v16, v16, 0, s[40:41]
    v_cndmask_b32 v17, v17, 0, s[40:41]
K2_FQ1:
    s_nop 1
    v_mfma_f32_32x32x16_bf16 v[114:129], v[130:133], v[10:13], 0
    v_exp_f32 v104, v104
    v_exp_f32 v105, v105
    v_exp_f32 v106, v106
    v_cvt_pk_bf16_f32 v99, v100, v101
    v_cvt_pk_bf16_f32 v100, v102, v103
    v_mfma_f32_32x32x16_bf16 v[114:129], v[134:137], v[14:17], v[114:129]
    v_exp_f32 v107, v107
    v_exp_f32 v108, v108
    v_exp_f32 v109, v109
    v_exp_f32 v110, v110
    v_exp_f32 v111, v111
    v_exp_f32 v112, v112
    v_exp_f32 v113, v113
    v_cvt_pk_bf16_f32 v101, v104, v105
    v_cvt_pk_bf16_f32 v102, v106, v107
    v_cvt_pk_bf16_f32 v103, v108, v109
    v_cvt_pk_bf16_f32 v104, v110, v111
    v_cvt_pk_bf16_f32 v105, v112, v113
    s_waitcnt vmcnt(4)
    v_mfma_f32_32x32x16_bf16 v[34:49], v[146:149], v[98:101], 0
ST_C_3:
    s_cbranch_execz K1_CONS
    v_exp_f32 v114, v114
    v_exp_f32 v115, v115
    v_exp_f32 v116, v116
    v_mfma_f32_32x32x16_bf16 v[34:49], v[150:153], v[102:105], v[34:49]
    v_exp_f32 v117, v117
    v_exp_f32 v118, v118
    v_exp_f32 v119, v119
    v_cvt_pk_bf16_f32 v114, v114, v115
    s_cmp_lg_u32 s14, 0
    s_cbranch_scc1 K2_FQ2
    v_cndmask_b32 v18, v18, 0, s[42:43]
    v_cndmask_b32 v19, v19, 0, s[42:43]
    v_cndmask_b32 v24, v24, 0, s[40:41]
    v_cndmask_b32 v25, v25, 0, s[40:41]
K2_FQ2:
    s_nop 1
    v_mfma_f32_32x32x16_bf16 v[98:113], v[130:133], v[18:21], 0
    v_exp_f32 v120, v120
    v_exp_f32 v121, v121
    v_exp_f32 v122, v122
    v_cvt_pk_bf16_f32 v115, v116, v117
    v_cvt_pk_bf16_f32 v116, v118, v119
    v_mfma_f32_32x32x16_bf16 v[98:113], v[134:137], v[22:25], v[98:113]
    v_exp_f32 v123, v123
    v_exp_f32 v124, v124
    v_exp_f32 v125, v125
    v_exp_f32 v126, v126
    v_exp_f32 v127, v127
    v_exp_f32 v128, v128
    v_exp_f32 v129, v129
    v_cvt_pk_bf16_f32 v117, v120, v121
    v_cvt_pk_bf16_f32 v118, v122, v123
    v_cvt_pk_bf16_f32 v119, v124, v125
    v_cvt_pk_bf16_f32 v120, v126, v127
    v_cvt_pk_bf16_f32 v121, v128, v129
    v_mfma_f32_32x32x16_bf16 v[50:65], v[146:149], v[114:117], 0
    v_exp_f32 v98, v98
    v_exp_f32 v99, v99
    v_exp_f32 v100, v100
    v_mfma_f32_32x32x16_bf16 v[50:65], v[150:153], v[118:121], v[50:65]
    v_exp_f32 v101, v101
    v_exp_f32 v102, v102
    v_exp_f32 v103, v103
    v_cvt_pk_bf16_f32 v98, v98, v99
    s_cmp_lg_u32 s14, 0
    s_cbranch_scc1 K2_FQ3
ST_C_4:
    s_cbranch_execz K1_CONS
    v_cndmask_b32 v26, v26, 0, s[42:43]
    v_cndmask_b32 v27, v27, 0, s[42:43]
    v_cndmask_b32 v32, v32, 0, s[40:41]
    v_cndmask_b32 v33, v33, 0, s[40:41]
K2_FQ3:
    s_nop 1
    v_mfma_f32_32x32x16_bf16 v[114:129], v[130:133], v[26:29], 0
    v_exp_f32 v104, v104
    v_exp_f32 v105, v105
    v_exp_f32 v106, v106
    v_cvt_pk_bf16_f32 v99, v100, v101
    v_cvt_pk_bf16_f32 v100, v102, v103
    v_mfma_f32_32x32x16_bf16 v[114:129], v[134:137], v[30:33], v[114:129]
    s_add_u32 s13, s38, 114688
    buffer_load_dwordx4 v[130:133], v1, s[32:35], s13 offen offset:0
    buffer_load_dwordx4 v[134:137], v1, s[32:35], s13 offen offset:1024
    v_exp_f32 v107, v107
    v_exp_f32 v108, v108
    v_exp_f32 v109, v109
    v_exp_f32 v110, v110
    v_exp_f32 v111, v111
    v_exp_f32 v112, v112
    v_exp_f32 v113, v113
    v_cvt_pk_bf16_f32 v101, v104, v105
    v_cvt_pk_bf16_f32 v102, v106, v107
    v_cvt_pk_bf16_f32 v103, v108, v109
    v_cvt_pk_bf16_f32 v104, v110, v111
    v_cvt_pk_bf16_f32 v105, v112, v113
    v_mfma_f32_32x32x16_bf16 v[66:81], v[146:149], v[98:101], 0
    v_exp_f32 v114, v114
    v_exp_f32 v115, v115
    v_exp_f32 v116, v116
    v_mfma_f32_32x32x16_bf16 v[66:81], v[150:153], v[102:105], v[66:81]
    v_exp_f32 v117, v117
    v_exp_f32 v118, v118
    v_exp_f32 v119, v119
    v_cvt_pk_bf16_f32 v114, v114, v115
    s_waitcnt vmcnt(4)
    s_cmp_lg_u32 s14, 0
    s_cbranch_scc0 K2_FK1
    v_mov_b32 v162, 0x3f803f80
    v_cndmask_b32 v138, v138, v162, s[42:43]
    v_cndmask_b32 v139, v139, v162, s[42:43]
ST_C_5:
    s_cbranch_execz K1_CONS
    v_cndmask_b32 v144, v144, v162, s[40:41]
    v_cndmask_b32 v145, v145, v162, s[40:41]
    s_nop 1
K2_FK1:
    v_mfma_f32_32x32x16_bf16 v[98:113], v[138:141], v[2:5], 0
    v_exp_f32 v120, v120
    v_exp_f32 v121, v121
    v_exp_f32 v122, v122
    v_cvt_pk_bf16_f32 v115, v116, v117
    v_cvt_pk_bf16_f32 v116, v118, v119
    v_mfma_f32_32x32x16_bf16 v[98:113], v[142:145], v[6:9], v[98:113]
    v_exp_f32 v123, v123
    v_exp_f32 v124, v124
    v_exp_f32 v125, v125
    v_exp_f32 v126, v126
    v_exp_f32 v127, v127
    v_exp_f32 v128, v128
    v_exp_f32 v129, v129
    v_cvt_pk_bf16_f32 v117, v120, v121
    v_cvt_pk_bf16_f32 v118, v122, v123
    v_cvt_pk_bf16_f32 v119, v124, v125
    v_cvt_pk_bf16_f32 v120, v126, v127
    v_cvt_pk_bf16_f32 v121, v128, v129
    v_mfma_f32_32x32x16_bf16 v[82:97], v[146:149], v[114:117], 0
    v_exp_f32 v98, v98
    v_exp_f32 v99, v99
    v_exp_f32 v100, v100
    v_mfma_f32_32x32x16_bf16 v[82:97], v[150:153], v[118:121], v[82:97]
    s_add_u32 s13, s12, 4096
    buffer_load_dwordx4 v[146:149], v1, s[32:35], s13 offen offset:0
    buffer_load_dwordx4 v[150:153], v1, s[32:35], s13 offen offset:1024
    v_exp_f32 v101, v101
    v_exp_f32 v102, v102
    v_exp_f32 v103, v103
    v_cvt_pk_bf16_f32 v98, v98, v99
    v_mfma_f32_32x32x16_bf16 v[114:129], v[138:141], v[10:13], 0
    v_exp_f32 v104, v104
    v_exp_f32 v105, v105
    v_exp_f32 v106, v106
    v_cvt_pk_bf16_f32 v99, v100, v101
    v_cvt_pk_bf16_f32 v100, v102, v103
    v_mfma_f32_32x32x16_bf16 v[114:129], v[142:145], v[14:17], v[114:129]
ST_C_6:
    s_cbranch_execz K1_CONS
    v_exp_f32 v107, v107
    v_exp_f32 v108, v108
    v_exp_f32 v109, v109
    v_exp_f32 v110, v110
    v_exp_f32 v111, v111
    v_exp_f32 v112, v112
    v_exp_f32 v113, v113
    v_cvt_pk_bf16_f32 v101, v104, v105
    v_cvt_pk_bf16_f32 v102, v106, v107
    v_cvt_pk_bf16_f32 v103, v108, v109
    v_cvt_pk_bf16_f32 v104, v110, v111
    v_cvt_pk_bf16_f32 v105, v112, v113
    s_waitcnt vmcnt(4)
    v_mfma_f32_32x32x16_bf16 v[34:49], v[154:157], v[98:101], v[34:49]
    v_exp_f32 v114, v114
    v_exp_f32 v115, v115
    v_exp_f32 v116, v116
    v_mfma_f32_32x32x16_bf16 v[34:49], v[158:161], v[102:105], v[34:49]
    v_exp_f32 v117, v117
    v_exp_f32 v118, v118
    v_exp_f32 v119, v119
    v_cvt_pk_bf16_f32 v114, v114, v115
    v_mfma_f32_32x32x16_bf16 v[98:113], v[138:141], v[18:21], 0
    v_exp_f32 v120, v120
    v_exp_f32 v121, v121
    v_exp_f32 v122, v122
    v_cvt_pk_bf16_f32 v115, v116, v117
    v_cvt_pk_bf16_f32 v116, v118, v119
    v_mfma_f32_32x32x16_bf16 v[98:113], v[142:145], v[22:25], v[98:113]
    v_exp_f32 v123, v123
    v_exp_f32 v124, v124
    v_exp_f32 v125, v125
    v_exp_f32 v126, v126
    v_exp_f32 v127, v127
    v_exp_f32 v128, v128
    v_exp_f32 v129, v129
    v_cvt_pk_bf16_f32 v117, v120, v121
    v_cvt_pk_bf16_f32 v118, v122, v123
    v_cvt_pk_bf16_f32 v119, v124, v125
    v_cvt_pk_bf16_f32 v120, v126, v127
    v_cvt_pk_bf16_f32 v121, v128, v129
    v_mfma_f32_32x32x16_bf16 v[50:65], v[154:157], v[114:117], v[50:65]
    v_exp_f32 v98, v98
    v_exp_f32 v99, v99
    v_exp_f32 v100, v100
ST_C_7:
    s_cbranch_execz K1_CONS
    v_mfma_f32_32x32x16_bf16 v[50:65], v[158:161], v[118:121], v[50:65]
    v_exp_f32 v101, v101
    v_exp_f32 v102, v102
    v_exp_f32 v103, v103
    v_cvt_pk_bf16_f32 v98, v98, v99
    v_mfma_f32_32x32x16_bf16 v[114:129], v[138:141], v[26:29], 0
    v_exp_f32 v104, v104
    v_exp_f32 v105, v105
    v_exp_f32 v106, v106
    v_cvt_pk_bf16_f32 v99, v100, v101
    v_cvt_pk_bf16_f32 v100, v102, v103
    v_mfma_f32_32x32x16_bf16 v[114:129], v[142:145], v[30:33], v[114:129]
    s_add_u32 s13, s38, 172032
    buffer_load_dwordx4 v[138:141], v1, s[32:35], s13 offen offset:0
    buffer_load_dwordx4 v[142:145], v1, s[32:35], s13 offen offset:1024
    v_exp_f32 v107, v107
    v_exp_f32 v108, v108
    v_exp_f32 v109, v109
    v_exp_f32 v110, v110
    v_exp_f32 v111, v111
    v_exp_f32 v112, v112
    v_exp_f32 v113, v113
    v_cvt_pk_bf16_f32 v101, v104, v105
    v_cvt_pk_bf16_f32 v102, v106, v107
    v_cvt_pk_bf16_f32 v103, v108, v109
    v_cvt_pk_bf16_f32 v104, v110, v111
    v_cvt_pk_bf16_f32 v105, v112, v113
    v_mfma_f32_32x32x16_bf16 v[66:81], v[154:157], v[98:101], v[66:81]
    v_exp_f32 v114, v114
    v_exp_f32 v115, v115
    v_exp_f32 v116, v116
    v_mfma_f32_32x32x16_bf16 v[66:81], v[158:161], v[102:105], v[66:81]
    v_exp_f32 v117, v117
    v_exp_f32 v118, v118
    v_exp_f32 v119, v119
    v_cvt_pk_bf16_f32 v114, v114, v115
    s_waitcnt vmcnt(4)
    s_cmp_lg_u32 s14, 0
    s_cbranch_scc0 K2_FK2
    v_mov_b32 v162, 0x3f803f80
    v_cndmask_b32 v130, v130, v162, s[42:43]
    v_cndmask_b32 v131, v131, v162, s[42:43]
    v_cndmask_b32 v136, v136, v162, s[40:41]
ST_C_8:
    s_cbranch_execz K1_CONS
    v_cndmask_b32 v137, v137, v162, s[40:41]
    s_nop 1
K2_FK2:
    v_mfma_f32_32x32x16_bf16 v[98:113], v[130:133], v[2:5], 0
    v_exp_f32 v120, v120
    v_exp_f32 v121, v121
    v_exp_f32 v122, v122
    v_cvt_pk_bf16_f32 v115, v116, v117
    v_cvt_pk_bf16_f32 v116, v118, v119
    v_mfma_f32_32x32x16_bf16 v[98:113], v[134:137], v[6:9], v[98:113]
    v_exp_f32 v123, v123
    v_exp_f32 v124, v124
    v_exp_f32 v125, v125
    v_exp_f32 v126, v126
    v_exp_f32 v127, v127
    v_exp_f32 v128, v128
    v_exp_f32 v129, v129
    v_cvt_pk_bf16_f32 v117, v120, v121
    v_cvt_pk_bf16_f32 v118, v122, v123
    v_cvt_pk_bf16_f32 v119, v124, v125
    v_cvt_pk_bf16_f32 v120, v126, v127
    v_cvt_pk_bf16_f32 v121, v128, v129
    v_mfma_f32_32x32x16_bf16 v[82:97], v[154:157], v[114:117], v[82:97]
    v_exp_f32 v98, v98
    v_exp_f32 v99, v99
    v_exp_f32 v100, v100
    v_mfma_f32_32x32x16_bf16 v[82:97], v[158:161], v[118:121], v[82:97]
    s_add_u32 s13, s12, 6144
    buffer_load_dwordx4 v[154:157], v1, s[32:35], s13 offen offset:0
    buffer_load_dwordx4 v[158:161], v1, s[32:35], s13 offen offset:1024
    v_exp_f32 v101, v101
    v_exp_f32 v102, v102
    v_exp_f32 v103, v103
    v_cvt_pk_bf16_f32 v98, v98, v99
    v_mfma_f32_32x32x16_bf16 v[114:129], v[130:133], v[10:13], 0
    v_exp_f32 v104, v104
    v_exp_f32 v105, v105
    v_exp_f32 v106, v106
    v_cvt_pk_bf16_f32 v99, v100, v101
    v_cvt_pk_bf16_f32 v100, v102, v103
    v_mfma_f32_32x32x16_bf16 v[114:129], v[134:137], v[14:17], v[114:129]
    v_exp_f32 v107, v107
    v_exp_f32 v108, v108
ST_C_9:
    s_cbranch_execz K1_CONS
    v_exp_f32 v109, v109
    v_exp_f32 v110, v110
    v_exp_f32 v111, v111
    v_exp_f32 v112, v112
    v_exp_f32 v113, v113
    v_cvt_pk_bf16_f32 v101, v104, v105
    v_cvt_pk_bf16_f32 v102, v106, v107
    v_cvt_pk_bf16_f32 v103, v108, v109
    v_cvt_pk_bf16_f32 v104, v110, v111
    v_cvt_pk_bf16_f32 v105, v112, v113
    s_waitcnt vmcnt(4)
    v_mfma_f32_32x32x16_bf16 v[34:49], v[146:149], v[98:101], v[34:49]
    v_exp_f32 v114, v114
    v_exp_f32 v115, v115
    v_exp_f32 v116, v116
    v_mfma_f32_32x32x16_bf16 v[34:49], v[150:153], v[102:105], v[34:49]
    v_exp_f32 v117, v117
    v_exp_f32 v118, v118
    v_exp_f32 v119, v119
    v_cvt_pk_bf16_f32 v114, v114, v115
    v_mfma_f32_32x32x16_bf16 v[98:113], v[130:133], v[18:21], 0
    v_exp_f32 v120, v120
    v_exp_f32 v121, v121
    v_exp_f32 v122, v122
    v_cvt_pk_bf16_f32 v115, v116, v117
    v_cvt_pk_bf16_f32 v116, v118, v119
    v_mfma_f32_32x32x16_bf16 v[98:113], v[134:137], v[22:25], v[98:113]
    v_exp_f32 v123, v123
    v_exp_f32 v124, v124
    v_exp_f32 v125, v125
    v_exp_f32 v126, v126
    v_exp_f32 v127, v127
    v_exp_f32 v128, v128
    v_exp_f32 v129, v129
    v_cvt_pk_bf16_f32 v117, v120, v121
    v_cvt_pk_bf16_f32 v118, v122, v123
    v_cvt_pk_bf16_f32 v119, v124, v125
    v_cvt_pk_bf16_f32 v120, v126, v127
    v_cvt_pk_bf16_f32 v121, v128, v129
    v_mfma_f32_32x32x16_bf16 v[50:65], v[146:149], v[114:117], v[50:65]
    v_exp_f32 v98, v98
    v_exp_f32 v99, v99
    v_exp_f32 v100, v100
    v_mfma_f32_32x32x16_bf16 v[50:65], v[150:153], v[118:121], v[50:65]
ST_C_10:
    s_cbranch_execz K1_CONS
    v_exp_f32 v101, v101
    v_exp_f32 v102, v102
    v_exp_f32 v103, v103
    v_cvt_pk_bf16_f32 v98, v98, v99
    v_mfma_f32_32x32x16_bf16 v[114:129], v[130:133], v[26:29], 0
    v_exp_f32 v104, v104
    v_exp_f32 v105, v105
    v_exp_f32 v106, v106
    v_cvt_pk_bf16_f32 v99, v100, v101
    v_cvt_pk_bf16_f32 v100, v102, v103
    v_mfma_f32_32x32x16_bf16 v[114:129], v[134:137], v[30:33], v[114:129]
    s_add_u32 s13, s38, 229376
    buffer_load_dwordx4 v[130:133], v1, s[32:35], s13 offen offset:0
    buffer_load_dwordx4 v[134:137], v1, s[32:35], s13 offen offset:1024
    v_exp_f32 v107, v107
    v_exp_f32 v108, v108
    v_exp_f32 v109, v109
    v_exp_f32 v110, v110
    v_exp_f32 v111, v111
    v_exp_f32 v112, v112
    v_exp_f32 v113, v113
    v_cvt_pk_bf16_f32 v101, v104, v105
    v_cvt_pk_bf16_f32 v102, v106, v107
    v_cvt_pk_bf16_f32 v103, v108, v109
    v_cvt_pk_bf16_f32 v104, v110, v111
    v_cvt_pk_bf16_f32 v105, v112, v113
    v_mfma_f32_32x32x16_bf16 v[66:81], v[146:149], v[98:101], v[66:81]
    v_exp_f32 v114, v114
    v_exp_f32 v115, v115
    v_exp_f32 v116, v116
    v_mfma_f32_32x32x16_bf16 v[66:81], v[150:153], v[102:105], v[66:81]
    v_exp_f32 v117, v117
    v_exp_f32 v118, v118
    v_exp_f32 v119, v119
    v_cvt_pk_bf16_f32 v114, v114, v115
    s_waitcnt vmcnt(4)
    s_cmp_lg_u32 s14, 0
    s_cbranch_scc0 K2_FK3
    v_mov_b32 v162, 0x3f803f80
    v_cndmask_b32 v138, v138, v162, s[42:43]
    v_cndmask_b32 v139, v139, v162, s[42:43]
    v_cndmask_b32 v144, v144, v162, s[40:41]
    v_cndmask_b32 v145, v145, v162, s[40:41]
ST_C_11:
    s_cbranch_execz K1_CONS
    s_nop 1
K2_FK3:
    v_mfma_f32_32x32x16_bf16 v[98:113], v[138:141], v[2:5], 0
    v_exp_f32 v120, v120
    v_exp_f32 v121, v121
    v_exp_f32 v122, v122
    v_cvt_pk_bf16_f32 v115, v116, v117
    v_cvt_pk_bf16_f32 v116, v118, v119
    v_mfma_f32_32x32x16_bf16 v[98:113], v[142:145], v[6:9], v[98:113]
    v_exp_f32 v123, v123
    v_exp_f32 v124, v124
    v_exp_f32 v125, v125
    v_exp_f32 v126, v126
    v_exp_f32 v127, v127
    v_exp_f32 v128, v128
    v_exp_f32 v129, v129
    v_cvt_pk_bf16_f32 v117, v120, v121
    v_cvt_pk_bf16_f32 v118, v122, v123
    v_cvt_pk_bf16_f32 v119, v124, v125
    v_cvt_pk_bf16_f32 v120, v126, v127
    v_cvt_pk_bf16_f32 v121, v128, v129
    v_mfma_f32_32x32x16_bf16 v[82:97], v[146:149], v[114:117], v[82:97]
    v_exp_f32 v98, v98
    v_exp_f32 v99, v99
    v_exp_f32 v100, v100
    v_mfma_f32_32x32x16_bf16 v[82:97], v[150:153], v[118:121], v[82:97]
    s_add_u32 s13, s12, 8192
    buffer_load_dwordx4 v[146:149], v1, s[32:35], s13 offen offset:0
    buffer_load_dwordx4 v[150:153], v1, s[32:35], s13 offen offset:1024
    v_exp_f32 v101, v101
    v_exp_f32 v102, v102
    v_exp_f32 v103, v103
    v_cvt_pk_bf16_f32 v98, v98, v99
    v_mfma_f32_32x32x16_bf16 v[114:129], v[138:141], v[10:13], 0
    v_exp_f32 v104, v104
    v_exp_f32 v105, v105
    v_exp_f32 v106, v106
    v_cvt_pk_bf16_f32 v99, v100, v101
    v_cvt_pk_bf16_f32 v100, v102, v103
    v_mfma_f32_32x32x16_bf16 v[114:129], v[142:145], v[14:17], v[114:129]
    v_exp_f32 v107, v107
    v_exp_f32 v108, v108
    v_exp_f32 v109, v109
    v_exp_f32 v110, v110
ST_C_12:
    s_cbranch_execz K1_CONS
    v_exp_f32 v111, v111
    v_exp_f32 v112, v112
    v_exp_f32 v113, v113
    v_cvt_pk_bf16_f32 v101, v104, v105
    v_cvt_pk_bf16_f32 v102, v106, v107
    v_cvt_pk_bf16_f32 v103, v108, v109
    v_cvt_pk_bf16_f32 v104, v110, v111
    v_cvt_pk_bf16_f32 v105, v112, v113
    s_waitcnt vmcnt(4)
    v_mfma_f32_32x32x16_bf16 v[34:49], v[154:157], v[98:101], v[34:49]
    v_exp_f32 v114, v114
    v_exp_f32 v115, v115
    v_exp_f32 v116, v116
    v_mfma_f32_32x32x16_bf16 v[34:49], v[158:161], v[102:105], v[34:49]
    v_exp_f32 v117, v117
    v_exp_f32 v118, v118
    v_exp_f32 v119, v119
    v_cvt_pk_bf16_f32 v114, v114, v115
    v_mfma_f32_32x32x16_bf16 v[98:113], v[138:141], v[18:21], 0
    v_exp_f32 v120, v120
    v_exp_f32 v121, v121
    v_exp_f32 v122, v122
    v_cvt_pk_bf16_f32 v115, v116, v117
    v_cvt_pk_bf16_f32 v116, v118, v119
    v_mfma_f32_32x32x16_bf16 v[98:113], v[142:145], v[22:25], v[98:113]
    v_exp_f32 v123, v123
    v_exp_f32 v124, v124
    v_exp_f32 v125, v125
    v_exp_f32 v126, v126
    v_exp_f32 v127, v127
    v_exp_f32 v128, v128
    v_exp_f32 v129, v129
    v_cvt_pk_bf16_f32 v117, v120, v121
    v_cvt_pk_bf16_f32 v118, v122, v123
    v_cvt_pk_bf16_f32 v119, v124, v125
    v_cvt_pk_bf16_f32 v120, v126, v127
    v_cvt_pk_bf16_f32 v121, v128, v129
    v_mfma_f32_32x32x16_bf16 v[50:65], v[154:157], v[114:117], v[50:65]
    v_exp_f32 v98, v98
    v_exp_f32 v99, v99
    v_exp_f32 v100, v100
    v_mfma_f32_32x32x16_bf16 v[50:65], v[158:161], v[118:121], v[50:65]
    v_exp_f32 v101, v101
    v_exp_f32 v102, v102
ST_C_13:
    s_cbranch_execz K1_CONS
    v_exp_f32 v103, v103
    v_cvt_pk_bf16_f32 v98, v98, v99
    v_mfma_f32_32x32x16_bf16 v[114:129], v[138:141], v[26:29], 0
    v_exp_f32 v104, v104
    v_exp_f32 v105, v105
    v_exp_f32 v106, v106
    v_cvt_pk_bf16_f32 v99, v100, v101
    v_cvt_pk_bf16_f32 v100, v102, v103
    v_mfma_f32_32x32x16_bf16 v[114:129], v[142:145], v[30:33], v[114:129]
    s_add_u32 s13, s38, 286720
    buffer_load_dwordx4 v[138:141], v1, s[32:35], s13 offen offset:0
    buffer_load_dwordx4 v[142:145], v1, s[32:35], s13 offen offset:1024
    v_exp_f32 v107, v107
    v_exp_f32 v108, v108
    v_exp_f32 v109, v109
    v_exp_f32 v110, v110
    v_exp_f32 v111, v111
    v_exp_f32 v112, v112
    v_exp_f32 v113, v113
    v_cvt_pk_bf16_f32 v101, v104, v105
    v_cvt_pk_bf16_f32 v102, v106, v107
    v_cvt_pk_bf16_f32 v103, v108, v109
    v_cvt_pk_bf16_f32 v104, v110, v111
    v_cvt_pk_bf16_f32 v105, v112, v113
    v_mfma_f32_32x32x16_bf16 v[66:81], v[154:157], v[98:101], v[66:81]
    v_exp_f32 v114, v114
    v_exp_f32 v115, v115
    v_exp_f32 v116, v116
    v_mfma_f32_32x32x16_bf16 v[66:81], v[158:161], v[102:105], v[66:81]
    v_exp_f32 v117, v117
    v_exp_f32 v118, v118
    v_exp_f32 v119, v119
    v_cvt_pk_bf16_f32 v114, v114, v115
    s_waitcnt vmcnt(4)
    s_cmp_lg_u32 s14, 0
    s_cbranch_scc0 K2_FK4
    v_mov_b32 v162, 0x3f803f80
    v_cndmask_b32 v130, v130, v162, s[42:43]
    v_cndmask_b32 v131, v131, v162, s[42:43]
    v_cndmask_b32 v136, v136, v162, s[40:41]
    v_cndmask_b32 v137, v137, v162, s[40:41]
    s_nop 1
ST_C_14:
    s_cbranch_execz K1_CONS
K2_FK4:
    v_mfma_f32_32x32x16_bf16 v[98:113], v[130:133], v[2:5], 0
    v_exp_f32 v120, v120
    v_exp_f32 v121, v121
    v_exp_f32 v122, v122
    v_cvt_pk_bf16_f32 v115, v116, v117
    v_cvt_pk_bf16_f32 v116, v118, v119
    v_mfma_f32_32x32x16_bf16 v[98:113], v[134:137], v[6:9], v[98:113]
    v_exp_f32 v123, v123
    v_exp_f32 v124, v124
    v_exp_f32 v125, v125
    v_exp_f32 v126, v126
    v_exp_f32 v127, v127
    v_exp_f32 v128, v128
    v_exp_f32 v129, v129
    v_cvt_pk_bf16_f32 v117, v120, v121
    v_cvt_pk_bf16_f32 v118, v122, v123
    v_cvt_pk_bf16_f32 v119, v124, v125
    v_cvt_pk_bf16_f32 v120, v126, v127
    v_cvt_pk_bf16_f32 v121, v128, v129
    v_mfma_f32_32x32x16_bf16 v[82:97], v[154:157], v[114:117], v[82:97]
    v_exp_f32 v98, v98
    v_exp_f32 v99, v99
    v_exp_f32 v100, v100
    v_mfma_f32_32x32x16_bf16 v[82:97], v[158:161], v[118:121], v[82:97]
    s_add_u32 s13, s12, 10240
    buffer_load_dwordx4 v[154:157], v1, s[32:35], s13 offen offset:0
    buffer_load_dwordx4 v[158:161], v1, s[32:35], s13 offen offset:1024
    v_exp_f32 v101, v101
    v_exp_f32 v102, v102
    v_exp_f32 v103, v103
    v_cvt_pk_bf16_f32 v98, v98, v99
    v_mfma_f32_32x32x16_bf16 v[114:129], v[130:133], v[10:13], 0
    v_exp_f32 v104, v104
    v_exp_f32 v105, v105
    v_exp_f32 v106, v106
    v_cvt_pk_bf16_f32 v99, v100, v101
    v_cvt_pk_bf16_f32 v100, v102, v103
    v_mfma_f32_32x32x16_bf16 v[114:129], v[134:137], v[14:17], v[114:129]
    v_exp_f32 v107, v107
    v_exp_f32 v108, v108
    v_exp_f32 v109, v109
    v_exp_f32 v110, v110
    v_exp_f32 v111, v111
    v_exp_f32 v112, v112
ST_C_15:
    s_cbranch_execz K1_CONS
    v_exp_f32 v113, v113
    v_cvt_pk_bf16_f32 v101, v104, v105
    v_cvt_pk_bf16_f32 v102, v106, v107
    v_cvt_pk_bf16_f32 v103, v108, v109
    v_cvt_pk_bf16_f32 v104, v110, v111
    v_cvt_pk_bf16_f32 v105, v112, v113
    s_waitcnt vmcnt(4)
    v_mfma_f32_32x32x16_bf16 v[34:49], v[146:149], v[98:101], v[34:49]
    v_exp_f32 v114, v114
    v_exp_f32 v115, v115
    v_exp_f32 v116, v116
    v_mfma_f32_32x32x16_bf16 v[34:49], v[150:153], v[102:105], v[34:49]
    v_exp_f32 v117, v117
    v_exp_f32 v118, v118
    v_exp_f32 v119, v119
    v_cvt_pk_bf16_f32 v114, v114, v115
    v_mfma_f32_32x32x16_bf16 v[98:113], v[130:133], v[18:21], 0
    v_exp_f32 v120, v120
    v_exp_f32 v121, v121
    v_exp_f32 v122, v122
    v_cvt_pk_bf16_f32 v115, v116, v117
    v_cvt_pk_bf16_f32 v116, v118, v119
    v_mfma_f32_32x32x16_bf16 v[98:113], v[134:137], v[22:25], v[98:113]
    v_exp_f32 v123, v123
    v_exp_f32 v124, v124
    v_exp_f32 v125, v125
    v_exp_f32 v126, v126
    v_exp_f32 v127, v127
    v_exp_f32 v128, v128
    v_exp_f32 v129, v129
    v_cvt_pk_bf16_f32 v117, v120, v121
    v_cvt_pk_bf16_f32 v118, v122, v123
    v_cvt_pk_bf16_f32 v119, v124, v125
    v_cvt_pk_bf16_f32 v120, v126, v127
    v_cvt_pk_bf16_f32 v121, v128, v129
    v_mfma_f32_32x32x16_bf16 v[50:65], v[146:149], v[114:117], v[50:65]
    v_exp_f32 v98, v98
    v_exp_f32 v99, v99
    v_exp_f32 v100, v100
    v_mfma_f32_32x32x16_bf16 v[50:65], v[150:153], v[118:121], v[50:65]
    v_exp_f32 v101, v101
    v_exp_f32 v102, v102
    v_exp_f32 v103, v103
    v_cvt_pk_bf16_f32 v98, v98, v99
ST_C_16:
    s_cbranch_execz K1_CONS
    v_mfma_f32_32x32x16_bf16 v[114:129], v[130:133], v[26:29], 0
    v_exp_f32 v104, v104
    v_exp_f32 v105, v105
    v_exp_f32 v106, v106
    v_cvt_pk_bf16_f32 v99, v100, v101
    v_cvt_pk_bf16_f32 v100, v102, v103
    v_mfma_f32_32x32x16_bf16 v[114:129], v[134:137], v[30:33], v[114:129]
    s_add_u32 s13, s38, 344064
    buffer_load_dwordx4 v[130:133], v1, s[32:35], s13 offen offset:0
    buffer_load_dwordx4 v[134:137], v1, s[32:35], s13 offen offset:1024
    v_exp_f32 v107, v107
    v_exp_f32 v108, v108
    v_exp_f32 v109, v109
    v_exp_f32 v110, v110
    v_exp_f32 v111, v111
    v_exp_f32 v112, v112
    v_exp_f32 v113, v113
    v_cvt_pk_bf16_f32 v101, v104, v105
    v_cvt_pk_bf16_f32 v102, v106, v107
    v_cvt_pk_bf16_f32 v103, v108, v109
    v_cvt_pk_bf16_f32 v104, v110, v111
    v_cvt_pk_bf16_f32 v105, v112, v113
    v_mfma_f32_32x32x16_bf16 v[66:81], v[146:149], v[98:101], v[66:81]
    v_exp_f32 v114, v114
    v_exp_f32 v115, v115
    v_exp_f32 v116, v116
    v_mfma_f32_32x32x16_bf16 v[66:81], v[150:153], v[102:105], v[66:81]
    v_exp_f32 v117, v117
    v_exp_f32 v118, v118
    v_exp_f32 v119, v119
    v_cvt_pk_bf16_f32 v114, v114, v115
    s_waitcnt vmcnt(4)
    s_cmp_lg_u32 s14, 0
    s_cbranch_scc0 K2_FK5
    v_mov_b32 v162, 0x3f803f80
    v_cndmask_b32 v138, v138, v162, s[42:43]
    v_cndmask_b32 v139, v139, v162, s[42:43]
    v_cndmask_b32 v144, v144, v162, s[40:41]
    v_cndmask_b32 v145, v145, v162, s[40:41]
    s_nop 1
K2_FK5:
    v_mfma_f32_32x32x16_bf16 v[98:113], v[138:141], v[2:5], 0
ST_C_17:
    s_cbranch_execz K1_CONS
    v_exp_f32 v120, v120
    v_exp_f32 v121, v121
    v_exp_f32 v122, v122
    v_cvt_pk_bf16_f32 v115, v116, v117
    v_cvt_pk_bf16_f32 v116, v118, v119
    v_mfma_f32_32x32x16_bf16 v[98:113], v[142:145], v[6:9], v[98:113]
    v_exp_f32 v123, v123
    v_exp_f32 v124, v124
    v_exp_f32 v125, v125
    v_exp_f32 v126, v126
    v_exp_f32 v127, v127
    v_exp_f32 v128, v128
    v_exp_f32 v129, v129
    v_cvt_pk_bf16_f32 v117, v120, v121
    v_cvt_pk_bf16_f32 v118, v122, v123
    v_cvt_pk_bf16_f32 v119, v124, v125
    v_cvt_pk_bf16_f32 v120, v126, v127
    v_cvt_pk_bf16_f32 v121, v128, v129
    s_cmp_ge_u32 s3, 4
    s_cbranch_scc1 K2_AP20
    s_setprio 1
K2_AP20:
    v_mfma_f32_32x32x16_bf16 v[82:97], v[146:149], v[114:117], v[82:97]
    v_exp_f32 v98, v98
    v_exp_f32 v99, v99
    v_exp_f32 v100, v100
    v_mfma_f32_32x32x16_bf16 v[82:97], v[150:153], v[118:121], v[82:97]
    s_add_u32 s13, s12, 12288
    buffer_load_dwordx4 v[146:149], v1, s[32:35], s13 offen offset:0
    buffer_load_dwordx4 v[150:153], v1, s[32:35], s13 offen offset:1024
    v_exp_f32 v101, v101
    v_exp_f32 v102, v102
    v_exp_f32 v103, v103
    v_cvt_pk_bf16_f32 v98, v98, v99
    v_mfma_f32_32x32x16_bf16 v[114:129], v[138:141], v[10:13], 0
    v_exp_f32 v104, v104
    v_exp_f32 v105, v105
    v_exp_f32 v106, v106
    v_cvt_pk_bf16_f32 v99, v100, v101
    v_cvt_pk_bf16_f32 v100, v102, v103
    v_mfma_f32_32x32x16_bf16 v[114:129], v[142:145], v[14:17], v[114:129]
    v_exp_f32 v107, v107
    v_exp_f32 v108, v108
    v_exp_f32 v109, v109
    v_exp_f32 v110, v110
    v_exp_f32 v111, v111
ST_C_18:
    s_cbranch_execz K1_CONS
    v_exp_f32 v112, v112
    v_exp_f32 v113, v113
    v_cvt_pk_bf16_f32 v101, v104, v105
    v_cvt_pk_bf16_f32 v102, v106, v107
    v_cvt_pk_bf16_f32 v103, v108, v109
    v_cvt_pk_bf16_f32 v104, v110, v111
    v_cvt_pk_bf16_f32 v105, v112, v113
    s_waitcnt vmcnt(4)
    v_mfma_f32_32x32x16_bf16 v[34:49], v[154:157], v[98:101], v[34:49]
    v_exp_f32 v114, v114
    v_exp_f32 v115, v115
    v_exp_f32 v116, v116
    v_mfma_f32_32x32x16_bf16 v[34:49], v[158:161], v[102:105], v[34:49]
    v_exp_f32 v117, v117
    v_exp_f32 v118, v118
    v_exp_f32 v119, v119
    v_cvt_pk_bf16_f32 v114, v114, v115
    v_mfma_f32_32x32x16_bf16 v[98:113], v[138:141], v[18:21], 0
    v_exp_f32 v120, v120
    v_exp_f32 v121, v121
    v_exp_f32 v122, v122
    v_cvt_pk_bf16_f32 v115, v116, v117
    v_cvt_pk_bf16_f32 v116, v118, v119
    v_mfma_f32_32x32x16_bf16 v[98:113], v[142:145], v[22:25], v[98:113]
    v_exp_f32 v123, v123
    v_exp_f32 v124, v124
    v_exp_f32 v125, v125
    v_exp_f32 v126, v126
    v_exp_f32 v127, v127
    v_exp_f32 v128, v128
    v_exp_f32 v129, v129
    v_cvt_pk_bf16_f32 v117, v120, v121
    v_cvt_pk_bf16_f32 v118, v122, v123
    v_cvt_pk_bf16_f32 v119, v124, v125
    v_cvt_pk_bf16_f32 v120, v126, v127
    v_cvt_pk_bf16_f32 v121, v128, v129
    v_mfma_f32_32x32x16_bf16 v[50:65], v[154:157], v[114:117], v[50:65]
    v_exp_f32 v98, v98
    v_exp_f32 v99, v99
    v_exp_f32 v100, v100
    v_mfma_f32_32x32x16_bf16 v[50:65], v[158:161], v[118:121], v[50:65]
    v_exp_f32 v101, v101
    v_exp_f32 v102, v102
    v_exp_f32 v103, v103
ST_C_19:
    s_cbranch_execz K1_CONS
    v_cvt_pk_bf16_f32 v98, v98, v99
    v_mfma_f32_32x32x16_bf16 v[114:129], v[138:141], v[26:29], 0
    v_exp_f32 v104, v104
    v_exp_f32 v105, v105
    v_exp_f32 v106, v106
    v_cvt_pk_bf16_f32 v99, v100, v101
    v_cvt_pk_bf16_f32 v100, v102, v103
    v_mfma_f32_32x32x16_bf16 v[114:129], v[142:145], v[30:33], v[114:129]
    s_add_u32 s13, s38, 401408
    buffer_load_dwordx4 v[138:141], v1, s[32:35], s13 offen offset:0
    buffer_load_dwordx4 v[142:145], v1, s[32:35], s13 offen offset:1024
    v_exp_f32 v107, v107
    v_exp_f32 v108, v108
    v_exp_f32 v109, v109
    v_exp_f32 v110, v110
    v_exp_f32 v111, v111
    v_exp_f32 v112, v112
    v_exp_f32 v113, v113
    v_cvt_pk_bf16_f32 v101, v104, v105
    v_cvt_pk_bf16_f32 v102, v106, v107
    v_cvt_pk_bf16_f32 v103, v108, v109
    v_cvt_pk_bf16_f32 v104, v110, v111
    v_cvt_pk_bf16_f32 v105, v112, v113
    v_mfma_f32_32x32x16_bf16 v[66:81], v[154:157], v[98:101], v[66:81]
    v_exp_f32 v114, v114
    v_exp_f32 v115, v115
    v_exp_f32 v116, v116
    v_mfma_f32_32x32x16_bf16 v[66:81], v[158:161], v[102:105], v[66:81]
    v_exp_f32 v117, v117
    v_exp_f32 v118, v118
    v_exp_f32 v119, v119
    v_cvt_pk_bf16_f32 v114, v114, v115
    s_waitcnt vmcnt(4)
    s_cmp_lg_u32 s14, 0
    s_cbranch_scc0 K2_FK6
    v_mov_b32 v162, 0x3f803f80
    v_cndmask_b32 v130, v130, v162, s[42:43]
    v_cndmask_b32 v131, v131, v162, s[42:43]
    v_cndmask_b32 v136, v136, v162, s[40:41]
    v_cndmask_b32 v137, v137, v162, s[40:41]
    s_nop 1
K2_FK6:
    v_mfma_f32_32x32x16_bf16 v[98:113], v[130:133], v[2:5], 0
ST_C_20:
    s_cbranch_execz K1_CONS
    v_exp_f32 v120, v120
    v_exp_f32 v121, v121
    v_exp_f32 v122, v122
    v_cvt_pk_bf16_f32 v115, v116, v117
    v_cvt_pk_bf16_f32 v116, v118, v119
    v_mfma_f32_32x32x16_bf16 v[98:113], v[134:137], v[6:9], v[98:113]
    v_exp_f32 v123, v123
    v_exp_f32 v124, v124
    v_exp_f32 v125, v125
    v_exp_f32 v126, v126
    v_exp_f32 v127, v127
    v_exp_f32 v128, v128
    v_exp_f32 v129, v129
    v_cvt_pk_bf16_f32 v117, v120, v121
    v_cvt_pk_bf16_f32 v118, v122, v123
    v_cvt_pk_bf16_f32 v119, v124, v125
    v_cvt_pk_bf16_f32 v120, v126, v127
    v_cvt_pk_bf16_f32 v121, v128, v129
    v_mfma_f32_32x32x16_bf16 v[82:97], v[154:157], v[114:117], v[82:97]
    v_exp_f32 v98, v98
    v_exp_f32 v99, v99
    v_exp_f32 v100, v100
    v_mfma_f32_32x32x16_bf16 v[82:97], v[158:161], v[118:121], v[82:97]
    s_add_u32 s13, s12, 14336
    buffer_load_dwordx4 v[154:157], v1, s[32:35], s13 offen offset:0
    buffer_load_dwordx4 v[158:161], v1, s[32:35], s13 offen offset:1024
    v_exp_f32 v101, v101
    v_exp_f32 v102, v102
    v_exp_f32 v103, v103
    v_cvt_pk_bf16_f32 v98, v98, v99
    v_mfma_f32_32x32x16_bf16 v[114:129], v[130:133], v[10:13], 0
    v_exp_f32 v104, v104
    v_exp_f32 v105, v105
    v_exp_f32 v106, v106
    v_cvt_pk_bf16_f32 v99, v100, v101
    v_cvt_pk_bf16_f32 v100, v102, v103
    v_mfma_f32_32x32x16_bf16 v[114:129], v[134:137], v[14:17], v[114:129]
    v_exp_f32 v107, v107
    v_exp_f32 v108, v108
    v_exp_f32 v109, v109
    v_exp_f32 v110, v110
    v_exp_f32 v111, v111
    v_exp_f32 v112, v112
    v_exp_f32 v113, v113
ST_C_21:
    s_cbranch_execz K1_CONS
    v_cvt_pk_bf16_f32 v101, v104, v105
    v_cvt_pk_bf16_f32 v102, v106, v107
    v_cvt_pk_bf16_f32 v103, v108, v109
    v_cvt_pk_bf16_f32 v104, v110, v111
    v_cvt_pk_bf16_f32 v105, v112, v113
    s_waitcnt vmcnt(4)
    v_mfma_f32_32x32x16_bf16 v[34:49], v[146:149], v[98:101], v[34:49]
    v_exp_f32 v114, v114
    v_exp_f32 v115, v115
    v_exp_f32 v116, v116
    v_mfma_f32_32x32x16_bf16 v[34:49], v[150:153], v[102:105], v[34:49]
    v_exp_f32 v117, v117
    v_exp_f32 v118, v118
    v_exp_f32 v119, v119
    v_cvt_pk_bf16_f32 v114, v114, v115
    s_waitcnt vmcnt(2)
    s_cmp_lg_u32 s14, 0
    s_cbranch_scc0 K2_FK7
    v_mov_b32 v162, 0x3f803f80
    v_cndmask_b32 v138, v138, v162, s[42:43]
    v_cndmask_b32 v139, v139, v162, s[42:43]
    v_cndmask_b32 v144, v144, v162, s[40:41]
    v_cndmask_b32 v145, v145, v162, s[40:41]
    s_nop 1
K2_FK7:
    v_mfma_f32_32x32x16_bf16 v[98:113], v[138:141], v[2:5], 0
    v_exp_f32 v120, v120
    v_exp_f32 v121, v121
    v_exp_f32 v122, v122
    v_cvt_pk_bf16_f32 v115, v116, v117
    v_cvt_pk_bf16_f32 v116, v118, v119
    v_mfma_f32_32x32x16_bf16 v[98:113], v[142:145], v[6:9], v[98:113]
    v_exp_f32 v123, v123
    v_exp_f32 v124, v124
    v_exp_f32 v125, v125
    v_exp_f32 v126, v126
    v_exp_f32 v127, v127
    v_exp_f32 v128, v128
    v_exp_f32 v129, v129
    v_cvt_pk_bf16_f32 v117, v120, v121
    v_cvt_pk_bf16_f32 v118, v122, v123
    v_cvt_pk_bf16_f32 v119, v124, v125
    v_cvt_pk_bf16_f32 v120, v126, v127
ST_C_22:
    s_cbranch_execz K1_CONS
    v_cvt_pk_bf16_f32 v121, v128, v129
    v_mfma_f32_32x32x16_bf16 v[50:65], v[146:149], v[114:117], v[50:65]
    v_exp_f32 v98, v98
    v_exp_f32 v99, v99
    v_exp_f32 v100, v100
    v_mfma_f32_32x32x16_bf16 v[50:65], v[150:153], v[118:121], v[50:65]
    v_exp_f32 v101, v101
    v_exp_f32 v102, v102
    v_exp_f32 v103, v103
    v_cvt_pk_bf16_f32 v98, v98, v99
    v_mfma_f32_32x32x16_bf16 v[114:129], v[138:141], v[10:13], 0
    v_exp_f32 v104, v104
    v_exp_f32 v105, v105
    v_exp_f32 v106, v106
    v_cvt_pk_bf16_f32 v99, v100, v101
    v_cvt_pk_bf16_f32 v100, v102, v103
    v_mfma_f32_32x32x16_bf16 v[114:129], v[142:145], v[14:17], v[114:129]
    v_exp_f32 v107, v107
    v_exp_f32 v108, v108
    v_exp_f32 v109, v109
    v_exp_f32 v110, v110
    v_exp_f32 v111, v111
    v_exp_f32 v112, v112
    v_exp_f32 v113, v113
    v_cvt_pk_bf16_f32 v101, v104, v105
    v_cvt_pk_bf16_f32 v102, v106, v107
    v_cvt_pk_bf16_f32 v103, v108, v109
    v_cvt_pk_bf16_f32 v104, v110, v111
    v_cvt_pk_bf16_f32 v105, v112, v113
    s_waitcnt vmcnt(0)
    v_mfma_f32_32x32x16_bf16 v[34:49], v[154:157], v[98:101], v[34:49]
    v_exp_f32 v114, v114
    v_exp_f32 v115, v115
    v_exp_f32 v116, v116
    v_mfma_f32_32x32x16_bf16 v[34:49], v[158:161], v[102:105], v[34:49]
    v_exp_f32 v117, v117
    v_exp_f32 v118, v118
    v_exp_f32 v119, v119
    v_cvt_pk_bf16_f32 v114, v114, v115
    v_mfma_f32_32x32x16_bf16 v[98:113], v[130:133], v[18:21], 0
    v_exp_f32 v120, v120
    v_exp_f32 v121, v121
    v_exp_f32 v122, v122
    v_cvt_pk_bf16_f32 v115, v116, v117
    v_cvt_pk_bf16_f32 v116, v118, v119
ST_C_23:
    s_cbranch_execz K1_CONS
    v_mfma_f32_32x32x16_bf16 v[98:113], v[134:137], v[22:25], v[98:113]
    v_exp_f32 v123, v123
    v_exp_f32 v124, v124
    v_exp_f32 v125, v125
    v_exp_f32 v126, v126
    v_exp_f32 v127, v127
    v_exp_f32 v128, v128
    v_exp_f32 v129, v129
    v_cvt_pk_bf16_f32 v117, v120, v121
    v_cvt_pk_bf16_f32 v118, v122, v123
    v_cvt_pk_bf16_f32 v119, v124, v125
    v_cvt_pk_bf16_f32 v120, v126, v127
    v_cvt_pk_bf16_f32 v121, v128, v129
    v_mfma_f32_32x32x16_bf16 v[50:65], v[154:157], v[114:117], v[50:65]
    v_exp_f32 v98, v98
    v_exp_f32 v99, v99
    v_exp_f32 v100, v100
    v_mfma_f32_32x32x16_bf16 v[50:65], v[158:161], v[118:121], v[50:65]
    s_sub_u32 s15, s39, 1
    s_and_b32 s15, s15, 7
    s_lshl_b32 s16, s15, 11
    v_add_u32 v162, s16, v1
    s_cmp_eq_u32 s15, 7
    s_cbranch_scc1 K2_SKW0
    ds_write_b128 v162, v[34:37] offset:0
    ds_write_b128 v162, v[38:41] offset:1024
K2_SKW0:
    s_sub_u32 s15, s39, 2
    s_and_b32 s15, s15, 7
    s_lshl_b32 s16, s15, 11
    v_add_u32 v162, s16, v1
    s_cmp_eq_u32 s15, 7
    s_cbranch_scc1 K2_SKW1
    ds_write_b128 v162, v[42:45] offset:14336
    ds_write_b128 v162, v[46:49] offset:15360
K2_SKW1:
    ds_write_b32 v163, v46 offset:0
    v_exp_f32 v101, v101
    v_exp_f32 v102, v102
    v_exp_f32 v103, v103
    v_cvt_pk_bf16_f32 v98, v98, v99
    v_mfma_f32_32x32x16_bf16 v[114:129], v[138:141], v[18:21], 0
    v_exp_f32 v104, v104
    v_exp_f32 v105, v105
    v_exp_f32 v106, v106
    v_cvt_pk_bf16_f32 v99, v100, v101
    v_cvt_pk_bf16_f32 v100, v102, v103
ST_C_24:
    s_cbranch_execz K1_CONS
    v_mfma_f32_32x32x16_bf16 v[114:129], v[142:145], v[22:25], v[114:129]
    v_exp_f32 v107, v107
    v_exp_f32 v108, v108
    v_exp_f32 v109, v109
    v_exp_f32 v110, v110
    v_exp_f32 v111, v111
    v_exp_f32 v112, v112
    v_exp_f32 v113, v113
    v_cvt_pk_bf16_f32 v101, v104, v105
    v_cvt_pk_bf16_f32 v102, v106, v107
    v_cvt_pk_bf16_f32 v103, v108, v109
    v_cvt_pk_bf16_f32 v104, v110, v111
    v_cvt_pk_bf16_f32 v105, v112, v113
    v_mfma_f32_32x32x16_bf16 v[66:81], v[146:149], v[98:101], v[66:81]
    v_exp_f32 v114, v114
    v_exp_f32 v115, v115
    v_exp_f32 v116, v116
    v_mfma_f32_32x32x16_bf16 v[66:81], v[150:153], v[102:105], v[66:81]
    s_sub_u32 s15, s39, 3
    s_and_b32 s15, s15, 7
    s_lshl_b32 s16, s15, 11
    v_add_u32 v162, s16, v1
    s_cmp_eq_u32 s15, 7
    s_cbranch_scc1 K2_SKW2
    ds_write_b128 v162, v[50:53] offset:28672
    ds_write_b128 v162, v[54:57] offset:29696
K2_SKW2:
    s_sub_u32 s15, s39, 4
    s_and_b32 s15, s15, 7
    s_lshl_b32 s16, s15, 11
    v_add_u32 v162, s16, v1
    s_cmp_eq_u32 s15, 7
    s_cbranch_scc1 K2_SKW3
    ds_write_b128 v162, v[58:61] offset:43008
    ds_write_b128 v162, v[62:65] offset:44032
K2_SKW3:
    ds_write_b32 v163, v62 offset:2048
    s_lshl_b32 s15, s3, 2
    s_add_u32 s15, s15, 155776
    s_add_u32 s16, s14, 1
    v_mov_b32 v162, s15
    v_mov_b32 v164, s16
    s_mov_b64 exec, 1
    ds_write_b32 v162, v164
    s_mov_b64 exec, -1
    v_exp_f32 v117, v117
    v_exp_f32 v118, v118
    v_exp_f32 v119, v119
    v_cvt_pk_bf16_f32 v114, v114, v115
ST_C_25:
    s_cbranch_execz K1_CONS
    v_mfma_f32_32x32x16_bf16 v[98:113], v[130:133], v[26:29], 0
    v_exp_f32 v120, v120
    v_exp_f32 v121, v121
    v_exp_f32 v122, v122
    v_cvt_pk_bf16_f32 v115, v116, v117
    v_cvt_pk_bf16_f32 v116, v118, v119
    v_mfma_f32_32x32x16_bf16 v[98:113], v[134:137], v[30:33], v[98:113]
    v_exp_f32 v123, v123
    v_exp_f32 v124, v124
    v_exp_f32 v125, v125
    v_exp_f32 v126, v126
    v_exp_f32 v127, v127
    v_exp_f32 v128, v128
    v_exp_f32 v129, v129
    v_cvt_pk_bf16_f32 v117, v120, v121
    v_cvt_pk_bf16_f32 v118, v122, v123
    v_cvt_pk_bf16_f32 v119, v124, v125
    v_cvt_pk_bf16_f32 v120, v126, v127
    v_cvt_pk_bf16_f32 v121, v128, v129
    v_mfma_f32_32x32x16_bf16 v[66:81], v[154:157], v[114:117], v[66:81]
    v_exp_f32 v98, v98
    v_exp_f32 v99, v99
    v_exp_f32 v100, v100
    v_mfma_f32_32x32x16_bf16 v[66:81], v[158:161], v[118:121], v[66:81]
    v_exp_f32 v101, v101
    v_exp_f32 v102, v102
    v_exp_f32 v103, v103
    v_cvt_pk_bf16_f32 v98, v98, v99
    v_mfma_f32_32x32x16_bf16 v[114:129], v[138:141], v[26:29], 0
    v_exp_f32 v104, v104
    v_exp_f32 v105, v105
    v_exp_f32 v106, v106
    v_cvt_pk_bf16_f32 v99, v100, v101
    v_cvt_pk_bf16_f32 v100, v102, v103
    v_mfma_f32_32x32x16_bf16 v[114:129], v[142:145], v[30:33], v[114:129]
    v_exp_f32 v107, v107
    v_exp_f32 v108, v108
    v_exp_f32 v109, v109
    v_exp_f32 v110, v110
    v_exp_f32 v111, v111
    v_exp_f32 v112, v112
    v_exp_f32 v113, v113
    v_cvt_pk_bf16_f32 v101, v104, v105
    v_cvt_pk_bf16_f32 v102, v106, v107
    v_cvt_pk_bf16_f32 v103, v108, v109
ST_C_26:
    s_cbranch_execz K1_CONS
    v_cvt_pk_bf16_f32 v104, v110, v111
    v_cvt_pk_bf16_f32 v105, v112, v113
    v_mfma_f32_32x32x16_bf16 v[82:97], v[146:149], v[98:101], v[82:97]
    v_exp_f32 v114, v114
    v_exp_f32 v115, v115
    v_exp_f32 v116, v116
    v_mfma_f32_32x32x16_bf16 v[82:97], v[150:153], v[102:105], v[82:97]
    s_sub_u32 s15, s39, 5
    s_and_b32 s15, s15, 7
    s_lshl_b32 s16, s15, 11
    v_add_u32 v162, s16, v1
    s_cmp_eq_u32 s15, 7
    s_cbranch_scc1 K2_SKW4
    ds_write_b128 v162, v[66:69] offset:57344
    ds_write_b128 v162, v[70:73] offset:58368
K2_SKW4:
    s_sub_u32 s15, s39, 6
    s_and_b32 s15, s15, 7
    s_lshl_b32 s16, s15, 11
    s_add_u32 s16, s16, 0x10000
    v_add_u32 v162, s16, v1
    s_cmp_eq_u32 s15, 7
    s_cbranch_scc1 K2_SKW5
    ds_write_b128 v162, v[74:77] offset:6144
    ds_write_b128 v162, v[78:81] offset:7168
K2_SKW5:
    ds_write_b32 v163, v78 offset:4096
    v_exp_f32 v117, v117
    v_exp_f32 v118, v118
    v_exp_f32 v119, v119
    v_cvt_pk_bf16_f32 v114, v114, v115
    v_exp_f32 v120, v120
    v_exp_f32 v121, v121
    v_exp_f32 v122, v122
    v_cvt_pk_bf16_f32 v115, v116, v117
    v_cvt_pk_bf16_f32 v116, v118, v119
    v_exp_f32 v123, v123
    v_exp_f32 v124, v124
    v_exp_f32 v125, v125
    v_exp_f32 v126, v126
    v_exp_f32 v127, v127
    v_exp_f32 v128, v128
    v_exp_f32 v129, v129
    v_cvt_pk_bf16_f32 v117, v120, v121
    v_cvt_pk_bf16_f32 v118, v122, v123
    v_cvt_pk_bf16_f32 v119, v124, v125
    v_cvt_pk_bf16_f32 v120, v126, v127
ST_C_27:
    s_cbranch_execz K1_CONS
    v_cvt_pk_bf16_f32 v121, v128, v129
    s_cmp_ge_u32 s3, 4
    s_cbranch_scc1 K2_AP32
    s_setprio 3
K2_AP32:
    v_mfma_f32_32x32x16_bf16 v[82:97], v[154:157], v[114:117], v[82:97]
    v_mfma_f32_32x32x16_bf16 v[82:97], v[158:161], v[118:121], v[82:97]
    s_sub_u32 s15, s39, 7
    s_and_b32 s15, s15, 7
    s_lshl_b32 s16, s15, 11
    s_add_u32 s16, s16, 0x10000
    v_add_u32 v162, s16, v1
    s_cmp_eq_u32 s15, 7
    s_cbranch_scc1 K2_SKW6
    s_nop 4
    ds_write_b128 v162, v[82:85] offset:20480
    ds_write_b128 v162, v[86:89] offset:21504
K2_SKW6:
    s_sub_u32 s15, s39, 8
    s_and_b32 s15, s15, 7
    s_lshl_b32 s16, s15, 11
    s_add_u32 s16, s16, 0x10000
    v_add_u32 v162, s16, v1
    s_cmp_eq_u32 s15, 7
    s_cbranch_scc1 K2_SKW7
    ds_write_b128 v162, v[90:93] offset:34816
    ds_write_b128 v162, v[94:97] offset:35840
K2_SKW7:
    ds_write_b32 v163, v94 offset:6144
    s_lshl_b32 s15, s39, 3
    s_set_gpr_idx_on s15, gpr_idx(SRC0)
    v_mov_b32 v98, v34
    v_mov_b32 v99, v35
    v_mov_b32 v100, v36
    v_mov_b32 v101, v37
    v_mov_b32 v102, v38
    v_mov_b32 v103, v39
    v_mov_b32 v104, v40
    v_mov_b32 v105, v41
    s_set_gpr_idx_off
    s_mul_i32 s15, s39, 14336
    v_add_u32 v162, s15, v1
    s_lshr_b32 s16, s39, 1
    s_lshl_b32 s17, s16, 11
    s_add_u32 s17, s17, 115712
    v_and_b32 v164, 31, v0
    v_lshl_add_u32 v164, v164, 5, s17
    s_lshl_b32 s15, s5, 2
    s_add_u32 s15, s15, s16
    s_mul_i32 s15, s15, 147456
    s_lshl_b32 s16, s4, 1
    s_and_b32 s17, s3, 1
ST_C_28:
    s_cbranch_execz K1_CONS
    s_add_u32 s16, s16, s17
    s_lshl_b32 s16, s16, 10
    s_add_u32 s15, s15, s16
    s_add_u32 s15, s15, 8503296
    s_and_b32 s25, s3, 1
    s_lshl_b32 s25, s25, 5
    s_sub_u32 s25, 64, s25
    v_cmp_gt_u32 vcc, s25, v0
    s_cmp_lg_u32 s14, 0
    s_cselect_b64 s[22:23], 0, -1
    s_mov_b32 s26, 0x30800000
    s_mov_b32 s27, 0x4e800000
    s_cmp_lt_u32 s3, 4
    s_cbranch_scc1 K2_TPA
    v_and_b32 v106, 7, v0
    v_lshlrev_b32 v106, 2, v106
    v_add_u32 v106, 155776, v106
K2_TPL:
    ds_read_b32 v107, v106
    s_waitcnt lgkmcnt(0)
    v_cmp_ge_u32 s[18:19], s14, v107
    s_cmp_eq_u64 s[18:19], 0
    s_cbranch_scc1 K2_TPB
    s_sleep 1
    s_branch K2_TPL
K2_TPA:
    s_setprio 3
    s_waitcnt lgkmcnt(0)
    s_barrier
K2_TPB:
    ds_read_b128 v[106:109], v164
    ds_read_b128 v[110:113], v164 offset:16
    ds_read_b128 v[34:37], v162 offset:0
    ds_read_b128 v[38:41], v162 offset:1024
    ds_read_b128 v[42:45], v162 offset:2048
    ds_read_b128 v[46:49], v162 offset:3072
    ds_read_b128 v[50:53], v162 offset:4096
    ds_read_b128 v[54:57], v162 offset:5120
    ds_read_b128 v[58:61], v162 offset:6144
    ds_read_b128 v[62:65], v162 offset:7168
    ds_read_b128 v[66:69], v162 offset:8192
    ds_read_b128 v[70:73], v162 offset:9216
    ds_read_b128 v[74:77], v162 offset:10240
    ds_read_b128 v[78:81], v162 offset:11264
    s_waitcnt lgkmcnt(12)
    ds_read_b128 v[82:85], v162 offset:12288
ST_C_29:
    s_cbranch_execz K1_CONS
    ds_read_b128 v[86:89], v162 offset:13312
    v_add_f32 v106, v106, v107
    v_add_f32 v108, v108, v109
    v_add_f32 v110, v110, v111
    v_add_f32 v112, v112, v113
    v_add_f32 v106, v106, v108
    v_add_f32 v110, v110, v112
    v_add_f32 v106, v106, v110
    v_rcp_f32 v107, v106
    v_cmp_nle_f32 s[18:19], s26, v106
    v_cmp_nge_f32 s[20:21], s27, v106
    v_mul_f32 v107, v107, v165
    s_or_b64 s[18:19], s[18:19], s[20:21]
    v_cndmask_b32 v108, 0, v107, vcc
    s_and_b64 s[18:19], s[18:19], s[22:23]
    s_waitcnt lgkmcnt(12)
    v_add_f32 v98, v98, v34
    v_add_f32 v99, v99, v35
    v_add_f32 v100, v100, v36
    v_add_f32 v101, v101, v37
    v_add_f32 v102, v102, v38
    v_add_f32 v103, v103, v39
    v_add_f32 v104, v104, v40
    v_add_f32 v105, v105, v41
    s_waitcnt lgkmcnt(10)
    v_add_f32 v98, v98, v42
    v_add_f32 v99, v99, v43
    v_add_f32 v100, v100, v44
    v_add_f32 v101, v101, v45
    v_add_f32 v102, v102, v46
    v_add_f32 v103, v103, v47
    v_add_f32 v104, v104, v48
    v_add_f32 v105, v105, v49
    s_waitcnt lgkmcnt(8)
    v_add_f32 v98, v98, v50
    v_add_f32 v99, v99, v51
    v_add_f32 v100, v100, v52
    v_add_f32 v101, v101, v53
    v_add_f32 v102, v102, v54
    v_add_f32 v103, v103, v55
    v_add_f32 v104, v104, v56
    v_add_f32 v105, v105, v57
    s_waitcnt lgkmcnt(6)
    v_add_f32 v98, v98, v58
    v_add_f32 v99, v99, v59
    v_add_f32 v100, v100, v60
    v_add_f32 v101, v101, v61
    v_add_f32 v102, v102, v62
    v_add_f32 v103, v103, v63
    v_add_f32 v104, v104, v64
    v_add_f32 v105, v105, v65
    s_waitcnt lgkmcnt(4)
    v_add_f32 v98, v98, v66
    v_add_f32 v99, v99, v67
    v_add_f32 v100, v100, v68
    v_add_f32 v101, v101, v69
    v_add_f32 v102, v102, v70
    v_add_f32 v103, v103, v71
    v_add_f32 v104, v104, v72
ST_C_30:
    s_cbranch_execz K1_CONS
    v_add_f32 v105, v105, v73
    s_waitcnt lgkmcnt(2)
    v_add_f32 v98, v98, v74
    v_add_f32 v99, v99, v75
    v_add_f32 v100, v100, v76
    v_add_f32 v101, v101, v77
    v_add_f32 v102, v102, v78
    v_add_f32 v103, v103, v79
    v_add_f32 v104, v104, v80
    v_add_f32 v105, v105, v81
    s_waitcnt lgkmcnt(0)
    v_add_f32 v98, v98, v82
    v_add_f32 v99, v99, v83
    v_add_f32 v100, v100, v84
    v_add_f32 v101, v101, v85
    v_add_f32 v102, v102, v86
    v_add_f32 v103, v103, v87
    v_add_f32 v104, v104, v88
    v_add_f32 v105, v105, v89
    v_mul_f32 v98, v98, v107
    v_mul_f32 v99, v99, v107
    v_mul_f32 v100, v100, v107
    v_mul_f32 v101, v101, v107
    v_mul_f32 v102, v102, v108
    v_mul_f32 v103, v103, v108
    v_mul_f32 v104, v104, v108
    v_mul_f32 v105, v105, v108
    v_cvt_pk_bf16_f32 v98, v98, v99
    v_cvt_pk_bf16_f32 v99, v100, v101
    v_cvt_pk_bf16_f32 v100, v102, v103
    v_cvt_pk_bf16_f32 v101, v104, v105
    v_min_u32 v98, -2, v98
    v_min_u32 v99, -2, v99
    v_min_u32 v100, -2, v100
    v_min_u32 v101, -2, v101
    s_cmp_eq_u64 s[18:19], 0
    s_cbranch_scc1 K2_OKS
    v_mov_b32 v162, 155712
    v_mov_b32 v164, 1
    ds_write_b32 v162, v164
    s_branch K2_OKW
K2_OKS:
    buffer_store_dwordx4 v[98:101], v1, s[32:35], s15 offen sc1
    s_cmp_lg_u32 s14, 0
    s_cbranch_scc1 K2_END
K2_OKW:
    s_cmp_lt_u32 s3, 4
    s_cbranch_scc1 K2_TPC
    s_barrier
K2_TPC:
    v_mov_b32 v162, 155712
    s_waitcnt lgkmcnt(0)
    s_barrier
    ds_read_b32 v164, v162
    s_waitcnt lgkmcnt(0)
    v_readfirstlane_b32 s15, v164
    s_cmp_eq_u32 s15, 0
ST_C_31:
    s_cbranch_execz K1_CONS
    s_cbranch_scc1 K2_END
    s_waitcnt vmcnt(0)
    s_mov_b32 s14, 1
    s_mov_b32 s13, s38
    s_mov_b32 s15, 8
    v_mov_b32 v34, 0xff800000
    v_mov_b32 v35, 0xff800000
    v_mov_b32 v36, 0xff800000
    v_mov_b32 v37, 0xff800000
K2_MXL:
    buffer_load_dwordx4 v[130:133], v1, s[32:35], s13 offen
    buffer_load_dwordx4 v[134:137], v1, s[32:35], s13 offen offset:1024
    s_waitcnt vmcnt(0)
    v_mfma_f32_32x32x16_bf16 v[98:113], v[130:133], v[2:5], 0
    v_mfma_f32_32x32x16_bf16 v[98:113], v[134:137], v[6:9], v[98:113]
    s_nop 11
    v_max3_f32 v34, v34, v98, v99
    v_max3_f32 v34, v34, v100, v101
    v_max3_f32 v34, v34, v102, v103
    v_max3_f32 v34, v34, v104, v105
    v_max3_f32 v34, v34, v106, v107
    v_max3_f32 v34, v34, v108, v109
    v_max3_f32 v34, v34, v110, v111
    v_max3_f32 v34, v34, v112, v113
    v_mfma_f32_32x32x16_bf16 v[98:113], v[130:133], v[10:13], 0
    v_mfma_f32_32x32x16_bf16 v[98:113], v[134:137], v[14:17], v[98:113]
    s_nop 11
    v_max3_f32 v35, v35, v98, v99
    v_max3_f32 v35, v35, v100, v101
    v_max3_f32 v35, v35, v102, v103
    v_max3_f32 v35, v35, v104, v105
    v_max3_f32 v35, v35, v106, v107
    v_max3_f32 v35, v35, v108, v109
    v_max3_f32 v35, v35, v110, v111
    v_max3_f32 v35, v35, v112, v113
    v_mfma_f32_32x32x16_bf16 v[98:113], v[130:133], v[18:21], 0
    v_mfma_f32_32x32x16_bf16 v[98:113], v[134:137], v[22:25], v[98:113]
    s_nop 11
    v_max3_f32 v36, v36, v98, v99
    v_max3_f32 v36, v36, v100, v101
    v_max3_f32 v36, v36, v102, v103
    v_max3_f32 v36, v36, v104, v105
    v_max3_f32 v36, v36, v106, v107
    v_max3_f32 v36, v36, v108, v109
    v_max3_f32 v36, v36, v110, v111
    v_max3_f32 v36, v36, v112, v113
    v_mfma_f32_32x32x16_bf16 v[98:113], v[130:133], v[26:29], 0
    v_mfma_f32_32x32x16_bf16 v[98:113], v[134:137], v[30:33], v[98:113]
    s_nop 11
    v_max3_f32 v37, v37, v98, v99
    v_max3_f32 v37, v37, v100, v101
    v_max3_f32 v37, v37, v102, v103
    v_max3_f32 v37, v37, v104, v105
    v_max3_f32 v37, v37, v106, v107
    v_max3_f32 v37, v37, v108, v109
    v_max3_f32 v37, v37, v110, v111
    v_max3_f32 v37, v37, v112, v113
    s_add_u32 s13, s13, 57344
    s_sub_u32 s15, s15, 1
    s_cmp_lg_u32 s15, 0
    s_nop 7
    s_cbranch_scc1 K2_MXL
    ds_write_b32 v163, v34 offset:0
    ds_write_b32 v163, v35 offset:2048
    ds_write_b32 v163, v36 offset:4096
    ds_write_b32 v163, v37 offset:6144
    v_and_b32 v164, 31, v0
    v_lshlrev_b32 v164, 5, v164
    v_add_u32 v164, 114688, v164
    v_cmp_le_u32 vcc, 32, v0
    s_waitcnt lgkmcnt(0)
    s_barrier
    ds_read_b128 v[98:101], v164 offset:0
    ds_read_b128 v[102:105], v164 offset:16
    ds_read_b128 v[106:109], v164 offset:1024
    ds_read_b128 v[110:113], v164 offset:1040
    s_waitcnt lgkmcnt(0)
    v_max_f32 v38, v98, v99
    v_max3_f32 v38, v38, v100, v101
    v_max3_f32 v38, v38, v102, v103
    v_max3_f32 v38, v38, v104, v105
    v_max3_f32 v38, v38, v106, v107
    v_max3_f32 v38, v38, v108, v109
    v_max3_f32 v38, v38, v110, v111
    v_max3_f32 v38, v38, v112, v113
    v_mul_f32 v38, -1.0, v38
    v_and_b32 v39, 0xffff0000, v38
    v_sub_f32 v38, v38, v39
    v_and_b32 v40, 0xffff0000, v38
    v_sub_f32 v38, v38, v40
    v_lshrrev_b32 v39, 16, v39
    v_or_b32 v39, v39, v40
    v_lshrrev_b32 v38, 16, v38
    v_cndmask_b32 v8, v8, v39, s[40:41]
    v_cndmask_b32 v9, v9, v38, s[40:41]
    v_cndmask_b32 v2, v2, v39, s[42:43]
    v_cndmask_b32 v3, v3, v38, s[42:43]
    ds_read_b128 v[98:101], v164 offset:2048
    ds_read_b128 v[102:105], v164 offset:2064
    ds_read_b128 v[106:109], v164 offset:3072
    ds_read_b128 v[110:113], v164 offset:3088
    s_waitcnt lgkmcnt(0)
    v_max_f32 v38, v98, v99
    v_max3_f32 v38, v38, v100, v101
    v_max3_f32 v38, v38, v102, v103
    v_max3_f32 v38, v38, v104, v105
    v_max3_f32 v38, v38, v106, v107
    v_max3_f32 v38, v38, v108, v109
    v_max3_f32 v38, v38, v110, v111
    v_max3_f32 v38, v38, v112, v113
    v_mul_f32 v38, -1.0, v38
    v_and_b32 v39, 0xffff0000, v38
    v_sub_f32 v38, v38, v39
    v_and_b32 v40, 0xffff0000, v38
    v_sub_f32 v38, v38, v40
    v_lshrrev_b32 v39, 16, v39
    v_or_b32 v39, v39, v40
    v_lshrrev_b32 v38, 16, v38
    v_cndmask_b32 v16, v16, v39, s[40:41]
    v_cndmask_b32 v17, v17, v38, s[40:41]
    v_cndmask_b32 v10, v10, v39, s[42:43]
    v_cndmask_b32 v11, v11, v38, s[42:43]
    ds_read_b128 v[98:101], v164 offset:4096
    ds_read_b128 v[102:105], v164 offset:4112
    ds_read_b128 v[106:109], v164 offset:5120
    ds_read_b128 v[110:113], v164 offset:5136
    s_waitcnt lgkmcnt(0)
    v_max_f32 v38, v98, v99
    v_max3_f32 v38, v38, v100, v101
    v_max3_f32 v38, v38, v102, v103
    v_max3_f32 v38, v38, v104, v105
    v_max3_f32 v38, v38, v106, v107
    v_max3_f32 v38, v38, v108, v109
    v_max3_f32 v38, v38, v110, v111
    v_max3_f32 v38, v38, v112, v113
    v_mul_f32 v38, -1.0, v38
    v_and_b32 v39, 0xffff0000, v38
    v_sub_f32 v38, v38, v39
    v_and_b32 v40, 0xffff0000, v38
    v_sub_f32 v38, v38, v40
    v_lshrrev_b32 v39, 16, v39
    v_or_b32 v39, v39, v40
    v_lshrrev_b32 v38, 16, v38
    v_cndmask_b32 v24, v24, v39, s[40:41]
    v_cndmask_b32 v25, v25, v38, s[40:41]
    v_cndmask_b32 v18, v18, v39, s[42:43]
    v_cndmask_b32 v19, v19, v38, s[42:43]
    ds_read_b128 v[98:101], v164 offset:6144
    ds_read_b128 v[102:105], v164 offset:6160
    ds_read_b128 v[106:109], v164 offset:7168
    ds_read_b128 v[110:113], v164 offset:7184
    s_waitcnt lgkmcnt(0)
    v_max_f32 v38, v98, v99
    v_max3_f32 v38, v38, v100, v101
    v_max3_f32 v38, v38, v102, v103
    v_max3_f32 v38, v38, v104, v105
    v_max3_f32 v38, v38, v106, v107
    v_max3_f32 v38, v38, v108, v109
    v_max3_f32 v38, v38, v110, v111
    v_max3_f32 v38, v38, v112, v113
    v_mul_f32 v38, -1.0, v38
    v_and_b32 v39, 0xffff0000, v38
    v_sub_f32 v38, v38, v39
    v_and_b32 v40, 0xffff0000, v38
    v_sub_f32 v38, v38, v40
    v_lshrrev_b32 v39, 16, v39
    v_or_b32 v39, v39, v40
    v_lshrrev_b32 v38, 16, v38
    v_cndmask_b32 v32, v32, v39, s[40:41]
    v_cndmask_b32 v33, v33, v38, s[40:41]
    v_cndmask_b32 v26, v26, v39, s[42:43]
    v_cndmask_b32 v27, v27, v38, s[42:43]
    buffer_load_dwordx4 v[130:133], v1, s[32:35], s38 offen
    buffer_load_dwordx4 v[134:137], v1, s[32:35], s38 offen offset:1024
    s_waitcnt vmcnt(0)
    s_barrier
    s_branch K2_RUN
ST_C_32:
    s_cbranch_execz K1_CONS
K2_GEMM:
    s_load_dwordx2 s[36:37], s[0:1], 64
    s_sub_u32 s3, s3, 8
    s_cmp_lg_u32 s3, 0
    s_cbranch_scc1 K2_G1
    v_lshlrev_b32 v162, 2, v0
    v_add_u32 v162, 131072, v162
    v_mov_b32 v163, 0
    ds_write_b32 v162, v163 offset:24576
K2_G1:
    s_mul_i32 s8, s7, 37
    s_lshr_b32 s8, s8, 8
    s_mul_i32 s9, s8, 7
    s_sub_u32 s9, s7, s9
    s_lshl_b32 s10, s6, 2
    s_add_u32 s8, s8, s10
    s_and_b32 s10, s3, 1
ST_C_33:
    s_cbranch_execz K1_CONS
    s_lshr_b32 s11, s3, 1
    s_mul_i32 s12, s3, 28672
    s_lshl_b32 s13, s9, 1
    s_add_u32 s14, s13, s10
    s_xor_b32 s15, s14, 1
    s_mul_i32 s14, s14, 147456
    s_mul_i32 s15, s15, 147456
    s_add_u32 s14, s14, 25165824
    s_add_u32 s15, s15, 25165824
    s_lshl_b32 s13, s8, 1
    s_add_u32 s16, s13, s11
    s_lshl_b32 s22, s16, 5
    s_xor_b32 s17, s16, 1
    s_lshl_b32 s20, s16, 7
    s_lshl_b32 s21, s17, 7
    s_add_u32 s20, s20, 18874368
    s_add_u32 s21, s21, 18874368
    s_mul_i32 s16, s16, 147456
    s_mul_i32 s17, s17, 147456
    s_add_u32 s16, s16, 8388608
    s_add_u32 s17, s17, 8388608
    s_lshl_b32 s13, s3, 13
    s_add_u32 s23, s13, 122880
    s_add_u32 s13, s13, 114688
    s_add_u32 s40, s14, s13
    s_add_u32 s41, s15, s13
    s_add_u32 s42, s16, s13
    s_add_u32 s43, s17, s13
    s_add_u32 s44, s40, 4096
    s_add_u32 s45, s41, 4096
    s_add_u32 s46, s42, 4096
    s_add_u32 s47, s43, 4096
    s_add_u32 s14, s14, s12
    s_add_u32 s15, s15, s12
    s_add_u32 s16, s16, s12
    s_add_u32 s17, s17, s12
    v_and_b32 v165, 31, v0
    v_lshlrev_b32 v164, 2, v165
    s_mov_b32 s38, 1835008
    s_mov_b32 s39, 0x00020000
    s_waitcnt lgkmcnt(0)
    s_cmp_ge_u32 s7, 28
    s_cbranch_scc0 K2_G2
    s_barrier
ST_C_34:
    s_cbranch_execz K1_CONS
    s_endpgm
K2_G2:
    s_barrier
    buffer_load_dwordx4 v[66:69], v1, s[32:35], s14 offen offset:0
    buffer_load_dwordx4 v[70:73], v1, s[32:35], s16 offen offset:0
    buffer_load_dwordx4 v[74:77], v1, s[32:35], s15 offen offset:0
    buffer_load_dwordx4 v[78:81], v1, s[32:35], s17 offen offset:0
    buffer_load_dwordx4 v[82:85], v1, s[32:35], s14 offen offset:1024
    buffer_load_dwordx4 v[86:89], v1, s[32:35], s16 offen offset:1024
    buffer_load_dwordx4 v[90:93], v1, s[32:35], s15 offen offset:1024
    buffer_load_dwordx4 v[94:97], v1, s[32:35], s17 offen offset:1024
    buffer_load_dwordx4 v[98:101], v1, s[32:35], s14 offen offset:2048
    buffer_load_dwordx4 v[102:105], v1, s[32:35], s16 offen offset:2048
    buffer_load_dwordx4 v[106:109], v1, s[32:35], s15 offen offset:2048
    buffer_load_dwordx4 v[110:113], v1, s[32:35], s17 offen offset:2048
    buffer_load_dwordx4 v[114:117], v1, s[32:35], s14 offen offset:3072
    buffer_load_dwordx4 v[118:121], v1, s[32:35], s16 offen offset:3072
    buffer_load_dwordx4 v[122:125], v1, s[32:35], s15 offen offset:3072
    buffer_load_dwordx4 v[126:129], v1, s[32:35], s17 offen offset:3072
    s_add_u32 s14, s14, 4096
    s_add_u32 s15, s15, 4096
    s_add_u32 s16, s16, 4096
    s_add_u32 s17, s17, 4096
    buffer_load_dwordx4 v[130:133], v1, s[32:35], s14 offen offset:0
    buffer_load_dwordx4 v[134:137], v1, s[32:35], s16 offen offset:0
    buffer_load_dwordx4 v[138:141], v1, s[32:35], s15 offen offset:0
    buffer_load_dwordx4 v[142:145], v1, s[32:35], s17 offen offset:0
    buffer_load_dwordx4 v[146:149], v1, s[32:35], s14 offen offset:1024
    buffer_load_dwordx4 v[150:153], v1, s[32:35], s16 offen offset:1024
    buffer_load_dwordx4 v[154:157], v1, s[32:35], s15 offen offset:1024
    buffer_load_dwordx4 v[158:161], v1, s[32:35], s17 offen offset:1024
    buffer_load_dword v166, v164, s[32:35], s20 offen
    buffer_load_dword v167, v164, s[32:35], s21 offen
    s_waitcnt vmcnt(24)
ST_C_35:
    s_cbranch_execz K1_CONS
    v_mfma_f32_32x32x16_bf16 v[2:17], v[66:69], v[70:73], 0
    s_waitcnt vmcnt(23)
    v_mfma_f32_32x32x16_bf16 v[34:49], v[74:77], v[70:73], 0
    s_waitcnt vmcnt(22)
    v_mfma_f32_32x32x16_bf16 v[18:33], v[66:69], v[78:81], 0
    v_mfma_f32_32x32x16_bf16 v[50:65], v[74:77], v[78:81], 0
    buffer_load_dwordx4 v[66:69], v1, s[32:35], s14 offen offset:2048
    buffer_load_dwordx4 v[70:73], v1, s[32:35], s16 offen offset:2048
    buffer_load_dwordx4 v[74:77], v1, s[32:35], s15 offen offset:2048
    buffer_load_dwordx4 v[78:81], v1, s[32:35], s17 offen offset:2048
    s_waitcnt vmcnt(24)
    v_mfma_f32_32x32x16_bf16 v[2:17], v[82:85], v[86:89], v[2:17]
    s_waitcnt vmcnt(23)
    v_mfma_f32_32x32x16_bf16 v[34:49], v[90:93], v[86:89], v[34:49]
    s_waitcnt vmcnt(22)
    v_mfma_f32_32x32x16_bf16 v[18:33], v[82:85], v[94:97], v[18:33]
    v_mfma_f32_32x32x16_bf16 v[50:65], v[90:93], v[94:97], v[50:65]
    buffer_load_dwordx4 v[82:85], v1, s[32:35], s14 offen offset:3072
    buffer_load_dwordx4 v[86:89], v1, s[32:35], s16 offen offset:3072
    buffer_load_dwordx4 v[90:93], v1, s[32:35], s15 offen offset:3072
    buffer_load_dwordx4 v[94:97], v1, s[32:35], s17 offen offset:3072
    s_waitcnt vmcnt(24)
    v_mfma_f32_32x32x16_bf16 v[2:17], v[98:101], v[102:105], v[2:17]
    s_waitcnt vmcnt(23)
    v_mfma_f32_32x32x16_bf16 v[34:49], v[106:109], v[102:105], v[34:49]
    s_waitcnt vmcnt(22)
    v_mfma_f32_32x32x16_bf16 v[18:33], v[98:101], v[110:113], v[18:33]
    v_mfma_f32_32x32x16_bf16 v[50:65], v[106:109], v[110:113], v[50:65]
    s_add_u32 s14, s14, 4096
    s_add_u32 s15, s15, 4096
    s_add_u32 s16, s16, 4096
    s_add_u32 s17, s17, 4096
    buffer_load_dwordx4 v[98:101], v1, s[32:35], s14 offen offset:0
    buffer_load_dwordx4 v[102:105], v1, s[32:35], s16 offen offset:0
    buffer_load_dwordx4 v[106:109], v1, s[32:35], s15 offen offset:0
    buffer_load_dwordx4 v[110:113], v1, s[32:35], s17 offen offset:0
ST_C_36:
    s_cbranch_execz K1_CONS
    s_waitcnt vmcnt(24)
    v_mfma_f32_32x32x16_bf16 v[2:17], v[114:117], v[118:121], v[2:17]
    s_waitcnt vmcnt(23)
    v_mfma_f32_32x32x16_bf16 v[34:49], v[122:125], v[118:121], v[34:49]
    s_waitcnt vmcnt(22)
    v_mfma_f32_32x32x16_bf16 v[18:33], v[114:117], v[126:129], v[18:33]
    v_mfma_f32_32x32x16_bf16 v[50:65], v[122:125], v[126:129], v[50:65]
    buffer_load_dwordx4 v[114:117], v1, s[32:35], s14 offen offset:1024
    buffer_load_dwordx4 v[118:121], v1, s[32:35], s16 offen offset:1024
    buffer_load_dwordx4 v[122:125], v1, s[32:35], s15 offen offset:1024
    buffer_load_dwordx4 v[126:129], v1, s[32:35], s17 offen offset:1024
    s_waitcnt vmcnt(24)
    v_mfma_f32_32x32x16_bf16 v[2:17], v[130:133], v[134:137], v[2:17]
    s_waitcnt vmcnt(23)
    v_mfma_f32_32x32x16_bf16 v[34:49], v[138:141], v[134:137], v[34:49]
    s_waitcnt vmcnt(22)
    v_mfma_f32_32x32x16_bf16 v[18:33], v[130:133], v[142:145], v[18:33]
    v_mfma_f32_32x32x16_bf16 v[50:65], v[138:141], v[142:145], v[50:65]
    buffer_load_dwordx4 v[130:133], v1, s[32:35], s14 offen offset:2048
    buffer_load_dwordx4 v[134:137], v1, s[32:35], s16 offen offset:2048
    buffer_load_dwordx4 v[138:141], v1, s[32:35], s15 offen offset:2048
    buffer_load_dwordx4 v[142:145], v1, s[32:35], s17 offen offset:2048
    s_waitcnt vmcnt(24)
    v_mfma_f32_32x32x16_bf16 v[2:17], v[146:149], v[150:153], v[2:17]
    s_waitcnt vmcnt(23)
    v_mfma_f32_32x32x16_bf16 v[34:49], v[154:157], v[150:153], v[34:49]
    s_waitcnt vmcnt(22)
    v_mfma_f32_32x32x16_bf16 v[18:33], v[146:149], v[158:161], v[18:33]
    v_mfma_f32_32x32x16_bf16 v[50:65], v[154:157], v[158:161], v[50:65]
    buffer_load_dwordx4 v[146:149], v1, s[32:35], s14 offen offset:3072
    buffer_load_dwordx4 v[150:153], v1, s[32:35], s16 offen offset:3072
    buffer_load_dwordx4 v[154:157], v1, s[32:35], s15 offen offset:3072
    buffer_load_dwordx4 v[158:161], v1, s[32:35], s17 offen offset:3072
    s_waitcnt vmcnt(22)
    v_mfma_f32_32x32x16_bf16 v[2:17], v[66:69], v[70:73], v[2:17]
    s_waitcnt vmcnt(21)
    v_mfma_f32_32x32x16_bf16 v[34:49], v[74:77], v[70:73], v[34:49]
ST_C_37:
    s_cbranch_execz K1_CONS
    s_waitcnt vmcnt(20)
    v_mfma_f32_32x32x16_bf16 v[18:33], v[66:69], v[78:81], v[18:33]
    v_mfma_f32_32x32x16_bf16 v[50:65], v[74:77], v[78:81], v[50:65]
    s_add_u32 s14, s14, 4096
    s_add_u32 s15, s15, 4096
    s_add_u32 s16, s16, 4096
    s_add_u32 s17, s17, 4096
    buffer_load_dwordx4 v[66:69], v1, s[32:35], s14 offen offset:0
    buffer_load_dwordx4 v[70:73], v1, s[32:35], s16 offen offset:0
    buffer_load_dwordx4 v[74:77], v1, s[32:35], s15 offen offset:0
    buffer_load_dwordx4 v[78:81], v1, s[32:35], s17 offen offset:0
    s_waitcnt vmcnt(22)
    v_mfma_f32_32x32x16_bf16 v[2:17], v[82:85], v[86:89], v[2:17]
    s_waitcnt vmcnt(21)
    v_mfma_f32_32x32x16_bf16 v[34:49], v[90:93], v[86:89], v[34:49]
    s_waitcnt vmcnt(20)
    v_mfma_f32_32x32x16_bf16 v[18:33], v[82:85], v[94:97], v[18:33]
    v_mfma_f32_32x32x16_bf16 v[50:65], v[90:93], v[94:97], v[50:65]
    buffer_load_dwordx4 v[82:85], v1, s[32:35], s14 offen offset:1024
    buffer_load_dwordx4 v[86:89], v1, s[32:35], s16 offen offset:1024
    buffer_load_dwordx4 v[90:93], v1, s[32:35], s15 offen offset:1024
    buffer_load_dwordx4 v[94:97], v1, s[32:35], s17 offen offset:1024
    s_waitcnt vmcnt(22)
    v_mfma_f32_32x32x16_bf16 v[2:17], v[98:101], v[102:105], v[2:17]
    s_waitcnt vmcnt(21)
    v_mfma_f32_32x32x16_bf16 v[34:49], v[106:109], v[102:105], v[34:49]
    s_waitcnt vmcnt(20)
    v_mfma_f32_32x32x16_bf16 v[18:33], v[98:101], v[110:113], v[18:33]
    v_mfma_f32_32x32x16_bf16 v[50:65], v[106:109], v[110:113], v[50:65]
    buffer_load_dwordx4 v[98:101], v1, s[32:35], s14 offen offset:2048
    buffer_load_dwordx4 v[102:105], v1, s[32:35], s16 offen offset:2048
    buffer_load_dwordx4 v[106:109], v1, s[32:35], s15 offen offset:2048
    buffer_load_dwordx4 v[110:113], v1, s[32:35], s17 offen offset:2048
    s_waitcnt vmcnt(22)
    v_mfma_f32_32x32x16_bf16 v[2:17], v[114:117], v[118:121], v[2:17]
ST_C_38:
    s_cbranch_execz K1_CONS
    s_waitcnt vmcnt(21)
    v_mfma_f32_32x32x16_bf16 v[34:49], v[122:125], v[118:121], v[34:49]
    s_waitcnt vmcnt(20)
    v_mfma_f32_32x32x16_bf16 v[18:33], v[114:117], v[126:129], v[18:33]
    v_mfma_f32_32x32x16_bf16 v[50:65], v[122:125], v[126:129], v[50:65]
    buffer_load_dwordx4 v[114:117], v1, s[32:35], s14 offen offset:3072
    buffer_load_dwordx4 v[118:121], v1, s[32:35], s16 offen offset:3072
    buffer_load_dwordx4 v[122:125], v1, s[32:35], s15 offen offset:3072
    buffer_load_dwordx4 v[126:129], v1, s[32:35], s17 offen offset:3072
    s_waitcnt vmcnt(22)
    v_mfma_f32_32x32x16_bf16 v[2:17], v[130:133], v[134:137], v[2:17]
    s_waitcnt vmcnt(21)
    v_mfma_f32_32x32x16_bf16 v[34:49], v[138:141], v[134:137], v[34:49]
    s_waitcnt vmcnt(20)
    v_mfma_f32_32x32x16_bf16 v[18:33], v[130:133], v[142:145], v[18:33]
    v_mfma_f32_32x32x16_bf16 v[50:65], v[138:141], v[142:145], v[50:65]
    s_add_u32 s14, s14, 4096
    s_add_u32 s15, s15, 4096
    s_add_u32 s16, s16, 4096
    s_add_u32 s17, s17, 4096
    buffer_load_dwordx4 v[130:133], v1, s[32:35], s14 offen offset:0
    buffer_load_dwordx4 v[134:137], v1, s[32:35], s16 offen offset:0
    buffer_load_dwordx4 v[138:141], v1, s[32:35], s15 offen offset:0
    buffer_load_dwordx4 v[142:145], v1, s[32:35], s17 offen offset:0
    s_add_u32 m0, s23, 0
    s_nop 0
    buffer_load_dwordx4 v1, s[32:35], s44 offen offset:0 lds
    s_add_u32 m0, s23, 1024
    s_nop 0
    buffer_load_dwordx4 v1, s[32:35], s45 offen offset:0 lds
    s_waitcnt vmcnt(24)
    v_mfma_f32_32x32x16_bf16 v[2:17], v[146:149], v[150:153], v[2:17]
    s_waitcnt vmcnt(23)
    v_mfma_f32_32x32x16_bf16 v[34:49], v[154:157], v[150:153], v[34:49]
    s_waitcnt vmcnt(22)
    v_mfma_f32_32x32x16_bf16 v[18:33], v[146:149], v[158:161], v[18:33]
    v_mfma_f32_32x32x16_bf16 v[50:65], v[154:157], v[158:161], v[50:65]
ST_C_39:
    s_cbranch_execz K1_CONS
    buffer_load_dwordx4 v[146:149], v1, s[32:35], s14 offen offset:1024
    buffer_load_dwordx4 v[150:153], v1, s[32:35], s16 offen offset:1024
    buffer_load_dwordx4 v[154:157], v1, s[32:35], s15 offen offset:1024
    buffer_load_dwordx4 v[158:161], v1, s[32:35], s17 offen offset:1024
    s_add_u32 m0, s23, 1024
    s_nop 0
    buffer_load_dwordx4 v1, s[32:35], s44 offen offset:1024 lds
    s_add_u32 m0, s23, 2048
    s_nop 0
    buffer_load_dwordx4 v1, s[32:35], s45 offen offset:1024 lds
    s_waitcnt vmcnt(26)
    v_mfma_f32_32x32x16_bf16 v[2:17], v[66:69], v[70:73], v[2:17]
    s_waitcnt vmcnt(25)
    v_mfma_f32_32x32x16_bf16 v[34:49], v[74:77], v[70:73], v[34:49]
    s_waitcnt vmcnt(24)
    v_mfma_f32_32x32x16_bf16 v[18:33], v[66:69], v[78:81], v[18:33]
    v_mfma_f32_32x32x16_bf16 v[50:65], v[74:77], v[78:81], v[50:65]
    buffer_load_dwordx4 v[66:69], v1, s[32:35], s14 offen offset:2048
    buffer_load_dwordx4 v[70:73], v1, s[32:35], s16 offen offset:2048
    buffer_load_dwordx4 v[74:77], v1, s[32:35], s15 offen offset:2048
    buffer_load_dwordx4 v[78:81], v1, s[32:35], s17 offen offset:2048
    s_add_u32 m0, s23, 2048
    s_nop 0
    buffer_load_dwordx4 v1, s[32:35], s44 offen offset:2048 lds
    s_add_u32 m0, s23, 3072
    s_nop 0
    buffer_load_dwordx4 v1, s[32:35], s45 offen offset:2048 lds
    s_waitcnt vmcnt(28)
    v_mfma_f32_32x32x16_bf16 v[2:17], v[82:85], v[86:89], v[2:17]
    s_waitcnt vmcnt(27)
    v_mfma_f32_32x32x16_bf16 v[34:49], v[90:93], v[86:89], v[34:49]
    s_waitcnt vmcnt(26)
    v_mfma_f32_32x32x16_bf16 v[18:33], v[82:85], v[94:97], v[18:33]
    v_mfma_f32_32x32x16_bf16 v[50:65], v[90:93], v[94:97], v[50:65]
    buffer_load_dwordx4 v[82:85], v1, s[32:35], s14 offen offset:3072
    buffer_load_dwordx4 v[86:89], v1, s[32:35], s16 offen offset:3072
    buffer_load_dwordx4 v[90:93], v1, s[32:35], s15 offen offset:3072
ST_C_40:
    s_cbranch_execz K1_CONS
    buffer_load_dwordx4 v[94:97], v1, s[32:35], s17 offen offset:3072
    s_add_u32 m0, s23, 3072
    s_nop 0
    buffer_load_dwordx4 v1, s[32:35], s44 offen offset:3072 lds
    s_add_u32 m0, s23, 4096
    s_nop 0
    buffer_load_dwordx4 v1, s[32:35], s45 offen offset:3072 lds
    s_waitcnt vmcnt(30)
    v_mfma_f32_32x32x16_bf16 v[2:17], v[98:101], v[102:105], v[2:17]
    s_waitcnt vmcnt(29)
    v_mfma_f32_32x32x16_bf16 v[34:49], v[106:109], v[102:105], v[34:49]
    s_waitcnt vmcnt(28)
    v_mfma_f32_32x32x16_bf16 v[18:33], v[98:101], v[110:113], v[18:33]
    v_mfma_f32_32x32x16_bf16 v[50:65], v[106:109], v[110:113], v[50:65]
    s_add_u32 s14, s14, 4096
    s_add_u32 s15, s15, 4096
    s_add_u32 s16, s16, 4096
    s_add_u32 s17, s17, 4096
    buffer_load_dwordx4 v[98:101], v1, s[32:35], s14 offen offset:0
    buffer_load_dwordx4 v[102:105], v1, s[32:35], s16 offen offset:0
    buffer_load_dwordx4 v[106:109], v1, s[32:35], s15 offen offset:0
    buffer_load_dwordx4 v[110:113], v1, s[32:35], s17 offen offset:0
    s_waitcnt vmcnt(30)
    v_mfma_f32_32x32x16_bf16 v[2:17], v[114:117], v[118:121], v[2:17]
    s_waitcnt vmcnt(29)
    v_mfma_f32_32x32x16_bf16 v[34:49], v[122:125], v[118:121], v[34:49]
    s_waitcnt vmcnt(28)
    v_mfma_f32_32x32x16_bf16 v[18:33], v[114:117], v[126:129], v[18:33]
    v_mfma_f32_32x32x16_bf16 v[50:65], v[122:125], v[126:129], v[50:65]
    buffer_load_dwordx4 v[114:117], v1, s[32:35], s14 offen offset:1024
    buffer_load_dwordx4 v[118:121], v1, s[32:35], s16 offen offset:1024
    buffer_load_dwordx4 v[122:125], v1, s[32:35], s15 offen offset:1024
    buffer_load_dwordx4 v[126:129], v1, s[32:35], s17 offen offset:1024
    s_waitcnt vmcnt(30)
    v_mfma_f32_32x32x16_bf16 v[2:17], v[130:133], v[134:137], v[2:17]
    s_waitcnt vmcnt(29)
ST_C_41:
    s_cbranch_execz K1_CONS
    v_mfma_f32_32x32x16_bf16 v[34:49], v[138:141], v[134:137], v[34:49]
    s_waitcnt vmcnt(28)
    v_mfma_f32_32x32x16_bf16 v[18:33], v[130:133], v[142:145], v[18:33]
    v_mfma_f32_32x32x16_bf16 v[50:65], v[138:141], v[142:145], v[50:65]
    buffer_load_dwordx4 v[130:133], v1, s[32:35], s14 offen offset:2048
    buffer_load_dwordx4 v[134:137], v1, s[32:35], s16 offen offset:2048
    buffer_load_dwordx4 v[138:141], v1, s[32:35], s15 offen offset:2048
    buffer_load_dwordx4 v[142:145], v1, s[32:35], s17 offen offset:2048
    s_waitcnt vmcnt(28)
    v_mfma_f32_32x32x16_bf16 v[2:17], v[146:149], v[150:153], v[2:17]
    s_waitcnt vmcnt(27)
    v_mfma_f32_32x32x16_bf16 v[34:49], v[154:157], v[150:153], v[34:49]
    s_waitcnt vmcnt(26)
    v_mfma_f32_32x32x16_bf16 v[18:33], v[146:149], v[158:161], v[18:33]
    v_mfma_f32_32x32x16_bf16 v[50:65], v[154:157], v[158:161], v[50:65]
    buffer_load_dwordx4 v[146:149], v1, s[32:35], s14 offen offset:3072
    buffer_load_dwordx4 v[150:153], v1, s[32:35], s16 offen offset:3072
    buffer_load_dwordx4 v[154:157], v1, s[32:35], s15 offen offset:3072
    buffer_load_dwordx4 v[158:161], v1, s[32:35], s17 offen offset:3072
    s_waitcnt vmcnt(26)
    v_mfma_f32_32x32x16_bf16 v[2:17], v[66:69], v[70:73], v[2:17]
    s_waitcnt vmcnt(25)
    v_mfma_f32_32x32x16_bf16 v[34:49], v[74:77], v[70:73], v[34:49]
    s_waitcnt vmcnt(24)
    v_mfma_f32_32x32x16_bf16 v[18:33], v[66:69], v[78:81], v[18:33]
    v_mfma_f32_32x32x16_bf16 v[50:65], v[74:77], v[78:81], v[50:65]
    s_add_u32 s14, s14, 4096
    s_add_u32 s15, s15, 4096
    s_add_u32 s16, s16, 4096
    s_add_u32 s17, s17, 4096
    buffer_load_dwordx4 v[66:69], v1, s[32:35], s14 offen offset:0
    buffer_load_dwordx4 v[70:73], v1, s[32:35], s16 offen offset:0
    buffer_load_dwordx4 v[74:77], v1, s[32:35], s15 offen offset:0
    buffer_load_dwordx4 v[78:81], v1, s[32:35], s17 offen offset:0
    s_waitcnt vmcnt(24)
    v_mfma_f32_32x32x16_bf16 v[2:17], v[82:85], v[86:89], v[2:17]
ST_C_42:
    s_cbranch_execz K1_CONS
    s_waitcnt vmcnt(23)
    v_mfma_f32_32x32x16_bf16 v[34:49], v[90:93], v[86:89], v[34:49]
    s_waitcnt vmcnt(22)
    v_mfma_f32_32x32x16_bf16 v[18:33], v[82:85], v[94:97], v[18:33]
    v_mfma_f32_32x32x16_bf16 v[50:65], v[90:93], v[94:97], v[50:65]
    buffer_load_dwordx4 v[82:85], v1, s[32:35], s14 offen offset:1024
    buffer_load_dwordx4 v[86:89], v1, s[32:35], s16 offen offset:1024
    buffer_load_dwordx4 v[90:93], v1, s[32:35], s15 offen offset:1024
    buffer_load_dwordx4 v[94:97], v1, s[32:35], s17 offen offset:1024
    s_waitcnt vmcnt(22)
    v_mfma_f32_32x32x16_bf16 v[2:17], v[98:101], v[102:105], v[2:17]
    s_waitcnt vmcnt(21)
    v_mfma_f32_32x32x16_bf16 v[34:49], v[106:109], v[102:105], v[34:49]
    s_waitcnt vmcnt(20)
    v_mfma_f32_32x32x16_bf16 v[18:33], v[98:101], v[110:113], v[18:33]
    v_mfma_f32_32x32x16_bf16 v[50:65], v[106:109], v[110:113], v[50:65]
    buffer_load_dwordx4 v[98:101], v1, s[32:35], s14 offen offset:2048
    buffer_load_dwordx4 v[102:105], v1, s[32:35], s16 offen offset:2048
    buffer_load_dwordx4 v[106:109], v1, s[32:35], s15 offen offset:2048
    buffer_load_dwordx4 v[110:113], v1, s[32:35], s17 offen offset:2048
    s_waitcnt vmcnt(22)
    v_mfma_f32_32x32x16_bf16 v[2:17], v[114:117], v[118:121], v[2:17]
    s_waitcnt vmcnt(21)
    v_mfma_f32_32x32x16_bf16 v[34:49], v[122:125], v[118:121], v[34:49]
    s_waitcnt vmcnt(20)
    v_mfma_f32_32x32x16_bf16 v[18:33], v[114:117], v[126:129], v[18:33]
    v_mfma_f32_32x32x16_bf16 v[50:65], v[122:125], v[126:129], v[50:65]
    buffer_load_dwordx4 v[114:117], v1, s[32:35], s14 offen offset:3072
    buffer_load_dwordx4 v[118:121], v1, s[32:35], s16 offen offset:3072
    buffer_load_dwordx4 v[122:125], v1, s[32:35], s15 offen offset:3072
    buffer_load_dwordx4 v[126:129], v1, s[32:35], s17 offen offset:3072
    s_barrier
    s_waitcnt vmcnt(22)
    v_mfma_f32_32x32x16_bf16 v[2:17], v[130:133], v[134:137], v[2:17]
    s_waitcnt vmcnt(21)
    v_mfma_f32_32x32x16_bf16 v[34:49], v[138:141], v[134:137], v[34:49]
    s_waitcnt vmcnt(20)
ST_C_43:
    s_cbranch_execz K1_CONS
    v_mfma_f32_32x32x16_bf16 v[18:33], v[130:133], v[142:145], v[18:33]
    v_mfma_f32_32x32x16_bf16 v[50:65], v[138:141], v[142:145], v[50:65]
    buffer_load_dwordx4 v[130:133], v1, s[32:35], s40 offen offset:0
    buffer_load_dwordx4 v[134:137], v1, s[32:35], s41 offen offset:0
    buffer_load_dwordx4 v[138:141], v1, s[32:35], s40 offen offset:1024
    buffer_load_dwordx4 v[142:145], v1, s[32:35], s41 offen offset:1024
    s_waitcnt vmcnt(22)
    v_mfma_f32_32x32x16_bf16 v[2:17], v[146:149], v[150:153], v[2:17]
    s_waitcnt vmcnt(21)
    v_mfma_f32_32x32x16_bf16 v[34:49], v[154:157], v[150:153], v[34:49]
    s_waitcnt vmcnt(20)
    v_mfma_f32_32x32x16_bf16 v[18:33], v[146:149], v[158:161], v[18:33]
    v_mfma_f32_32x32x16_bf16 v[50:65], v[154:157], v[158:161], v[50:65]
    buffer_load_dwordx4 v[146:149], v1, s[32:35], s40 offen offset:2048
    buffer_load_dwordx4 v[150:153], v1, s[32:35], s41 offen offset:2048
    buffer_load_dwordx4 v[154:157], v1, s[32:35], s40 offen offset:3072
    buffer_load_dwordx4 v[158:161], v1, s[32:35], s41 offen offset:3072
    s_waitcnt vmcnt(22)
    v_mfma_f32_32x32x16_bf16 v[2:17], v[66:69], v[70:73], v[2:17]
    s_waitcnt vmcnt(21)
    v_mfma_f32_32x32x16_bf16 v[34:49], v[74:77], v[70:73], v[34:49]
    s_waitcnt vmcnt(20)
    v_mfma_f32_32x32x16_bf16 v[18:33], v[66:69], v[78:81], v[18:33]
    v_mfma_f32_32x32x16_bf16 v[50:65], v[74:77], v[78:81], v[50:65]
    s_waitcnt vmcnt(18)
    v_mfma_f32_32x32x16_bf16 v[2:17], v[82:85], v[86:89], v[2:17]
    s_waitcnt vmcnt(17)
    v_mfma_f32_32x32x16_bf16 v[34:49], v[90:93], v[86:89], v[34:49]
    s_waitcnt vmcnt(16)
    v_mfma_f32_32x32x16_bf16 v[18:33], v[82:85], v[94:97], v[18:33]
    v_mfma_f32_32x32x16_bf16 v[50:65], v[90:93], v[94:97], v[50:65]
    s_waitcnt vmcnt(14)
    v_mfma_f32_32x32x16_bf16 v[2:17], v[98:101], v[102:105], v[2:17]
    s_waitcnt vmcnt(13)
    v_mfma_f32_32x32x16_bf16 v[34:49], v[106:109], v[102:105], v[34:49]
    s_waitcnt vmcnt(12)
    v_mfma_f32_32x32x16_bf16 v[18:33], v[98:101], v[110:113], v[18:33]
    v_mfma_f32_32x32x16_bf16 v[50:65], v[106:109], v[110:113], v[50:65]
ST_C_44:
    s_cbranch_execz K1_CONS
    s_waitcnt vmcnt(10)
    v_mfma_f32_32x32x16_bf16 v[2:17], v[114:117], v[118:121], v[2:17]
    s_waitcnt vmcnt(9)
    v_mfma_f32_32x32x16_bf16 v[34:49], v[122:125], v[118:121], v[34:49]
    s_waitcnt vmcnt(8)
    v_mfma_f32_32x32x16_bf16 v[18:33], v[114:117], v[126:129], v[18:33]
    v_mfma_f32_32x32x16_bf16 v[50:65], v[122:125], v[126:129], v[50:65]
    v_sub_f32 v166, 1.0, v166
    v_sub_f32 v167, 1.0, v167
    v_mov_b32 v162, 155712
    v_add_u32 v163, s23, v1
    s_nop 2
    v_mul_f32 v2, v2, v166
    v_mul_f32 v3, v3, v166
    v_mul_f32 v4, v4, v166
    v_mul_f32 v5, v5, v166
    v_mul_f32 v6, v6, v166
    v_mul_f32 v7, v7, v166
    v_mul_f32 v8, v8, v166
    v_mul_f32 v9, v9, v166
    v_mul_f32 v10, v10, v166
    v_mul_f32 v11, v11, v166
    v_mul_f32 v12, v12, v166
    v_mul_f32 v13, v13, v166
    v_mul_f32 v14, v14, v166
    v_mul_f32 v15, v15, v166
    v_mul_f32 v16, v16, v166
    v_mul_f32 v17, v17, v166
    v_mul_f32 v18, v18, v167
    v_mul_f32 v19, v19, v167
    v_mul_f32 v20, v20, v167
    v_mul_f32 v21, v21, v167
    v_mul_f32 v22, v22, v167
    v_mul_f32 v23, v23, v167
    v_mul_f32 v24, v24, v167
    v_mul_f32 v25, v25, v167
    v_mul_f32 v26, v26, v167
    v_mul_f32 v27, v27, v167
    v_mul_f32 v28, v28, v167
    v_mul_f32 v29, v29, v167
    v_mul_f32 v30, v30, v167
    v_mul_f32 v31, v31, v167
    v_mul_f32 v32, v32, v167
    v_mul_f32 v33, v33, v167
    v_mul_f32 v34, v34, v166
    v_mul_f32 v35, v35, v166
    v_mul_f32 v36, v36, v166
    v_mul_f32 v37, v37, v166
    v_mul_f32 v38, v38, v166
    v_mul_f32 v39, v39, v166
    v_mul_f32 v40, v40, v166
    v_mul_f32 v41, v41, v166
    v_mul_f32 v42, v42, v166
    v_mul_f32 v43, v43, v166
    v_mul_f32 v44, v44, v166
    v_mul_f32 v45, v45, v166
    v_mul_f32 v46, v46, v166
ST_C_45:
    s_cbranch_execz K1_CONS
    v_mul_f32 v47, v47, v166
    v_mul_f32 v48, v48, v166
    v_mul_f32 v49, v49, v166
    v_mul_f32 v50, v50, v167
    v_mul_f32 v51, v51, v167
    v_mul_f32 v52, v52, v167
    v_mul_f32 v53, v53, v167
    v_mul_f32 v54, v54, v167
    v_mul_f32 v55, v55, v167
    v_mul_f32 v56, v56, v167
    v_mul_f32 v57, v57, v167
    v_mul_f32 v58, v58, v167
    v_mul_f32 v59, v59, v167
    v_mul_f32 v60, v60, v167
    v_mul_f32 v61, v61, v167
    v_mul_f32 v62, v62, v167
    v_mul_f32 v63, v63, v167
    v_mul_f32 v64, v64, v167
    v_mul_f32 v65, v65, v167
    s_waitcnt vmcnt(0)
    s_mov_b32 s24, 20000
    s_barrier
    ds_read_b32 v166, v162
    s_waitcnt lgkmcnt(0)
    v_readfirstlane_b32 s18, v166
    s_cmp_eq_u32 s18, 0
    s_cbranch_scc1 K2_GNF
    s_barrier
    s_barrier
    s_barrier
    s_barrier
K2_GNF:
    buffer_load_dwordx4 v[66:69], v1, s[32:35], s42 offen offset:0 sc1
    buffer_load_dwordx4 v[70:73], v1, s[32:35], s43 offen offset:0 sc1
    buffer_load_dwordx4 v[74:77], v1, s[32:35], s42 offen offset:1024 sc1
    buffer_load_dwordx4 v[78:81], v1, s[32:35], s43 offen offset:1024 sc1
    buffer_load_dwordx4 v[82:85], v1, s[32:35], s42 offen offset:2048 sc1
    buffer_load_dwordx4 v[86:89], v1, s[32:35], s43 offen offset:2048 sc1
    buffer_load_dwordx4 v[90:93], v1, s[32:35], s42 offen offset:3072 sc1
    buffer_load_dwordx4 v[94:97], v1, s[32:35], s43 offen offset:3072 sc1
    buffer_load_dwordx4 v[98:101], v1, s[32:35], s46 offen offset:0 sc1
    buffer_load_dwordx4 v[102:105], v1, s[32:35], s47 offen offset:0 sc1
    buffer_load_dwordx4 v[106:109], v1, s[32:35], s46 offen offset:1024 sc1
    buffer_load_dwordx4 v[110:113], v1, s[32:35], s47 offen offset:1024 sc1
    buffer_load_dwordx4 v[114:117], v1, s[32:35], s46 offen offset:2048 sc1
    buffer_load_dwordx4 v[118:121], v1, s[32:35], s47 offen offset:2048 sc1
    buffer_load_dwordx4 v[122:125], v1, s[32:35], s46 offen offset:3072 sc1
ST_C_46:
    s_cbranch_execz K1_CONS
    buffer_load_dwordx4 v[126:129], v1, s[32:35], s47 offen offset:3072 sc1
K2_PL0:
    s_waitcnt vmcnt(14)
    v_max3_u32 v166, v66, v67, v68
    v_max3_u32 v167, v69, v70, v71
    v_max3_u32 v166, v166, v72, v73
    v_max_u32 v166, v166, v167
    v_cmp_eq_u32 vcc, -1, v166
    s_cbranch_vccz K2_PK0
    s_cmp_eq_u32 s24, 0
    s_cbranch_scc1 K2_PK0
    s_sub_u32 s24, s24, 1
    s_sleep 2
    buffer_load_dwordx4 v[66:69], v1, s[32:35], s42 offen offset:0 sc1
    buffer_load_dwordx4 v[70:73], v1, s[32:35], s43 offen offset:0 sc1
    buffer_load_dwordx4 v[74:77], v1, s[32:35], s42 offen offset:1024 sc1
    buffer_load_dwordx4 v[78:81], v1, s[32:35], s43 offen offset:1024 sc1
    buffer_load_dwordx4 v[82:85], v1, s[32:35], s42 offen offset:2048 sc1
    buffer_load_dwordx4 v[86:89], v1, s[32:35], s43 offen offset:2048 sc1
    buffer_load_dwordx4 v[90:93], v1, s[32:35], s42 offen offset:3072 sc1
    buffer_load_dwordx4 v[94:97], v1, s[32:35], s43 offen offset:3072 sc1
    buffer_load_dwordx4 v[98:101], v1, s[32:35], s46 offen offset:0 sc1
    buffer_load_dwordx4 v[102:105], v1, s[32:35], s47 offen offset:0 sc1
    buffer_load_dwordx4 v[106:109], v1, s[32:35], s46 offen offset:1024 sc1
    buffer_load_dwordx4 v[110:113], v1, s[32:35], s47 offen offset:1024 sc1
    buffer_load_dwordx4 v[114:117], v1, s[32:35], s46 offen offset:2048 sc1
    buffer_load_dwordx4 v[118:121], v1, s[32:35], s47 offen offset:2048 sc1
    buffer_load_dwordx4 v[122:125], v1, s[32:35], s46 offen offset:3072 sc1
    buffer_load_dwordx4 v[126:129], v1, s[32:35], s47 offen offset:3072 sc1
    s_branch K2_PL0
K2_PK0:
    v_mfma_f32_32x32x16_bf16 v[2:17], v[130:133], v[66:69], v[2:17]
    v_mfma_f32_32x32x16_bf16 v[34:49], v[134:137], v[66:69], v[34:49]
    v_mfma_f32_32x32x16_bf16 v[18:33], v[130:133], v[70:73], v[18:33]
    v_mfma_f32_32x32x16_bf16 v[50:65], v[134:137], v[70:73], v[50:65]
    ds_read_b128 v[130:133], v163 offset:0
    ds_read_b128 v[134:137], v163 offset:1024
K2_PL1:
    s_waitcnt vmcnt(12)
    v_max3_u32 v166, v74, v75, v76
ST_C_47:
    s_cbranch_execz K1_CONS
    v_max3_u32 v167, v77, v78, v79
    v_max3_u32 v166, v166, v80, v81
    v_max_u32 v166, v166, v167
    v_cmp_eq_u32 vcc, -1, v166
    s_cbranch_vccz K2_PK1
    s_cmp_eq_u32 s24, 0
    s_cbranch_scc1 K2_PK1
    s_sub_u32 s24, s24, 1
    s_sleep 2
    buffer_load_dwordx4 v[74:77], v1, s[32:35], s42 offen offset:1024 sc1
    buffer_load_dwordx4 v[78:81], v1, s[32:35], s43 offen offset:1024 sc1
    buffer_load_dwordx4 v[82:85], v1, s[32:35], s42 offen offset:2048 sc1
    buffer_load_dwordx4 v[86:89], v1, s[32:35], s43 offen offset:2048 sc1
    buffer_load_dwordx4 v[90:93], v1, s[32:35], s42 offen offset:3072 sc1
    buffer_load_dwordx4 v[94:97], v1, s[32:35], s43 offen offset:3072 sc1
    buffer_load_dwordx4 v[98:101], v1, s[32:35], s46 offen offset:0 sc1
    buffer_load_dwordx4 v[102:105], v1, s[32:35], s47 offen offset:0 sc1
    buffer_load_dwordx4 v[106:109], v1, s[32:35], s46 offen offset:1024 sc1
    buffer_load_dwordx4 v[110:113], v1, s[32:35], s47 offen offset:1024 sc1
    buffer_load_dwordx4 v[114:117], v1, s[32:35], s46 offen offset:2048 sc1
    buffer_load_dwordx4 v[118:121], v1, s[32:35], s47 offen offset:2048 sc1
    buffer_load_dwordx4 v[122:125], v1, s[32:35], s46 offen offset:3072 sc1
    buffer_load_dwordx4 v[126:129], v1, s[32:35], s47 offen offset:3072 sc1
    s_branch K2_PL1
K2_PK1:
    v_mfma_f32_32x32x16_bf16 v[2:17], v[138:141], v[74:77], v[2:17]
    v_mfma_f32_32x32x16_bf16 v[34:49], v[142:145], v[74:77], v[34:49]
    v_mfma_f32_32x32x16_bf16 v[18:33], v[138:141], v[78:81], v[18:33]
    v_mfma_f32_32x32x16_bf16 v[50:65], v[142:145], v[78:81], v[50:65]
    ds_read_b128 v[138:141], v163 offset:2048
    ds_read_b128 v[142:145], v163 offset:3072
K2_PL2:
    s_waitcnt vmcnt(10)
    v_max3_u32 v166, v82, v83, v84
    v_max3_u32 v167, v85, v86, v87
    v_max3_u32 v166, v166, v88, v89
    v_max_u32 v166, v166, v167
    v_cmp_eq_u32 vcc, -1, v166
    s_cbranch_vccz K2_PK2
ST_C_48:
    s_cbranch_execz K1_CONS
    s_cmp_eq_u32 s24, 0
    s_cbranch_scc1 K2_PK2
    s_sub_u32 s24, s24, 1
    s_sleep 2
    buffer_load_dwordx4 v[82:85], v1, s[32:35], s42 offen offset:2048 sc1
    buffer_load_dwordx4 v[86:89], v1, s[32:35], s43 offen offset:2048 sc1
    buffer_load_dwordx4 v[90:93], v1, s[32:35], s42 offen offset:3072 sc1
    buffer_load_dwordx4 v[94:97], v1, s[32:35], s43 offen offset:3072 sc1
    buffer_load_dwordx4 v[98:101], v1, s[32:35], s46 offen offset:0 sc1
    buffer_load_dwordx4 v[102:105], v1, s[32:35], s47 offen offset:0 sc1
    buffer_load_dwordx4 v[106:109], v1, s[32:35], s46 offen offset:1024 sc1
    buffer_load_dwordx4 v[110:113], v1, s[32:35], s47 offen offset:1024 sc1
    buffer_load_dwordx4 v[114:117], v1, s[32:35], s46 offen offset:2048 sc1
    buffer_load_dwordx4 v[118:121], v1, s[32:35], s47 offen offset:2048 sc1
    buffer_load_dwordx4 v[122:125], v1, s[32:35], s46 offen offset:3072 sc1
    buffer_load_dwordx4 v[126:129], v1, s[32:35], s47 offen offset:3072 sc1
    s_branch K2_PL2
K2_PK2:
    v_mfma_f32_32x32x16_bf16 v[2:17], v[146:149], v[82:85], v[2:17]
    v_mfma_f32_32x32x16_bf16 v[34:49], v[150:153], v[82:85], v[34:49]
    v_mfma_f32_32x32x16_bf16 v[18:33], v[146:149], v[86:89], v[18:33]
    v_mfma_f32_32x32x16_bf16 v[50:65], v[150:153], v[86:89], v[50:65]
    ds_read_b128 v[146:149], v163 offset:4096
    ds_read_b128 v[150:153], v163 offset:5120
K2_PL3:
    s_waitcnt vmcnt(8)
    v_max3_u32 v166, v90, v91, v92
    v_max3_u32 v167, v93, v94, v95
    v_max3_u32 v166, v166, v96, v97
    v_max_u32 v166, v166, v167
    v_cmp_eq_u32 vcc, -1, v166
    s_cbranch_vccz K2_PK3
    s_cmp_eq_u32 s24, 0
    s_cbranch_scc1 K2_PK3
    s_sub_u32 s24, s24, 1
    s_sleep 2
    buffer_load_dwordx4 v[90:93], v1, s[32:35], s42 offen offset:3072 sc1
    buffer_load_dwordx4 v[94:97], v1, s[32:35], s43 offen offset:3072 sc1
    buffer_load_dwordx4 v[98:101], v1, s[32:35], s46 offen offset:0 sc1
    buffer_load_dwordx4 v[102:105], v1, s[32:35], s47 offen offset:0 sc1
ST_C_49:
    s_cbranch_execz K1_CONS
    buffer_load_dwordx4 v[106:109], v1, s[32:35], s46 offen offset:1024 sc1
    buffer_load_dwordx4 v[110:113], v1, s[32:35], s47 offen offset:1024 sc1
    buffer_load_dwordx4 v[114:117], v1, s[32:35], s46 offen offset:2048 sc1
    buffer_load_dwordx4 v[118:121], v1, s[32:35], s47 offen offset:2048 sc1
    buffer_load_dwordx4 v[122:125], v1, s[32:35], s46 offen offset:3072 sc1
    buffer_load_dwordx4 v[126:129], v1, s[32:35], s47 offen offset:3072 sc1
    s_branch K2_PL3
K2_PK3:
    v_mfma_f32_32x32x16_bf16 v[2:17], v[154:157], v[90:93], v[2:17]
    v_mfma_f32_32x32x16_bf16 v[34:49], v[158:161], v[90:93], v[34:49]
    v_mfma_f32_32x32x16_bf16 v[18:33], v[154:157], v[94:97], v[18:33]
    v_mfma_f32_32x32x16_bf16 v[50:65], v[158:161], v[94:97], v[50:65]
    ds_read_b128 v[154:157], v163 offset:6144
    ds_read_b128 v[158:161], v163 offset:7168
K2_PL4:
    s_waitcnt vmcnt(6)
    v_max3_u32 v166, v98, v99, v100
    v_max3_u32 v167, v101, v102, v103
    v_max3_u32 v166, v166, v104, v105
    v_max_u32 v166, v166, v167
    v_cmp_eq_u32 vcc, -1, v166
    s_cbranch_vccz K2_PK4
    s_cmp_eq_u32 s24, 0
    s_cbranch_scc1 K2_PK4
    s_sub_u32 s24, s24, 1
    s_sleep 2
    buffer_load_dwordx4 v[98:101], v1, s[32:35], s46 offen offset:0 sc1
    buffer_load_dwordx4 v[102:105], v1, s[32:35], s47 offen offset:0 sc1
    buffer_load_dwordx4 v[106:109], v1, s[32:35], s46 offen offset:1024 sc1
    buffer_load_dwordx4 v[110:113], v1, s[32:35], s47 offen offset:1024 sc1
    buffer_load_dwordx4 v[114:117], v1, s[32:35], s46 offen offset:2048 sc1
    buffer_load_dwordx4 v[118:121], v1, s[32:35], s47 offen offset:2048 sc1
    buffer_load_dwordx4 v[122:125], v1, s[32:35], s46 offen offset:3072 sc1
    buffer_load_dwordx4 v[126:129], v1, s[32:35], s47 offen offset:3072 sc1
    s_branch K2_PL4
K2_PK4:
    s_waitcnt lgkmcnt(6)
    v_mfma_f32_32x32x16_bf16 v[2:17], v[130:133], v[98:101], v[2:17]
    v_mfma_f32_32x32x16_bf16 v[34:49], v[134:137], v[98:101], v[34:49]
    v_mfma_f32_32x32x16_bf16 v[18:33], v[130:133], v[102:105], v[18:33]
ST_C_50:
    s_cbranch_execz K1_CONS
    v_mfma_f32_32x32x16_bf16 v[50:65], v[134:137], v[102:105], v[50:65]
K2_PL5:
    s_waitcnt vmcnt(4)
    v_max3_u32 v166, v106, v107, v108
    v_max3_u32 v167, v109, v110, v111
    v_max3_u32 v166, v166, v112, v113
    v_max_u32 v166, v166, v167
    v_cmp_eq_u32 vcc, -1, v166
    s_cbranch_vccz K2_PK5
    s_cmp_eq_u32 s24, 0
    s_cbranch_scc1 K2_PK5
    s_sub_u32 s24, s24, 1
    s_sleep 2
    buffer_load_dwordx4 v[106:109], v1, s[32:35], s46 offen offset:1024 sc1
    buffer_load_dwordx4 v[110:113], v1, s[32:35], s47 offen offset:1024 sc1
    buffer_load_dwordx4 v[114:117], v1, s[32:35], s46 offen offset:2048 sc1
    buffer_load_dwordx4 v[118:121], v1, s[32:35], s47 offen offset:2048 sc1
    buffer_load_dwordx4 v[122:125], v1, s[32:35], s46 offen offset:3072 sc1
    buffer_load_dwordx4 v[126:129], v1, s[32:35], s47 offen offset:3072 sc1
    s_branch K2_PL5
K2_PK5:
    s_waitcnt lgkmcnt(4)
    v_mfma_f32_32x32x16_bf16 v[2:17], v[138:141], v[106:109], v[2:17]
    v_mfma_f32_32x32x16_bf16 v[34:49], v[142:145], v[106:109], v[34:49]
    v_mfma_f32_32x32x16_bf16 v[18:33], v[138:141], v[110:113], v[18:33]
    v_mfma_f32_32x32x16_bf16 v[50:65], v[142:145], v[110:113], v[50:65]
K2_PL6:
    s_waitcnt vmcnt(2)
    v_max3_u32 v166, v114, v115, v116
    v_max3_u32 v167, v117, v118, v119
    v_max3_u32 v166, v166, v120, v121
    v_max_u32 v166, v166, v167
    v_cmp_eq_u32 vcc, -1, v166
    s_cbranch_vccz K2_PK6
    s_cmp_eq_u32 s24, 0
    s_cbranch_scc1 K2_PK6
    s_sub_u32 s24, s24, 1
    s_sleep 2
    buffer_load_dwordx4 v[114:117], v1, s[32:35], s46 offen offset:2048 sc1
    buffer_load_dwordx4 v[118:121], v1, s[32:35], s47 offen offset:2048 sc1
    buffer_load_dwordx4 v[122:125], v1, s[32:35], s46 offen offset:3072 sc1
    buffer_load_dwordx4 v[126:129], v1, s[32:35], s47 offen offset:3072 sc1
    s_branch K2_PL6
K2_PK6:
    s_waitcnt lgkmcnt(2)
    v_mfma_f32_32x32x16_bf16 v[2:17], v[146:149], v[114:117], v[2:17]
ST_C_51:
    s_cbranch_execz K1_CONS
    v_mfma_f32_32x32x16_bf16 v[34:49], v[150:153], v[114:117], v[34:49]
    v_mfma_f32_32x32x16_bf16 v[18:33], v[146:149], v[118:121], v[18:33]
    v_mfma_f32_32x32x16_bf16 v[50:65], v[150:153], v[118:121], v[50:65]
K2_PL7:
    s_waitcnt vmcnt(0)
    v_max3_u32 v166, v122, v123, v124
    v_max3_u32 v167, v125, v126, v127
    v_max3_u32 v166, v166, v128, v129
    v_max_u32 v166, v166, v167
    v_cmp_eq_u32 vcc, -1, v166
    s_cbranch_vccz K2_PK7
    s_cmp_eq_u32 s24, 0
    s_cbranch_scc1 K2_PK7
    s_sub_u32 s24, s24, 1
    s_sleep 2
    buffer_load_dwordx4 v[122:125], v1, s[32:35], s46 offen offset:3072 sc1
    buffer_load_dwordx4 v[126:129], v1, s[32:35], s47 offen offset:3072 sc1
    s_branch K2_PL7
K2_PK7:
    s_waitcnt lgkmcnt(0)
    v_mfma_f32_32x32x16_bf16 v[50:65], v[158:161], v[126:129], v[50:65]
    v_mfma_f32_32x32x16_bf16 v[34:49], v[158:161], v[122:125], v[34:49]
    v_mfma_f32_32x32x16_bf16 v[18:33], v[154:157], v[126:129], v[18:33]
    v_mfma_f32_32x32x16_bf16 v[2:17], v[154:157], v[122:125], v[2:17]
    s_xor_b32 s18, s3, 3
    s_mul_i32 s18, s18, 12288
    v_add_u32 v164, s18, v1
    s_xor_b32 s18, s3, 1
    s_mul_i32 s18, s18, 12288
    v_add_u32 v162, s18, v1
    s_xor_b32 s18, s3, 2
    s_mul_i32 s18, s18, 12288
    v_add_u32 v163, s18, v1
    s_mul_i32 s18, s3, 12288
    v_add_u32 v166, s18, v1
    ds_write_b128 v164, v[50:53] offset:8192
    ds_write_b128 v164, v[54:57] offset:9216
    ds_write_b128 v164, v[58:61] offset:10240
    ds_write_b128 v164, v[62:65] offset:11264
    ds_write_b128 v162, v[34:37] offset:0
    ds_write_b128 v162, v[38:41] offset:1024
    ds_write_b128 v162, v[42:45] offset:2048
ST_C_52:
    s_cbranch_execz K1_CONS
    ds_write_b128 v162, v[46:49] offset:3072
    ds_write_b128 v163, v[18:21] offset:4096
    ds_write_b128 v163, v[22:25] offset:5120
    ds_write_b128 v163, v[26:29] offset:6144
    ds_write_b128 v163, v[30:33] offset:7168
    v_add_u32 v167, s22, v165
    v_mul_u32_u24 v167, 896, v167
    v_lshrrev_b32 v165, 5, v0
    v_lshl_add_u32 v167, v165, 4, v167
    s_lshl_b32 s19, s9, 7
    s_lshl_b32 s20, s10, 6
    s_add_u32 s19, s19, s20
    s_waitcnt lgkmcnt(0)
    s_barrier
    ds_read_b128 v[66:69], v166 offset:0
    ds_read_b128 v[82:85], v166 offset:4096
    ds_read_b128 v[98:101], v166 offset:8192
    ds_read_b128 v[70:73], v166 offset:1024
    ds_read_b128 v[86:89], v166 offset:5120
    ds_read_b128 v[102:105], v166 offset:9216
    ds_read_b128 v[74:77], v166 offset:2048
    ds_read_b128 v[90:93], v166 offset:6144
    ds_read_b128 v[106:109], v166 offset:10240
    ds_read_b128 v[78:81], v166 offset:3072
    ds_read_b128 v[94:97], v166 offset:7168
    ds_read_b128 v[110:113], v166 offset:11264
    s_waitcnt lgkmcnt(10)
    v_pk_add_f32 v[66:67], v[66:67], v[82:83]
    v_pk_add_f32 v[68:69], v[68:69], v[84:85]
    s_waitcnt lgkmcnt(9)
    v_pk_add_f32 v[2:3], v[2:3], v[98:99]
    v_pk_add_f32 v[4:5], v[4:5], v[100:101]
    v_pk_add_f32 v[2:3], v[2:3], v[66:67]
    v_pk_add_f32 v[4:5], v[4:5], v[68:69]
    v_cvt_pk_bf16_f32 v114, v2, v3
    v_cvt_pk_bf16_f32 v115, v4, v5
ST_C_53:
    s_cbranch_execz K1_CONS
    s_waitcnt lgkmcnt(7)
    v_pk_add_f32 v[70:71], v[70:71], v[86:87]
    v_pk_add_f32 v[72:73], v[72:73], v[88:89]
    s_waitcnt lgkmcnt(6)
    v_pk_add_f32 v[6:7], v[6:7], v[102:103]
    v_pk_add_f32 v[8:9], v[8:9], v[104:105]
    v_pk_add_f32 v[6:7], v[6:7], v[70:71]
    v_pk_add_f32 v[8:9], v[8:9], v[72:73]
    v_cvt_pk_bf16_f32 v116, v6, v7
    v_cvt_pk_bf16_f32 v117, v8, v9
    s_nop 0
    v_permlane32_swap_b32 v114, v116
    v_permlane32_swap_b32 v115, v117
    buffer_store_dwordx4 v[114:117], v167, s[36:39], s19 offen offset:0
    s_waitcnt lgkmcnt(4)
    v_pk_add_f32 v[74:75], v[74:75], v[90:91]
    v_pk_add_f32 v[76:77], v[76:77], v[92:93]
    s_waitcnt lgkmcnt(3)
    v_pk_add_f32 v[10:11], v[10:11], v[106:107]
    v_pk_add_f32 v[12:13], v[12:13], v[108:109]
    v_pk_add_f32 v[10:11], v[10:11], v[74:75]
    v_pk_add_f32 v[12:13], v[12:13], v[76:77]
    v_cvt_pk_bf16_f32 v118, v10, v11
    v_cvt_pk_bf16_f32 v119, v12, v13
    s_waitcnt lgkmcnt(1)
    v_pk_add_f32 v[78:79], v[78:79], v[94:95]
    v_pk_add_f32 v[80:81], v[80:81], v[96:97]
    s_waitcnt lgkmcnt(0)
    v_pk_add_f32 v[14:15], v[14:15], v[110:111]
    v_pk_add_f32 v[16:17], v[16:17], v[112:113]
    v_pk_add_f32 v[14:15], v[14:15], v[78:79]
    v_pk_add_f32 v[16:17], v[16:17], v[80:81]
    v_cvt_pk_bf16_f32 v120, v14, v15
    v_cvt_pk_bf16_f32 v121, v16, v17
    s_nop 0
    v_permlane32_swap_b32 v118, v120
    v_permlane32_swap_b32 v119, v121
ST_C_54:
    s_cbranch_execz K1_CONS
    buffer_store_dwordx4 v[118:121], v167, s[36:39], s19 offen offset:32
    s_endpgm
K2_END:
    s_endpgm

.section .rodata,"a"
.p2align 6
.amdhsa_kernel k1_kernel
  .amdhsa_next_free_vgpr 256
  .amdhsa_next_free_sgpr 96
  .amdhsa_accum_offset 256
  .amdhsa_group_segment_fixed_size 0
  .amdhsa_kernarg_size 88
  .amdhsa_user_sgpr_count 2
  .amdhsa_user_sgpr_kernarg_segment_ptr 1
  .amdhsa_system_sgpr_workgroup_id_x 1
.end_amdhsa_kernel
.p2align 6
.amdhsa_kernel k2_kernel
  .amdhsa_next_free_vgpr 168
  .amdhsa_next_free_sgpr 96
  .amdhsa_accum_offset 168
  .amdhsa_group_segment_fixed_size 0
  .amdhsa_kernarg_size 88
  .amdhsa_user_sgpr_count 2
  .amdhsa_user_sgpr_kernarg_segment_ptr 1
  .amdhsa_system_sgpr_workgroup_id_x 1
.end_amdhsa_kernel
```
